```python
import torch

def _softmax(x, axis=-1):
    return torch.softmax(x, dim=axis)
def _gelu(x):
    return torch.nn.functional.gelu(x, approximate="tanh")
def _silu(x):
    return torch.nn.functional.silu(x)
def _sigmoid(x):
    return torch.sigmoid(x)
def _layernorm(x, axis=-1, eps=1e-5):
    m = x.mean(dim=axis, keepdim=True)
    v = x.var(dim=axis, keepdim=True, unbiased=False)
    return (x - m) / torch.sqrt(v + eps)
def _scatter_add(tgt, idx, src, axis=0):
    return tgt.clone().index_add_(axis, idx, src)
def _segment_sum(src, seg, n):
    out = torch.zeros((n,) + src.shape[1:], dtype=src.dtype)
    return out.index_add_(0, seg, src)
def _pad(x, pw):
    flat = tuple(v for pair in reversed(pw) for v in pair)
    return torch.nn.functional.pad(x, flat)

kernel_name = 'sequential_preLN__linear_kernel_hedgehog__glu_gated_geglu__prompt'

def setup_inputs():

    _w = (lambda a: (lambda t: t.to(torch.bfloat16) if t.is_floating_point() else t)(torch.as_tensor(a)))
    def _A_setup():
        B, S, D, H = 1, 2048, 640, 32
        Dh = D // H
        return {
            "x": _w((lambda *s: torch.randn(*s, dtype=torch.bfloat16) * 0.05)(B, S, D)),
            "wqkv": _w((lambda *s: torch.randn(*s, dtype=torch.bfloat16) * 0.2)(D, 3 * D)),
            "w_phi": _w((lambda *s: torch.randn(*s, dtype=torch.bfloat16) * 0.2)(H, Dh, Dh) * (Dh ** -0.5)),
            "wo": _w((lambda *s: torch.randn(*s, dtype=torch.bfloat16) * 0.05)(D, D)),
        }
    _A_in = _A_setup()

    def _B_setup():
        B, S, Dm, Df = 1, 2048, 640, 1536
        return {
            "x": _w((lambda *s: torch.randn(*s, dtype=torch.bfloat16) * 0.05)(B, S, Dm)),
            "w_gate": _w((lambda *s: torch.randn(*s, dtype=torch.bfloat16) * 0.4)(Dm, Df) * (Dm ** -0.5)),
            "w_up": _w((lambda *s: torch.randn(*s, dtype=torch.bfloat16) * 0.4)(Dm, Df) * (Dm ** -0.5)),
            "w_down": _w((lambda *s: torch.randn(*s, dtype=torch.bfloat16) * 0.4)(Df, Dm) * (Df ** -0.5)),
        }
    _B_in = _B_setup()

    return {
        "A_x": _A_in["x"],
        "A_wqkv": _A_in["wqkv"],
        "A_w_phi": _A_in["w_phi"],
        "A_wo": _A_in["wo"],
        "B_x": _B_in["x"],
        "B_w_gate": _B_in["w_gate"],
        "B_w_up": _B_in["w_up"],
        "B_w_down": _B_in["w_down"],
    }

def reference(A_x, A_wqkv, A_w_phi, A_wo, B_x, B_w_gate, B_w_up, B_w_down):
    def _A_ref(x, wqkv, w_phi, wo):
        B, S, D = x.shape
        H = 32; Dh = D // H
        qkv = (lambda x, *d: x.permute(*d))((x @ wqkv).reshape(B, S, 3, H, Dh), 2, 0, 3, 1, 4)
        q, k, v = qkv[0], qkv[1], qkv[2]
        pq = torch.einsum("bhsd,hdf->bhsf", q, w_phi)
        pk = torch.einsum("bhsd,hdf->bhsf", k, w_phi)
        phi_q = torch.concatenate([_softmax(pq, axis=-1), _softmax(-pq, axis=-1)], axis=-1)
        phi_k = torch.concatenate([_softmax(pk, axis=-1), _softmax(-pk, axis=-1)], axis=-1)
        kv = torch.einsum("bhsf,bhsd->bhfd", phi_k, v)
        z  = torch.einsum("bhsf->bhf", phi_k)
        num = torch.einsum("bhqf,bhfd->bhqd", phi_q, kv)
        den = torch.einsum("bhqf,bhf->bhq", phi_q, z)[..., None] + 1e-6
        o = num / den
        return (lambda x, *d: x.permute(*d))(o, 0, 2, 1, 3).reshape(B, S, D) @ wo

    def _B_ref(x, w_gate, w_up, w_down):
        g = torch.einsum("bsd,df->bsf", x, w_gate)
        u = torch.einsum("bsd,df->bsf", x, w_up)
        h = _gelu(g) * u
        return torch.einsum("bsf,fd->bsd", h, w_down)

    x = A_x
    h = x + _A_ref(_layernorm(x, axis=-1), A_wqkv, A_w_phi, A_wo)
    h2 = h + _B_ref(_layernorm(h, axis=-1), B_w_gate, B_w_up, B_w_down)
    return h2
```

```asm
; @launch grid=(256,1,1) block=(256,1,1) lds=163840
.amdgcn_target "amdgcn-amd-amdhsa--gfx950"
.text
.globl sequential_preLN__linear_kernel_hedgehog__glu_gated_geglu__prompt_kernel
.p2align 8
.type sequential_preLN__linear_kernel_hedgehog__glu_gated_geglu__prompt_kernel,@function
sequential_preLN__linear_kernel_hedgehog__glu_gated_geglu__prompt_kernel:
    s_cmp_ge_u32 s2, 256
    s_cbranch_scc1 L_end
    s_load_dwordx16 s[64:79], s[0:1], 0
    s_load_dwordx4 s[80:83], s[0:1], 64
    s_load_dwordx2 s[84:85], s[0:1], 80
    s_getpc_b64 s[6:7]
L_pc:
    v_lshrrev_b32 v5, 6, v0
    v_and_b32 v2, 63, v0
    v_readfirstlane_b32 s24, v5
    s_and_b32 s25, s2, 7
    s_lshr_b32 s26, s2, 3
    s_and_b32 s30, s26, 7
    s_lshl_b32 s30, s30, 13
    v_lshlrev_b32 v5, 11, v5
    v_and_b32_e64 v3, 15, v0
    v_lshl_add_u32 v3, v3, 7, v5
    v_add_u32_e64 v3, s30, v3
    v_min_u32 v3, L_end-L_pc, v3
    global_load_dword v4, v3, s[6:7]
    v_lshlrev_b32 v1, 4, v2
    s_cmp_lt_u32 s26, 16
    s_cselect_b32 s30, 1120, 0
    v_mov_b32_e64 v6, s30
    v_mov_b32 v30, 128
    v_lshrrev_b32_e64 v8, 3, v2
    v_mul_u32_u24 v8, 1280, v8
    v_lshrrev_b32 v9, 4, v2
    v_and_b32 v10, 7, v2
    v_xor_b32_e64 v9, v9, v10
    v_lshl_add_u32 v12, v9, 4, v8
    v_xor_b32_e64 v13, 64, v12
    v_add_u32 v14, 18432, v12
    v_add_u32 v15, 27648, v13
    v_add_u32 v13, 9216, v13
    s_and_b32 s30, s24, 1
    s_mul_i32 s30, s30, 320
    s_lshr_b32 s31, s24, 1
    s_mul_i32 s31, s31, 30720
    v_add_u32_e64 v8, s30, v2
    v_mul_u32_u24 v9, 3277, v8
    v_lshrrev_b32 v9, 16, v9
    v_mul_u32_u24 v10, 20, v9
    v_sub_u32 v10, v8, v10
    v_and_b32 v11, 0x38, v9
    v_add_u32_e64 v9, v9, v11
    v_mul_u32_u24 v9, 3840, v9
    v_lshl_add_u32 v9, v10, 4, v9
    v_cmp_lt_u32 vcc, 9, v10
    s_nop 1
    v_cndmask_b32 v10, 0, v6, vcc
    v_add3_u32 v24, v9, v10, s31
    v_add_u32 v8, 64, v8
    v_mul_u32_u24 v9, 3277, v8
    v_lshrrev_b32 v9, 16, v9
    v_mul_u32_u24 v10, 20, v9
    v_sub_u32 v10, v8, v10
    v_and_b32 v11, 0x38, v9
    v_add_u32_e64 v9, v9, v11
    v_mul_u32_u24 v9, 3840, v9
    v_lshl_add_u32 v9, v10, 4, v9
    v_cmp_lt_u32 vcc, 9, v10
    s_nop 1
    v_cndmask_b32 v10, 0, v6, vcc
    v_add3_u32 v25, v9, v10, s31
    v_subrev_u32 v25, 1024, v25
    v_add_u32 v8, 64, v8
    v_mul_u32_u24 v9, 3277, v8
    v_lshrrev_b32 v9, 16, v9
    v_mul_u32_u24 v10, 20, v9
    v_sub_u32 v10, v8, v10
    v_and_b32 v11, 0x38, v9
    v_add_u32_e64 v9, v9, v11
    v_mul_u32_u24 v9, 3840, v9
    v_lshl_add_u32 v9, v10, 4, v9
    v_cmp_lt_u32 vcc, 9, v10
    s_nop 1
    v_cndmask_b32 v10, 0, v6, vcc
    v_add3_u32 v26, v9, v10, s31
    v_subrev_u32 v26, 2048, v26
    v_add_u32 v8, 64, v8
    v_mul_u32_u24 v9, 3277, v8
    v_lshrrev_b32 v9, 16, v9
    v_mul_u32_u24 v10, 20, v9
    v_sub_u32 v10, v8, v10
    v_and_b32 v11, 0x38, v9
    v_add_u32_e64 v9, v9, v11
    v_mul_u32_u24 v9, 3840, v9
    v_lshl_add_u32 v9, v10, 4, v9
    v_cmp_lt_u32 vcc, 9, v10
    s_nop 1
    v_cndmask_b32 v10, 0, v6, vcc
    v_add3_u32 v27, v9, v10, s31
    v_subrev_u32 v27, 3072, v27
    v_add_u32 v8, 64, v8
    v_mul_u32_u24 v9, 3277, v8
    v_lshrrev_b32 v9, 16, v9
    v_mul_u32_u24 v10, 20, v9
    v_sub_u32 v10, v8, v10
    v_and_b32 v11, 0x38, v9
    v_add_u32_e64 v9, v9, v11
    v_mul_u32_u24 v9, 3840, v9
    v_lshl_add_u32 v9, v10, 4, v9
    v_cmp_lt_u32 vcc, 9, v10
    s_nop 1
    v_cndmask_b32 v10, 0, v6, vcc
    v_add3_u32 v28, v9, v10, s31
    s_waitcnt lgkmcnt(0)
    s_mov_b32 s16, s64
    s_mov_b32 s17, s65
    s_mov_b32 s18, 2621440
    s_mov_b32 s19, 0x20000
    s_mov_b32 s20, s66
    s_mov_b32 s21, s67
    s_mov_b32 s22, 2457600
    s_mov_b32 s23, 0x20000
    s_mov_b32 s8, s84
    s_mov_b32 s9, s85
    s_mov_b32 s10, 22740992
    s_mov_b32 s11, 0x20000
    s_cmp_ge_u32 s26, 16
    s_cbranch_scc1 L_notkv
    s_lshr_b32 s30, s26, 2
    s_and_b32 s31, s26, 3
    s_and_b32 s32, s25, 1
    s_lshl_b32 s32, s32, 2
    s_add_u32 s41, s31, s32
    s_lshr_b32 s31, s25, 1
    s_lshl_b32 s31, s31, 2
    s_add_u32 s40, s30, s31
    s_lshl_b32 s30, s40, 2
    s_add_u32 s30, s30, s24
    s_mul_i32 s42, s30, 40960
    s_mul_i32 s43, s41, 160
    s_add_u32 s43, s43, 1280
    s_lshl_b32 s44, s24, 12
    s_lshr_b32 s31, s24, 1
    s_mul_i32 s31, s31, 10272
    s_and_b32 s32, s24, 1
    s_mul_i32 s32, s32, 5120
    s_add_u32 s31, s31, s32
    s_add_u32 s45, s31, 16384
    s_lshr_b32 s32, s25, 1
    s_mul_i32 s46, s32, 655360
    s_and_b32 s32, s25, 1
    s_mul_i32 s47, s32, 640
    s_mov_b32 m0, s44
    s_nop 0
    buffer_load_dwordx4 v12, s[16:19], s42 offen lds
    buffer_load_dwordx4 v13, s[16:19], s42 offen offset:1024 lds
    buffer_load_dwordx4 v14, s[16:19], s42 offen offset:2048 lds
    buffer_load_dwordx4 v15, s[16:19], s42 offen offset:3072 lds
    s_mov_b32 m0, s45
    s_nop 0
    buffer_load_dwordx4 v24, s[20:23], s43 offen lds
    buffer_load_dwordx4 v25, s[20:23], s43 offen offset:1024 lds
    buffer_load_dwordx4 v26, s[20:23], s43 offen offset:2048 lds
    buffer_load_dwordx4 v27, s[20:23], s43 offen offset:3072 lds
    s_add_u32 m0, s45, 4096
    s_add_u32 s42, s42, 128
    buffer_load_dwordx4 v28, s[20:23], s43 offen lds
    s_add_u32 s43, s43, 245760
    s_add_u32 m0, s44, 36896
    s_nop 0
    s_nop 0
    buffer_load_dwordx4 v12, s[16:19], s42 offen lds
    buffer_load_dwordx4 v13, s[16:19], s42 offen offset:1024 lds
    buffer_load_dwordx4 v14, s[16:19], s42 offen offset:2048 lds
    buffer_load_dwordx4 v15, s[16:19], s42 offen offset:3072 lds
    s_add_u32 m0, s45, 36896
    s_nop 0
    s_nop 0
    buffer_load_dwordx4 v24, s[20:23], s43 offen lds
    buffer_load_dwordx4 v25, s[20:23], s43 offen offset:1024 lds
    buffer_load_dwordx4 v26, s[20:23], s43 offen offset:2048 lds
    buffer_load_dwordx4 v27, s[20:23], s43 offen offset:3072 lds
    s_add_u32 m0, s45, 40992
    s_add_u32 s42, s42, 128
    buffer_load_dwordx4 v28, s[20:23], s43 offen lds
    s_add_u32 s43, s43, 245760
    s_and_b32 s30, s26, 3
    s_lshl_b32 s31, s30, 2
    s_add_u32 s31, s31, s24
    s_mul_i32 s54, s31, 51200
    s_lshr_b32 s32, s25, 1
    s_lshl_b32 s32, s32, 4
    s_add_u32 s32, s32, s31
    s_mul_i32 s27, s32, 61440
    s_lshr_b32 s32, s32, 2
    s_mul_i32 s55, s32, 192
    s_lshr_b32 s32, s24, 1
    s_mul_i32 s32, s32, 983040
    s_add_u32 s55, s55, s32
    s_add_u32 s55, s27, 1048576
    s_and_b32 s32, s25, 1
    s_lshl_b32 s32, s32, 4
    s_add_u32 s32, s32, s31
    s_mul_i32 s56, s32, 61440
    s_add_u32 s56, s56, 5242880
    s_mov_b32 s12, s68
    s_mov_b32 s13, s69
    s_mov_b32 s14, 25600
    s_mov_b32 s15, 0x20000
    s_mul_i32 s30, s41, 3200
    s_lshl_b32 s31, s24, 11
    s_add_u32 s30, s30, s31
    s_add_u32 m0, s31, 147584
    s_nop 0
    buffer_load_dwordx4 v1, s[12:15], s30 offen lds
    s_cmp_eq_u32 s24, 3
    s_cbranch_scc1 wp_2
    buffer_load_dwordx4 v1, s[12:15], s30 offen offset:1024 lds
wp_2:
    v_mov_b32 v32, 0
    v_mov_b32 v33, 0
    v_mov_b32 v34, 0
    v_mov_b32_e64 v35, 0
    v_add_u32 v8, 154752, v1
    ds_write_b128 v8, v[32:35]
    v_and_b32 v8, 15, v2
    v_lshrrev_b32 v9, 4, v2
    v_lshrrev_b32 v10, 1, v8
    v_xor_b32 v10, v10, v9
    v_lshlrev_b32_e64 v10, 4, v10
    v_lshl_add_u32 v10, v8, 7, v10
    v_add_u32 v16, s44, v10
    v_xor_b32 v18, 64, v16
    v_add_u32 v17, 73792, v16
    v_add_u32 v19, 73792, v18
    v_and_b32_e64 v10, 1, v9
    v_mul_u32_u24 v10, 10272, v10
    v_lshrrev_b32 v11, 5, v2
    v_lshlrev_b32 v11, 3, v11
    v_bfe_u32 v8, v2, 2, 2
    v_add_u32_e64 v11, v11, v8
    v_mul_u32_u24 v11, 320, v11
    v_add_u32 v10, v10, v11
    v_and_b32 v11, 3, v2
    v_mul_u32_u24 v20, 40, v11
    v_add_u32 v20, v20, v10
    v_lshl_add_u32 v22, v11, 3, v10
    v_add_u32 v22, 160, v22
    v_add_u32 v21, 73792, v20
    v_add_u32 v23, 73792, v22
    v_bfe_u32 v208, v2, 2, 1
    v_mul_u32_u24 v208, 10, v208
    s_mul_i32 s36, s24, 20
    v_add_u32_e64 v208, s36, v208
    v_bfe_u32 v209, v2, 3, 1
    v_lshl_add_u32 v209, v209, 2, v208
    v_and_b32 v210, 3, v2
    v_add_u32 v209, v209, v210
    v_and_b32_e64 v210, 1, v2
    v_add3_u32 v208, v208, v210, 8
    v_and_b32 v210, 10, v2
    v_cmp_eq_u32 vcc, 0, v210
    v_mov_b32 v210, 80
    s_nop 0
    v_cndmask_b32 v208, v210, v208, vcc
    v_and_b32_e64 v210, 0x30, v2
    v_add_u32 v210, 118848, v210
    s_movk_i32 s36, 272
    v_mad_u32_u24 v246, v209, s36, v210
    v_mad_u32_u24 v247, v208, s36, v210
    v_and_b32 v208, 15, v2
    v_mad_u32_u24 v251, v208, s36, v210
    s_lshl_b32 s36, s24, 6
    v_add_u32 v251, s36, v251
    v_lshlrev_b32_e64 v252, 2, v2
    v_add_u32 v252, 140608, v252
    v_mul_u32_u24 v253, 352, v208
    v_lshrrev_b32_e64 v209, 4, v2
    v_mul_u32_u24 v210, 80, v209
    s_mul_i32 s36, s24, 11264
    s_add_u32 s36, s36, 73792
    v_add3_u32 v253, v253, v210, s36
    v_lshrrev_b32_e64 v210, 2, v2
    v_mul_u32_u24 v210, 352, v210
    v_and_b32_e64 v211, 3, v2
    v_lshl_add_u32 v210, v211, 3, v210
    s_mul_i32 s36, s24, 80
    s_add_u32 s36, s36, 73792
    v_add_u32 v248, s36, v210
    v_and_b32 v210, 1, v209
    v_lshlrev_b32 v210, 3, v210
    v_lshrrev_b32 v209, 1, v209
    v_lshl_add_u32 v210, v209, 2, v210
    v_lshl_add_u32 v249, v208, 4, v210
    v_mov_b32 v209, 0xffc8
    v_lshrrev_b32 v209, v208, v209
    v_and_b32 v209, 1, v209
    v_lshl_add_u32 v250, v209, 30, v249
    s_lshl_b32 s36, s41, 2
    s_add_u32 s36, s36, s24
    s_mul_i32 s36, s36, 1920
    s_add_u32 s48, s36, 22020096
    s_lshl_b32 s50, s40, 2
    s_add_u32 s50, s50, s24
    s_lshl_b32 s50, s50, 7
    s_add_u32 s50, s50, 22151168
    s_add_u32 s51, s50, 8192
    v_and_b32 v7, 15, v2
    v_lshlrev_b32 v7, 2, v7
    v_lshrrev_b32 v218, 4, v2
    v_mul_u32_u24 v219, 80, v218
    v_mov_b32 v254, v219
    v_lshlrev_b32 v218, 4, v218
    s_mul_i32 s52, s41, 320
    s_add_u32 s52, s52, 22186496
    s_add_u32 s53, s52, 7680
    v_lshrrev_b32 v8, 4, v2
    v_and_b32_e64 v9, 3, v2
    v_cmp_eq_u32 vcc, v8, v9
    v_mul_u32_u24 v8, 800, v8
    v_bfe_u32 v9, v2, 2, 2
    v_mul_u32_u24 v9, 40, v9
    v_add_u32 v8, v8, v9
    v_add_u32 v8, 147584, v8
    v_mov_b32 v9, 154752
    v_cndmask_b32 v29, v9, v8, vcc
    s_waitcnt vmcnt(10)
    s_waitcnt lgkmcnt(0)
    s_barrier
    ds_read_b128 v[152:155], v16 offset:0
    ds_read_b128 v[156:159], v16 offset:2048
    ds_read_b64_tr_b16 v[112:113], v20 offset:16384
    ds_read_b64_tr_b16 v[114:115], v20 offset:17664
    ds_read_b64_tr_b16 v[116:117], v20 offset:16392
    ds_read_b64_tr_b16 v[118:119], v20 offset:17672
    ds_read_b64_tr_b16 v[120:121], v20 offset:16400
    ds_read_b64_tr_b16 v[122:123], v20 offset:17680
    ds_read_b64_tr_b16 v[124:125], v20 offset:16408
    ds_read_b64_tr_b16 v[126:127], v20 offset:17688
    ds_read_b64_tr_b16 v[128:129], v20 offset:16416
    ds_read_b64_tr_b16 v[130:131], v20 offset:17696
    ds_read_b64_tr_b16 v[132:133], v22 offset:16384
    ds_read_b64_tr_b16 v[134:135], v22 offset:17664
    ds_read_b64_tr_b16 v[136:137], v22 offset:16416
    ds_read_b64_tr_b16 v[138:139], v22 offset:17696
    ds_read_b64_tr_b16 v[140:141], v22 offset:16448
    ds_read_b64_tr_b16 v[142:143], v22 offset:17728
    ds_read_b64_tr_b16 v[144:145], v22 offset:16480
    ds_read_b64_tr_b16 v[146:147], v22 offset:17760
    ds_read_b64_tr_b16 v[148:149], v22 offset:16512
    ds_read_b64_tr_b16 v[150:151], v22 offset:17792
    s_waitcnt lgkmcnt(10)
    v_mfma_f32_16x16x32_bf16 v[32:35], v[112:115], v[152:155], 0
    ds_read_b128 v[160:163], v18 offset:0
    ds_read_b128 v[164:167], v18 offset:2048
    v_mfma_f32_16x16x32_bf16 v[52:55], v[112:115], v[156:159], 0
    ds_read_b64_tr_b16 v[112:113], v20 offset:21504
    ds_read_b64_tr_b16 v[114:115], v20 offset:22784
    v_mfma_f32_16x16x32_bf16 v[36:39], v[116:119], v[152:155], 0
    s_add_u32 m0, s44, 73792
    s_nop 0
    buffer_load_dwordx4 v12, s[16:19], s42 offen lds
    v_mfma_f32_16x16x32_bf16 v[56:59], v[116:119], v[156:159], 0
    ds_read_b64_tr_b16 v[116:117], v20 offset:21512
    ds_read_b64_tr_b16 v[118:119], v20 offset:22792
    v_mfma_f32_16x16x32_bf16 v[40:43], v[120:123], v[152:155], 0
    buffer_load_dwordx4 v13, s[16:19], s42 offen offset:1024 lds
    buffer_load_dwordx4 v14, s[16:19], s42 offen offset:2048 lds
    v_mfma_f32_16x16x32_bf16 v[60:63], v[120:123], v[156:159], 0
    ds_read_b64_tr_b16 v[120:121], v20 offset:21520
    ds_read_b64_tr_b16 v[122:123], v20 offset:22800
    v_mfma_f32_16x16x32_bf16 v[44:47], v[124:127], v[152:155], 0
    buffer_load_dwordx4 v15, s[16:19], s42 offen offset:3072 lds
    s_add_u32 m0, s45, 73792
    v_mfma_f32_16x16x32_bf16 v[64:67], v[124:127], v[156:159], 0
    ds_read_b64_tr_b16 v[124:125], v20 offset:21528
    ds_read_b64_tr_b16 v[126:127], v20 offset:22808
    v_mfma_f32_16x16x32_bf16 v[48:51], v[128:131], v[152:155], 0
    buffer_load_dwordx4 v24, s[20:23], s43 offen lds
    buffer_load_dwordx4 v25, s[20:23], s43 offen offset:1024 lds
    v_mfma_f32_16x16x32_bf16 v[68:71], v[128:131], v[156:159], 0
    s_waitcnt lgkmcnt(10)
    ds_read_b64_tr_b16 v[128:129], v20 offset:21536
    v_mfma_f32_16x16x32_bf16 v[72:75], v[152:155], v[132:135], 0
    ds_read_b64_tr_b16 v[130:131], v20 offset:22816
    buffer_load_dwordx4 v26, s[20:23], s43 offen offset:2048 lds
    v_mfma_f32_16x16x32_bf16 v[92:95], v[156:159], v[132:135], 0
    ds_read_b64_tr_b16 v[132:133], v22 offset:21504
    ds_read_b64_tr_b16 v[134:135], v22 offset:22784
    v_mfma_f32_16x16x32_bf16 v[76:79], v[152:155], v[136:139], 0
    buffer_load_dwordx4 v27, s[20:23], s43 offen offset:3072 lds
    s_add_u32 m0, s45, 77888
    v_mfma_f32_16x16x32_bf16 v[96:99], v[156:159], v[136:139], 0
    ds_read_b64_tr_b16 v[136:137], v22 offset:21536
    ds_read_b64_tr_b16 v[138:139], v22 offset:22816
    v_mfma_f32_16x16x32_bf16 v[80:83], v[152:155], v[140:143], 0
    s_add_u32 s42, s42, 128
    buffer_load_dwordx4 v28, s[20:23], s43 offen lds
    v_mfma_f32_16x16x32_bf16 v[100:103], v[156:159], v[140:143], 0
    ds_read_b64_tr_b16 v[140:141], v22 offset:21568
    ds_read_b64_tr_b16 v[142:143], v22 offset:22848
    v_mfma_f32_16x16x32_bf16 v[84:87], v[152:155], v[144:147], 0
    s_add_u32 s43, s43, 245760
    s_add_u32 m0, s44, 110688
    v_mfma_f32_16x16x32_bf16 v[104:107], v[156:159], v[144:147], 0
    ds_read_b64_tr_b16 v[144:145], v22 offset:21600
    ds_read_b64_tr_b16 v[146:147], v22 offset:22880
    v_mfma_f32_16x16x32_bf16 v[88:91], v[152:155], v[148:151], 0
    buffer_load_dwordx4 v12, s[16:19], s42 offen lds
    buffer_load_dwordx4 v13, s[16:19], s42 offen offset:1024 lds
    v_mfma_f32_16x16x32_bf16 v[108:111], v[156:159], v[148:151], 0
    ds_read_b64_tr_b16 v[148:149], v22 offset:21632
    s_waitcnt lgkmcnt(9)
    v_mfma_f32_16x16x32_bf16 v[32:35], v[112:115], v[160:163], v[32:35]
    ds_read_b64_tr_b16 v[150:151], v22 offset:22912
    buffer_load_dwordx4 v14, s[16:19], s42 offen offset:2048 lds
    v_mfma_f32_16x16x32_bf16 v[52:55], v[112:115], v[164:167], v[52:55]
    buffer_load_dwordx4 v15, s[16:19], s42 offen offset:3072 lds
    s_add_u32 m0, s45, 110688
    v_mfma_f32_16x16x32_bf16 v[36:39], v[116:119], v[160:163], v[36:39]
    buffer_load_dwordx4 v24, s[20:23], s43 offen lds
    buffer_load_dwordx4 v25, s[20:23], s43 offen offset:1024 lds
    v_mfma_f32_16x16x32_bf16 v[56:59], v[116:119], v[164:167], v[56:59]
    buffer_load_dwordx4 v26, s[20:23], s43 offen offset:2048 lds
    buffer_load_dwordx4 v27, s[20:23], s43 offen offset:3072 lds
    v_mfma_f32_16x16x32_bf16 v[40:43], v[120:123], v[160:163], v[40:43]
    s_add_u32 m0, s45, 114784
    s_add_u32 s42, s42, 128
    v_mfma_f32_16x16x32_bf16 v[60:63], v[120:123], v[164:167], v[60:63]
    buffer_load_dwordx4 v28, s[20:23], s43 offen lds
    s_add_u32 s43, s43, 245760
    v_mfma_f32_16x16x32_bf16 v[44:47], v[124:127], v[160:163], v[44:47]
    s_waitcnt vmcnt(19)
    s_waitcnt lgkmcnt(0)
    s_barrier
    v_mfma_f32_16x16x32_bf16 v[64:67], v[124:127], v[164:167], v[64:67]
    ds_read_b128 v[152:155], v16 offset:36896
    ds_read_b128 v[156:159], v16 offset:38944
    v_mfma_f32_16x16x32_bf16 v[48:51], v[128:131], v[160:163], v[48:51]
    ds_read_b64_tr_b16 v[112:113], v20 offset:53280
    ds_read_b64_tr_b16 v[114:115], v20 offset:54560
    v_mfma_f32_16x16x32_bf16 v[68:71], v[128:131], v[164:167], v[68:71]
    ds_read_b64_tr_b16 v[116:117], v20 offset:53288
    v_mfma_f32_16x16x32_bf16 v[72:75], v[160:163], v[132:135], v[72:75]
    ds_read_b64_tr_b16 v[118:119], v20 offset:54568
    ds_read_b64_tr_b16 v[120:121], v20 offset:53296
    v_mfma_f32_16x16x32_bf16 v[92:95], v[164:167], v[132:135], v[92:95]
    ds_read_b64_tr_b16 v[122:123], v20 offset:54576
    ds_read_b64_tr_b16 v[124:125], v20 offset:53304
    v_mfma_f32_16x16x32_bf16 v[76:79], v[160:163], v[136:139], v[76:79]
    ds_read_b64_tr_b16 v[126:127], v20 offset:54584
    ds_read_b64_tr_b16 v[128:129], v20 offset:53312
    v_mfma_f32_16x16x32_bf16 v[96:99], v[164:167], v[136:139], v[96:99]
    ds_read_b64_tr_b16 v[130:131], v20 offset:54592
    ds_read_b64_tr_b16 v[132:133], v22 offset:53280
    v_mfma_f32_16x16x32_bf16 v[80:83], v[160:163], v[140:143], v[80:83]
    ds_read_b64_tr_b16 v[134:135], v22 offset:54560
    ds_read_b64_tr_b16 v[136:137], v22 offset:53312
    v_mfma_f32_16x16x32_bf16 v[100:103], v[164:167], v[140:143], v[100:103]
    ds_read_b64_tr_b16 v[138:139], v22 offset:54592
    ds_read_b64_tr_b16 v[140:141], v22 offset:53344
    v_mfma_f32_16x16x32_bf16 v[84:87], v[160:163], v[144:147], v[84:87]
    ds_read_b64_tr_b16 v[142:143], v22 offset:54624
    s_mov_b32 m0, s44
    v_mfma_f32_16x16x32_bf16 v[104:107], v[164:167], v[144:147], v[104:107]
    ds_read_b64_tr_b16 v[144:145], v22 offset:53376
    ds_read_b64_tr_b16 v[146:147], v22 offset:54656
    v_mfma_f32_16x16x32_bf16 v[88:91], v[160:163], v[148:151], v[88:91]
    buffer_load_dwordx4 v12, s[16:19], s42 offen lds
    buffer_load_dwordx4 v13, s[16:19], s42 offen offset:1024 lds
    v_mfma_f32_16x16x32_bf16 v[108:111], v[164:167], v[148:151], v[108:111]
    ds_read_b64_tr_b16 v[148:149], v22 offset:53408
    s_waitcnt lgkmcnt(9)
    v_mfma_f32_16x16x32_bf16 v[32:35], v[112:115], v[152:155], v[32:35]
    ds_read_b64_tr_b16 v[150:151], v22 offset:54688
    ds_read_b128 v[160:163], v18 offset:36896
    v_mfma_f32_16x16x32_bf16 v[52:55], v[112:115], v[156:159], v[52:55]
    ds_read_b128 v[164:167], v18 offset:38944
    ds_read_b64_tr_b16 v[112:113], v20 offset:58400
    v_mfma_f32_16x16x32_bf16 v[36:39], v[116:119], v[152:155], v[36:39]
    ds_read_b64_tr_b16 v[114:115], v20 offset:59680
    buffer_load_dwordx4 v14, s[16:19], s42 offen offset:2048 lds
    v_mfma_f32_16x16x32_bf16 v[56:59], v[116:119], v[156:159], v[56:59]
    ds_read_b64_tr_b16 v[116:117], v20 offset:58408
    ds_read_b64_tr_b16 v[118:119], v20 offset:59688
    v_mfma_f32_16x16x32_bf16 v[40:43], v[120:123], v[152:155], v[40:43]
    buffer_load_dwordx4 v15, s[16:19], s42 offen offset:3072 lds
    s_mov_b32 m0, s45
    v_mfma_f32_16x16x32_bf16 v[60:63], v[120:123], v[156:159], v[60:63]
    ds_read_b64_tr_b16 v[120:121], v20 offset:58416
    ds_read_b64_tr_b16 v[122:123], v20 offset:59696
    v_mfma_f32_16x16x32_bf16 v[44:47], v[124:127], v[152:155], v[44:47]
    buffer_load_dwordx4 v24, s[20:23], s43 offen lds
    buffer_load_dwordx4 v25, s[20:23], s43 offen offset:1024 lds
    v_mfma_f32_16x16x32_bf16 v[64:67], v[124:127], v[156:159], v[64:67]
    ds_read_b64_tr_b16 v[124:125], v20 offset:58424
    ds_read_b64_tr_b16 v[126:127], v20 offset:59704
    v_mfma_f32_16x16x32_bf16 v[48:51], v[128:131], v[152:155], v[48:51]
    buffer_load_dwordx4 v26, s[20:23], s43 offen offset:2048 lds
    buffer_load_dwordx4 v27, s[20:23], s43 offen offset:3072 lds
    v_mfma_f32_16x16x32_bf16 v[68:71], v[128:131], v[156:159], v[68:71]
    s_waitcnt lgkmcnt(10)
    ds_read_b64_tr_b16 v[128:129], v20 offset:58432
    v_mfma_f32_16x16x32_bf16 v[72:75], v[152:155], v[132:135], v[72:75]
    ds_read_b64_tr_b16 v[130:131], v20 offset:59712
    s_add_u32 m0, s45, 4096
    v_mfma_f32_16x16x32_bf16 v[92:95], v[156:159], v[132:135], v[92:95]
    ds_read_b64_tr_b16 v[132:133], v22 offset:58400
    ds_read_b64_tr_b16 v[134:135], v22 offset:59680
    v_mfma_f32_16x16x32_bf16 v[76:79], v[152:155], v[136:139], v[76:79]
    s_add_u32 s42, s42, 128
    buffer_load_dwordx4 v28, s[20:23], s43 offen lds
    v_mfma_f32_16x16x32_bf16 v[96:99], v[156:159], v[136:139], v[96:99]
    ds_read_b64_tr_b16 v[136:137], v22 offset:58432
    ds_read_b64_tr_b16 v[138:139], v22 offset:59712
    v_mfma_f32_16x16x32_bf16 v[80:83], v[152:155], v[140:143], v[80:83]
    s_add_u32 s43, s43, 245760
    v_mfma_f32_16x16x32_bf16 v[100:103], v[156:159], v[140:143], v[100:103]
    ds_read_b64_tr_b16 v[140:141], v22 offset:58464
    ds_read_b64_tr_b16 v[142:143], v22 offset:59744
    v_mfma_f32_16x16x32_bf16 v[84:87], v[152:155], v[144:147], v[84:87]
    v_mfma_f32_16x16x32_bf16 v[104:107], v[156:159], v[144:147], v[104:107]
    ds_read_b64_tr_b16 v[144:145], v22 offset:58496
    ds_read_b64_tr_b16 v[146:147], v22 offset:59776
    v_mfma_f32_16x16x32_bf16 v[88:91], v[152:155], v[148:151], v[88:91]
    v_mfma_f32_16x16x32_bf16 v[108:111], v[156:159], v[148:151], v[108:111]
    ds_read_b64_tr_b16 v[148:149], v22 offset:58528
    s_waitcnt lgkmcnt(9)
    v_mfma_f32_16x16x32_bf16 v[32:35], v[112:115], v[160:163], v[32:35]
    ds_read_b64_tr_b16 v[150:151], v22 offset:59808
    v_mfma_f32_16x16x32_bf16 v[52:55], v[112:115], v[164:167], v[52:55]
    v_mfma_f32_16x16x32_bf16 v[36:39], v[116:119], v[160:163], v[36:39]
    v_mfma_f32_16x16x32_bf16 v[56:59], v[116:119], v[164:167], v[56:59]
    v_mfma_f32_16x16x32_bf16 v[40:43], v[120:123], v[160:163], v[40:43]
    v_mfma_f32_16x16x32_bf16 v[60:63], v[120:123], v[164:167], v[60:63]
    v_mfma_f32_16x16x32_bf16 v[44:47], v[124:127], v[160:163], v[44:47]
    s_waitcnt vmcnt(18)
    s_waitcnt lgkmcnt(0)
    s_barrier
    v_mfma_f32_16x16x32_bf16 v[64:67], v[124:127], v[164:167], v[64:67]
    ds_read_b128 v[152:155], v17 offset:0
    ds_read_b128 v[156:159], v17 offset:2048
    v_mfma_f32_16x16x32_bf16 v[48:51], v[128:131], v[160:163], v[48:51]
    ds_read_b64_tr_b16 v[112:113], v21 offset:16384
    ds_read_b64_tr_b16 v[114:115], v21 offset:17664
    v_mfma_f32_16x16x32_bf16 v[68:71], v[128:131], v[164:167], v[68:71]
    ds_read_b64_tr_b16 v[116:117], v21 offset:16392
    v_mfma_f32_16x16x32_bf16 v[72:75], v[160:163], v[132:135], v[72:75]
    ds_read_b64_tr_b16 v[118:119], v21 offset:17672
    ds_read_b64_tr_b16 v[120:121], v21 offset:16400
    v_mfma_f32_16x16x32_bf16 v[92:95], v[164:167], v[132:135], v[92:95]
    ds_read_b64_tr_b16 v[122:123], v21 offset:17680
    ds_read_b64_tr_b16 v[124:125], v21 offset:16408
    v_mfma_f32_16x16x32_bf16 v[76:79], v[160:163], v[136:139], v[76:79]
    ds_read_b64_tr_b16 v[126:127], v21 offset:17688
    ds_read_b64_tr_b16 v[128:129], v21 offset:16416
    v_mfma_f32_16x16x32_bf16 v[96:99], v[164:167], v[136:139], v[96:99]
    ds_read_b64_tr_b16 v[130:131], v21 offset:17696
    ds_read_b64_tr_b16 v[132:133], v23 offset:16384
    v_mfma_f32_16x16x32_bf16 v[80:83], v[160:163], v[140:143], v[80:83]
    ds_read_b64_tr_b16 v[134:135], v23 offset:17664
    ds_read_b64_tr_b16 v[136:137], v23 offset:16416
    v_mfma_f32_16x16x32_bf16 v[100:103], v[164:167], v[140:143], v[100:103]
    ds_read_b64_tr_b16 v[138:139], v23 offset:17696
    ds_read_b64_tr_b16 v[140:141], v23 offset:16448
    v_mfma_f32_16x16x32_bf16 v[84:87], v[160:163], v[144:147], v[84:87]
    ds_read_b64_tr_b16 v[142:143], v23 offset:17728
    s_add_u32 m0, s44, 36896
    v_mfma_f32_16x16x32_bf16 v[104:107], v[164:167], v[144:147], v[104:107]
    ds_read_b64_tr_b16 v[144:145], v23 offset:16480
    ds_read_b64_tr_b16 v[146:147], v23 offset:17760
    v_mfma_f32_16x16x32_bf16 v[88:91], v[160:163], v[148:151], v[88:91]
    buffer_load_dwordx4 v12, s[16:19], s42 offen lds
    buffer_load_dwordx4 v13, s[16:19], s42 offen offset:1024 lds
    v_mfma_f32_16x16x32_bf16 v[108:111], v[164:167], v[148:151], v[108:111]
    ds_read_b64_tr_b16 v[148:149], v23 offset:16512
    s_waitcnt lgkmcnt(9)
    v_mfma_f32_16x16x32_bf16 v[32:35], v[112:115], v[152:155], v[32:35]
    ds_read_b64_tr_b16 v[150:151], v23 offset:17792
    ds_read_b128 v[160:163], v19 offset:0
    v_mfma_f32_16x16x32_bf16 v[52:55], v[112:115], v[156:159], v[52:55]
    ds_read_b128 v[164:167], v19 offset:2048
    ds_read_b64_tr_b16 v[112:113], v21 offset:21504
    v_mfma_f32_16x16x32_bf16 v[36:39], v[116:119], v[152:155], v[36:39]
    ds_read_b64_tr_b16 v[114:115], v21 offset:22784
    buffer_load_dwordx4 v14, s[16:19], s42 offen offset:2048 lds
    v_mfma_f32_16x16x32_bf16 v[56:59], v[116:119], v[156:159], v[56:59]
    ds_read_b64_tr_b16 v[116:117], v21 offset:21512
    ds_read_b64_tr_b16 v[118:119], v21 offset:22792
    v_mfma_f32_16x16x32_bf16 v[40:43], v[120:123], v[152:155], v[40:43]
    buffer_load_dwordx4 v15, s[16:19], s42 offen offset:3072 lds
    s_add_u32 m0, s45, 36896
    v_mfma_f32_16x16x32_bf16 v[60:63], v[120:123], v[156:159], v[60:63]
    ds_read_b64_tr_b16 v[120:121], v21 offset:21520
    ds_read_b64_tr_b16 v[122:123], v21 offset:22800
    v_mfma_f32_16x16x32_bf16 v[44:47], v[124:127], v[152:155], v[44:47]
    buffer_load_dwordx4 v24, s[20:23], s43 offen lds
    buffer_load_dwordx4 v25, s[20:23], s43 offen offset:1024 lds
    v_mfma_f32_16x16x32_bf16 v[64:67], v[124:127], v[156:159], v[64:67]
    ds_read_b64_tr_b16 v[124:125], v21 offset:21528
    ds_read_b64_tr_b16 v[126:127], v21 offset:22808
    v_mfma_f32_16x16x32_bf16 v[48:51], v[128:131], v[152:155], v[48:51]
    buffer_load_dwordx4 v26, s[20:23], s43 offen offset:2048 lds
    buffer_load_dwordx4 v27, s[20:23], s43 offen offset:3072 lds
    v_mfma_f32_16x16x32_bf16 v[68:71], v[128:131], v[156:159], v[68:71]
    s_waitcnt lgkmcnt(10)
    ds_read_b64_tr_b16 v[128:129], v21 offset:21536
    v_mfma_f32_16x16x32_bf16 v[72:75], v[152:155], v[132:135], v[72:75]
    ds_read_b64_tr_b16 v[130:131], v21 offset:22816
    s_add_u32 m0, s45, 40992
    v_mfma_f32_16x16x32_bf16 v[92:95], v[156:159], v[132:135], v[92:95]
    ds_read_b64_tr_b16 v[132:133], v23 offset:21504
    ds_read_b64_tr_b16 v[134:135], v23 offset:22784
    v_mfma_f32_16x16x32_bf16 v[76:79], v[152:155], v[136:139], v[76:79]
    s_add_u32 s42, s42, 128
    buffer_load_dwordx4 v28, s[20:23], s43 offen lds
    v_mfma_f32_16x16x32_bf16 v[96:99], v[156:159], v[136:139], v[96:99]
    ds_read_b64_tr_b16 v[136:137], v23 offset:21536
    ds_read_b64_tr_b16 v[138:139], v23 offset:22816
    v_mfma_f32_16x16x32_bf16 v[80:83], v[152:155], v[140:143], v[80:83]
    s_add_u32 s43, s43, 245760
    v_mfma_f32_16x16x32_bf16 v[100:103], v[156:159], v[140:143], v[100:103]
    ds_read_b64_tr_b16 v[140:141], v23 offset:21568
    ds_read_b64_tr_b16 v[142:143], v23 offset:22848
    v_mfma_f32_16x16x32_bf16 v[84:87], v[152:155], v[144:147], v[84:87]
    v_mfma_f32_16x16x32_bf16 v[104:107], v[156:159], v[144:147], v[104:107]
    ds_read_b64_tr_b16 v[144:145], v23 offset:21600
    ds_read_b64_tr_b16 v[146:147], v23 offset:22880
    v_mfma_f32_16x16x32_bf16 v[88:91], v[152:155], v[148:151], v[88:91]
    v_mfma_f32_16x16x32_bf16 v[108:111], v[156:159], v[148:151], v[108:111]
    ds_read_b64_tr_b16 v[148:149], v23 offset:21632
    s_waitcnt lgkmcnt(9)
    v_mfma_f32_16x16x32_bf16 v[32:35], v[112:115], v[160:163], v[32:35]
    ds_read_b64_tr_b16 v[150:151], v23 offset:22912
    v_mfma_f32_16x16x32_bf16 v[52:55], v[112:115], v[164:167], v[52:55]
    v_mfma_f32_16x16x32_bf16 v[36:39], v[116:119], v[160:163], v[36:39]
    v_mfma_f32_16x16x32_bf16 v[56:59], v[116:119], v[164:167], v[56:59]
    v_mfma_f32_16x16x32_bf16 v[40:43], v[120:123], v[160:163], v[40:43]
    v_mfma_f32_16x16x32_bf16 v[60:63], v[120:123], v[164:167], v[60:63]
    v_mfma_f32_16x16x32_bf16 v[44:47], v[124:127], v[160:163], v[44:47]
    s_waitcnt vmcnt(18)
    s_waitcnt lgkmcnt(0)
    s_barrier
    v_mfma_f32_16x16x32_bf16 v[64:67], v[124:127], v[164:167], v[64:67]
    ds_read_b128 v[152:155], v17 offset:36896
    ds_read_b128 v[156:159], v17 offset:38944
    v_mfma_f32_16x16x32_bf16 v[48:51], v[128:131], v[160:163], v[48:51]
    ds_read_b64_tr_b16 v[112:113], v21 offset:53280
    ds_read_b64_tr_b16 v[114:115], v21 offset:54560
    v_mfma_f32_16x16x32_bf16 v[68:71], v[128:131], v[164:167], v[68:71]
    ds_read_b64_tr_b16 v[116:117], v21 offset:53288
    v_mfma_f32_16x16x32_bf16 v[72:75], v[160:163], v[132:135], v[72:75]
    ds_read_b64_tr_b16 v[118:119], v21 offset:54568
    ds_read_b64_tr_b16 v[120:121], v21 offset:53296
    v_mfma_f32_16x16x32_bf16 v[92:95], v[164:167], v[132:135], v[92:95]
    ds_read_b64_tr_b16 v[122:123], v21 offset:54576
    ds_read_b64_tr_b16 v[124:125], v21 offset:53304
    v_mfma_f32_16x16x32_bf16 v[76:79], v[160:163], v[136:139], v[76:79]
    ds_read_b64_tr_b16 v[126:127], v21 offset:54584
    ds_read_b64_tr_b16 v[128:129], v21 offset:53312
    v_mfma_f32_16x16x32_bf16 v[96:99], v[164:167], v[136:139], v[96:99]
    ds_read_b64_tr_b16 v[130:131], v21 offset:54592
    ds_read_b64_tr_b16 v[132:133], v23 offset:53280
    v_mfma_f32_16x16x32_bf16 v[80:83], v[160:163], v[140:143], v[80:83]
    ds_read_b64_tr_b16 v[134:135], v23 offset:54560
    ds_read_b64_tr_b16 v[136:137], v23 offset:53312
    v_mfma_f32_16x16x32_bf16 v[100:103], v[164:167], v[140:143], v[100:103]
    ds_read_b64_tr_b16 v[138:139], v23 offset:54592
    ds_read_b64_tr_b16 v[140:141], v23 offset:53344
    v_mfma_f32_16x16x32_bf16 v[84:87], v[160:163], v[144:147], v[84:87]
    ds_read_b64_tr_b16 v[142:143], v23 offset:54624
    s_add_u32 m0, s44, 73792
    v_mfma_f32_16x16x32_bf16 v[104:107], v[164:167], v[144:147], v[104:107]
    ds_read_b64_tr_b16 v[144:145], v23 offset:53376
    ds_read_b64_tr_b16 v[146:147], v23 offset:54656
    v_mfma_f32_16x16x32_bf16 v[88:91], v[160:163], v[148:151], v[88:91]
    buffer_load_dwordx4 v12, s[16:19], s42 offen lds
    buffer_load_dwordx4 v13, s[16:19], s42 offen offset:1024 lds
    v_mfma_f32_16x16x32_bf16 v[108:111], v[164:167], v[148:151], v[108:111]
    ds_read_b64_tr_b16 v[148:149], v23 offset:53408
    s_waitcnt lgkmcnt(9)
    v_mfma_f32_16x16x32_bf16 v[32:35], v[112:115], v[152:155], v[32:35]
    ds_read_b64_tr_b16 v[150:151], v23 offset:54688
    ds_read_b128 v[160:163], v19 offset:36896
    v_mfma_f32_16x16x32_bf16 v[52:55], v[112:115], v[156:159], v[52:55]
    ds_read_b128 v[164:167], v19 offset:38944
    ds_read_b64_tr_b16 v[112:113], v21 offset:58400
    v_mfma_f32_16x16x32_bf16 v[36:39], v[116:119], v[152:155], v[36:39]
    ds_read_b64_tr_b16 v[114:115], v21 offset:59680
    buffer_load_dwordx4 v14, s[16:19], s42 offen offset:2048 lds
    v_mfma_f32_16x16x32_bf16 v[56:59], v[116:119], v[156:159], v[56:59]
    ds_read_b64_tr_b16 v[116:117], v21 offset:58408
    ds_read_b64_tr_b16 v[118:119], v21 offset:59688
    v_mfma_f32_16x16x32_bf16 v[40:43], v[120:123], v[152:155], v[40:43]
    buffer_load_dwordx4 v15, s[16:19], s42 offen offset:3072 lds
    s_add_u32 m0, s45, 73792
    v_mfma_f32_16x16x32_bf16 v[60:63], v[120:123], v[156:159], v[60:63]
    ds_read_b64_tr_b16 v[120:121], v21 offset:58416
    ds_read_b64_tr_b16 v[122:123], v21 offset:59696
    v_mfma_f32_16x16x32_bf16 v[44:47], v[124:127], v[152:155], v[44:47]
    buffer_load_dwordx4 v24, s[20:23], s43 offen lds
    buffer_load_dwordx4 v25, s[20:23], s43 offen offset:1024 lds
    v_mfma_f32_16x16x32_bf16 v[64:67], v[124:127], v[156:159], v[64:67]
    ds_read_b64_tr_b16 v[124:125], v21 offset:58424
    ds_read_b64_tr_b16 v[126:127], v21 offset:59704
    v_mfma_f32_16x16x32_bf16 v[48:51], v[128:131], v[152:155], v[48:51]
    buffer_load_dwordx4 v26, s[20:23], s43 offen offset:2048 lds
    buffer_load_dwordx4 v27, s[20:23], s43 offen offset:3072 lds
    v_mfma_f32_16x16x32_bf16 v[68:71], v[128:131], v[156:159], v[68:71]
    s_waitcnt lgkmcnt(10)
    ds_read_b64_tr_b16 v[128:129], v21 offset:58432
    v_mfma_f32_16x16x32_bf16 v[72:75], v[152:155], v[132:135], v[72:75]
    ds_read_b64_tr_b16 v[130:131], v21 offset:59712
    s_add_u32 m0, s45, 77888
    v_mfma_f32_16x16x32_bf16 v[92:95], v[156:159], v[132:135], v[92:95]
    ds_read_b64_tr_b16 v[132:133], v23 offset:58400
    ds_read_b64_tr_b16 v[134:135], v23 offset:59680
    v_mfma_f32_16x16x32_bf16 v[76:79], v[152:155], v[136:139], v[76:79]
    s_add_u32 s42, s42, 128
    buffer_load_dwordx4 v28, s[20:23], s43 offen lds
    v_mfma_f32_16x16x32_bf16 v[96:99], v[156:159], v[136:139], v[96:99]
    ds_read_b64_tr_b16 v[136:137], v23 offset:58432
    ds_read_b64_tr_b16 v[138:139], v23 offset:59712
    v_mfma_f32_16x16x32_bf16 v[80:83], v[152:155], v[140:143], v[80:83]
    s_add_u32 s43, s43, 245760
    v_mfma_f32_16x16x32_bf16 v[100:103], v[156:159], v[140:143], v[100:103]
    ds_read_b64_tr_b16 v[140:141], v23 offset:58464
    ds_read_b64_tr_b16 v[142:143], v23 offset:59744
    v_mfma_f32_16x16x32_bf16 v[84:87], v[152:155], v[144:147], v[84:87]
    v_mfma_f32_16x16x32_bf16 v[104:107], v[156:159], v[144:147], v[104:107]
    ds_read_b64_tr_b16 v[144:145], v23 offset:58496
    ds_read_b64_tr_b16 v[146:147], v23 offset:59776
    v_mfma_f32_16x16x32_bf16 v[88:91], v[152:155], v[148:151], v[88:91]
    v_mfma_f32_16x16x32_bf16 v[108:111], v[156:159], v[148:151], v[108:111]
    ds_read_b64_tr_b16 v[148:149], v23 offset:58528
    s_waitcnt lgkmcnt(9)
    v_mfma_f32_16x16x32_bf16 v[32:35], v[112:115], v[160:163], v[32:35]
    ds_read_b64_tr_b16 v[150:151], v23 offset:59808
    v_mfma_f32_16x16x32_bf16 v[52:55], v[112:115], v[164:167], v[52:55]
    v_mfma_f32_16x16x32_bf16 v[36:39], v[116:119], v[160:163], v[36:39]
    v_mfma_f32_16x16x32_bf16 v[56:59], v[116:119], v[164:167], v[56:59]
    v_mfma_f32_16x16x32_bf16 v[40:43], v[120:123], v[160:163], v[40:43]
    v_mfma_f32_16x16x32_bf16 v[60:63], v[120:123], v[164:167], v[60:63]
    v_mfma_f32_16x16x32_bf16 v[44:47], v[124:127], v[160:163], v[44:47]
    s_waitcnt vmcnt(18)
    s_waitcnt lgkmcnt(0)
    s_barrier
    v_mfma_f32_16x16x32_bf16 v[64:67], v[124:127], v[164:167], v[64:67]
    ds_read_b128 v[152:155], v16 offset:0
    ds_read_b128 v[156:159], v16 offset:2048
    v_mfma_f32_16x16x32_bf16 v[48:51], v[128:131], v[160:163], v[48:51]
    ds_read_b64_tr_b16 v[112:113], v20 offset:16384
    ds_read_b64_tr_b16 v[114:115], v20 offset:17664
    v_mfma_f32_16x16x32_bf16 v[68:71], v[128:131], v[164:167], v[68:71]
    ds_read_b64_tr_b16 v[116:117], v20 offset:16392
    v_mfma_f32_16x16x32_bf16 v[72:75], v[160:163], v[132:135], v[72:75]
    ds_read_b64_tr_b16 v[118:119], v20 offset:17672
    ds_read_b64_tr_b16 v[120:121], v20 offset:16400
    v_mfma_f32_16x16x32_bf16 v[92:95], v[164:167], v[132:135], v[92:95]
    ds_read_b64_tr_b16 v[122:123], v20 offset:17680
    ds_read_b64_tr_b16 v[124:125], v20 offset:16408
    v_mfma_f32_16x16x32_bf16 v[76:79], v[160:163], v[136:139], v[76:79]
    ds_read_b64_tr_b16 v[126:127], v20 offset:17688
    ds_read_b64_tr_b16 v[128:129], v20 offset:16416
    v_mfma_f32_16x16x32_bf16 v[96:99], v[164:167], v[136:139], v[96:99]
    ds_read_b64_tr_b16 v[130:131], v20 offset:17696
    ds_read_b64_tr_b16 v[132:133], v22 offset:16384
    v_mfma_f32_16x16x32_bf16 v[80:83], v[160:163], v[140:143], v[80:83]
    ds_read_b64_tr_b16 v[134:135], v22 offset:17664
    ds_read_b64_tr_b16 v[136:137], v22 offset:16416
    v_mfma_f32_16x16x32_bf16 v[100:103], v[164:167], v[140:143], v[100:103]
    ds_read_b64_tr_b16 v[138:139], v22 offset:17696
    ds_read_b64_tr_b16 v[140:141], v22 offset:16448
    v_mfma_f32_16x16x32_bf16 v[84:87], v[160:163], v[144:147], v[84:87]
    ds_read_b64_tr_b16 v[142:143], v22 offset:17728
    s_add_u32 m0, s44, 110688
    v_mfma_f32_16x16x32_bf16 v[104:107], v[164:167], v[144:147], v[104:107]
    ds_read_b64_tr_b16 v[144:145], v22 offset:16480
    ds_read_b64_tr_b16 v[146:147], v22 offset:17760
    v_mfma_f32_16x16x32_bf16 v[88:91], v[160:163], v[148:151], v[88:91]
    buffer_load_dwordx4 v12, s[16:19], s42 offen lds
    buffer_load_dwordx4 v13, s[16:19], s42 offen offset:1024 lds
    v_mfma_f32_16x16x32_bf16 v[108:111], v[164:167], v[148:151], v[108:111]
    ds_read_b64_tr_b16 v[148:149], v22 offset:16512
    s_waitcnt lgkmcnt(9)
    v_mfma_f32_16x16x32_bf16 v[32:35], v[112:115], v[152:155], v[32:35]
    ds_read_b64_tr_b16 v[150:151], v22 offset:17792
    ds_read_b128 v[160:163], v18 offset:0
    v_mfma_f32_16x16x32_bf16 v[52:55], v[112:115], v[156:159], v[52:55]
    ds_read_b128 v[164:167], v18 offset:2048
    ds_read_b64_tr_b16 v[112:113], v20 offset:21504
    v_mfma_f32_16x16x32_bf16 v[36:39], v[116:119], v[152:155], v[36:39]
    ds_read_b64_tr_b16 v[114:115], v20 offset:22784
    buffer_load_dwordx4 v14, s[16:19], s42 offen offset:2048 lds
    v_mfma_f32_16x16x32_bf16 v[56:59], v[116:119], v[156:159], v[56:59]
    ds_read_b64_tr_b16 v[116:117], v20 offset:21512
    ds_read_b64_tr_b16 v[118:119], v20 offset:22792
    v_mfma_f32_16x16x32_bf16 v[40:43], v[120:123], v[152:155], v[40:43]
    buffer_load_dwordx4 v15, s[16:19], s42 offen offset:3072 lds
    s_add_u32 m0, s45, 110688
    v_mfma_f32_16x16x32_bf16 v[60:63], v[120:123], v[156:159], v[60:63]
    ds_read_b64_tr_b16 v[120:121], v20 offset:21520
    ds_read_b64_tr_b16 v[122:123], v20 offset:22800
    v_mfma_f32_16x16x32_bf16 v[44:47], v[124:127], v[152:155], v[44:47]
    buffer_load_dwordx4 v24, s[20:23], s43 offen lds
    buffer_load_dwordx4 v25, s[20:23], s43 offen offset:1024 lds
    v_mfma_f32_16x16x32_bf16 v[64:67], v[124:127], v[156:159], v[64:67]
    ds_read_b64_tr_b16 v[124:125], v20 offset:21528
    ds_read_b64_tr_b16 v[126:127], v20 offset:22808
    v_mfma_f32_16x16x32_bf16 v[48:51], v[128:131], v[152:155], v[48:51]
    buffer_load_dwordx4 v26, s[20:23], s43 offen offset:2048 lds
    buffer_load_dwordx4 v27, s[20:23], s43 offen offset:3072 lds
    v_mfma_f32_16x16x32_bf16 v[68:71], v[128:131], v[156:159], v[68:71]
    s_waitcnt lgkmcnt(10)
    ds_read_b64_tr_b16 v[128:129], v20 offset:21536
    v_mfma_f32_16x16x32_bf16 v[72:75], v[152:155], v[132:135], v[72:75]
    ds_read_b64_tr_b16 v[130:131], v20 offset:22816
    s_add_u32 m0, s45, 114784
    v_mfma_f32_16x16x32_bf16 v[92:95], v[156:159], v[132:135], v[92:95]
    ds_read_b64_tr_b16 v[132:133], v22 offset:21504
    ds_read_b64_tr_b16 v[134:135], v22 offset:22784
    v_mfma_f32_16x16x32_bf16 v[76:79], v[152:155], v[136:139], v[76:79]
    s_add_u32 s42, s42, 128
    buffer_load_dwordx4 v28, s[20:23], s43 offen lds
    v_mfma_f32_16x16x32_bf16 v[96:99], v[156:159], v[136:139], v[96:99]
    ds_read_b64_tr_b16 v[136:137], v22 offset:21536
    ds_read_b64_tr_b16 v[138:139], v22 offset:22816
    v_mfma_f32_16x16x32_bf16 v[80:83], v[152:155], v[140:143], v[80:83]
    s_add_u32 s43, s43, 245760
    v_mfma_f32_16x16x32_bf16 v[100:103], v[156:159], v[140:143], v[100:103]
    ds_read_b64_tr_b16 v[140:141], v22 offset:21568
    ds_read_b64_tr_b16 v[142:143], v22 offset:22848
    v_mfma_f32_16x16x32_bf16 v[84:87], v[152:155], v[144:147], v[84:87]
    v_mfma_f32_16x16x32_bf16 v[104:107], v[156:159], v[144:147], v[104:107]
    ds_read_b64_tr_b16 v[144:145], v22 offset:21600
    ds_read_b64_tr_b16 v[146:147], v22 offset:22880
    v_mfma_f32_16x16x32_bf16 v[88:91], v[152:155], v[148:151], v[88:91]
    v_mfma_f32_16x16x32_bf16 v[108:111], v[156:159], v[148:151], v[108:111]
    ds_read_b64_tr_b16 v[148:149], v22 offset:21632
    s_waitcnt lgkmcnt(9)
    v_mfma_f32_16x16x32_bf16 v[32:35], v[112:115], v[160:163], v[32:35]
    ds_read_b64_tr_b16 v[150:151], v22 offset:22912
    v_mfma_f32_16x16x32_bf16 v[52:55], v[112:115], v[164:167], v[52:55]
    v_mfma_f32_16x16x32_bf16 v[36:39], v[116:119], v[160:163], v[36:39]
    v_mfma_f32_16x16x32_bf16 v[56:59], v[116:119], v[164:167], v[56:59]
    v_mfma_f32_16x16x32_bf16 v[40:43], v[120:123], v[160:163], v[40:43]
    v_mfma_f32_16x16x32_bf16 v[60:63], v[120:123], v[164:167], v[60:63]
    v_mfma_f32_16x16x32_bf16 v[44:47], v[124:127], v[160:163], v[44:47]
    s_waitcnt vmcnt(18)
    s_waitcnt lgkmcnt(0)
    s_barrier
    v_mfma_f32_16x16x32_bf16 v[64:67], v[124:127], v[164:167], v[64:67]
    ds_read_b128 v[152:155], v16 offset:36896
    ds_read_b128 v[156:159], v16 offset:38944
    v_mfma_f32_16x16x32_bf16 v[48:51], v[128:131], v[160:163], v[48:51]
    ds_read_b64_tr_b16 v[112:113], v20 offset:53280
    ds_read_b64_tr_b16 v[114:115], v20 offset:54560
    v_mfma_f32_16x16x32_bf16 v[68:71], v[128:131], v[164:167], v[68:71]
    ds_read_b64_tr_b16 v[116:117], v20 offset:53288
    v_mfma_f32_16x16x32_bf16 v[72:75], v[160:163], v[132:135], v[72:75]
    ds_read_b64_tr_b16 v[118:119], v20 offset:54568
    ds_read_b64_tr_b16 v[120:121], v20 offset:53296
    v_mfma_f32_16x16x32_bf16 v[92:95], v[164:167], v[132:135], v[92:95]
    ds_read_b64_tr_b16 v[122:123], v20 offset:54576
    ds_read_b64_tr_b16 v[124:125], v20 offset:53304
    v_mfma_f32_16x16x32_bf16 v[76:79], v[160:163], v[136:139], v[76:79]
    ds_read_b64_tr_b16 v[126:127], v20 offset:54584
    ds_read_b64_tr_b16 v[128:129], v20 offset:53312
    v_mfma_f32_16x16x32_bf16 v[96:99], v[164:167], v[136:139], v[96:99]
    ds_read_b64_tr_b16 v[130:131], v20 offset:54592
    ds_read_b64_tr_b16 v[132:133], v22 offset:53280
    v_mfma_f32_16x16x32_bf16 v[80:83], v[160:163], v[140:143], v[80:83]
    ds_read_b64_tr_b16 v[134:135], v22 offset:54560
    ds_read_b64_tr_b16 v[136:137], v22 offset:53312
    v_mfma_f32_16x16x32_bf16 v[100:103], v[164:167], v[140:143], v[100:103]
    ds_read_b64_tr_b16 v[138:139], v22 offset:54592
    ds_read_b64_tr_b16 v[140:141], v22 offset:53344
    v_mfma_f32_16x16x32_bf16 v[84:87], v[160:163], v[144:147], v[84:87]
    ds_read_b64_tr_b16 v[142:143], v22 offset:54624
    s_mov_b32 m0, s44
    v_mfma_f32_16x16x32_bf16 v[104:107], v[164:167], v[144:147], v[104:107]
    ds_read_b64_tr_b16 v[144:145], v22 offset:53376
    ds_read_b64_tr_b16 v[146:147], v22 offset:54656
    v_mfma_f32_16x16x32_bf16 v[88:91], v[160:163], v[148:151], v[88:91]
    buffer_load_dwordx4 v12, s[16:19], s42 offen lds
    buffer_load_dwordx4 v13, s[16:19], s42 offen offset:1024 lds
    v_mfma_f32_16x16x32_bf16 v[108:111], v[164:167], v[148:151], v[108:111]
    ds_read_b64_tr_b16 v[148:149], v22 offset:53408
    s_waitcnt lgkmcnt(9)
    v_mfma_f32_16x16x32_bf16 v[32:35], v[112:115], v[152:155], v[32:35]
    ds_read_b64_tr_b16 v[150:151], v22 offset:54688
    ds_read_b128 v[160:163], v18 offset:36896
    v_mfma_f32_16x16x32_bf16 v[52:55], v[112:115], v[156:159], v[52:55]
    ds_read_b128 v[164:167], v18 offset:38944
    ds_read_b64_tr_b16 v[112:113], v20 offset:58400
    v_mfma_f32_16x16x32_bf16 v[36:39], v[116:119], v[152:155], v[36:39]
    ds_read_b64_tr_b16 v[114:115], v20 offset:59680
    buffer_load_dwordx4 v14, s[16:19], s42 offen offset:2048 lds
    v_mfma_f32_16x16x32_bf16 v[56:59], v[116:119], v[156:159], v[56:59]
    ds_read_b64_tr_b16 v[116:117], v20 offset:58408
    ds_read_b64_tr_b16 v[118:119], v20 offset:59688
    v_mfma_f32_16x16x32_bf16 v[40:43], v[120:123], v[152:155], v[40:43]
    buffer_load_dwordx4 v15, s[16:19], s42 offen offset:3072 lds
    s_mov_b32 m0, s45
    v_mfma_f32_16x16x32_bf16 v[60:63], v[120:123], v[156:159], v[60:63]
    ds_read_b64_tr_b16 v[120:121], v20 offset:58416
    ds_read_b64_tr_b16 v[122:123], v20 offset:59696
    v_mfma_f32_16x16x32_bf16 v[44:47], v[124:127], v[152:155], v[44:47]
    buffer_load_dwordx4 v24, s[20:23], s43 offen lds
    buffer_load_dwordx4 v25, s[20:23], s43 offen offset:1024 lds
    v_mfma_f32_16x16x32_bf16 v[64:67], v[124:127], v[156:159], v[64:67]
    ds_read_b64_tr_b16 v[124:125], v20 offset:58424
    ds_read_b64_tr_b16 v[126:127], v20 offset:59704
    v_mfma_f32_16x16x32_bf16 v[48:51], v[128:131], v[152:155], v[48:51]
    buffer_load_dwordx4 v26, s[20:23], s43 offen offset:2048 lds
    buffer_load_dwordx4 v27, s[20:23], s43 offen offset:3072 lds
    v_mfma_f32_16x16x32_bf16 v[68:71], v[128:131], v[156:159], v[68:71]
    s_waitcnt lgkmcnt(10)
    ds_read_b64_tr_b16 v[128:129], v20 offset:58432
    v_mfma_f32_16x16x32_bf16 v[72:75], v[152:155], v[132:135], v[72:75]
    ds_read_b64_tr_b16 v[130:131], v20 offset:59712
    s_add_u32 m0, s45, 4096
    v_mfma_f32_16x16x32_bf16 v[92:95], v[156:159], v[132:135], v[92:95]
    ds_read_b64_tr_b16 v[132:133], v22 offset:58400
    ds_read_b64_tr_b16 v[134:135], v22 offset:59680
    v_mfma_f32_16x16x32_bf16 v[76:79], v[152:155], v[136:139], v[76:79]
    s_add_u32 s42, s42, 128
    buffer_load_dwordx4 v28, s[20:23], s43 offen lds
    v_mfma_f32_16x16x32_bf16 v[96:99], v[156:159], v[136:139], v[96:99]
    ds_read_b64_tr_b16 v[136:137], v22 offset:58432
    ds_read_b64_tr_b16 v[138:139], v22 offset:59712
    v_mfma_f32_16x16x32_bf16 v[80:83], v[152:155], v[140:143], v[80:83]
    s_add_u32 s43, s43, 245760
    s_and_b32 s34, s26, 7
    v_mfma_f32_16x16x32_bf16 v[100:103], v[156:159], v[140:143], v[100:103]
    ds_read_b64_tr_b16 v[140:141], v22 offset:58464
    ds_read_b64_tr_b16 v[142:143], v22 offset:59744
    v_mfma_f32_16x16x32_bf16 v[84:87], v[152:155], v[144:147], v[84:87]
    s_lshl_b32 s34, s34, 2
    s_add_u32 s34, s34, s24
    v_mfma_f32_16x16x32_bf16 v[104:107], v[156:159], v[144:147], v[104:107]
    ds_read_b64_tr_b16 v[144:145], v22 offset:58496
    ds_read_b64_tr_b16 v[146:147], v22 offset:59776
    v_mfma_f32_16x16x32_bf16 v[88:91], v[152:155], v[148:151], v[88:91]
    s_mul_i32 s34, s34, 256
    v_min_u32_e64 v168, 1, v2
    v_mfma_f32_16x16x32_bf16 v[108:111], v[156:159], v[148:151], v[108:111]
    ds_read_b64_tr_b16 v[148:149], v22 offset:58528
    s_waitcnt lgkmcnt(9)
    v_mfma_f32_16x16x32_bf16 v[32:35], v[112:115], v[160:163], v[32:35]
    ds_read_b64_tr_b16 v[150:151], v22 offset:59808
    v_lshl_add_u32 v168, v168, 7, s34
    v_mfma_f32_16x16x32_bf16 v[52:55], v[112:115], v[164:167], v[52:55]
    v_min_u32 v168, L_notkv-L_ep_kv, v168
    v_add_u32 v168, L_ep_kv-L_pc, v168
    v_mfma_f32_16x16x32_bf16 v[36:39], v[116:119], v[160:163], v[36:39]
    global_load_dword v5, v168, s[6:7]
    v_mfma_f32_16x16x32_bf16 v[56:59], v[116:119], v[164:167], v[56:59]
    v_mfma_f32_16x16x32_bf16 v[40:43], v[120:123], v[160:163], v[40:43]
    v_mfma_f32_16x16x32_bf16 v[60:63], v[120:123], v[164:167], v[60:63]
    v_mfma_f32_16x16x32_bf16 v[44:47], v[124:127], v[160:163], v[44:47]
    s_waitcnt vmcnt(19)
    s_waitcnt lgkmcnt(0)
    s_barrier
    v_mfma_f32_16x16x32_bf16 v[64:67], v[124:127], v[164:167], v[64:67]
    ds_read_b128 v[152:155], v17 offset:0
    ds_read_b128 v[156:159], v17 offset:2048
    v_mfma_f32_16x16x32_bf16 v[48:51], v[128:131], v[160:163], v[48:51]
    ds_read_b64_tr_b16 v[112:113], v21 offset:16384
    ds_read_b64_tr_b16 v[114:115], v21 offset:17664
    v_mfma_f32_16x16x32_bf16 v[68:71], v[128:131], v[164:167], v[68:71]
    ds_read_b64_tr_b16 v[116:117], v21 offset:16392
    v_mfma_f32_16x16x32_bf16 v[72:75], v[160:163], v[132:135], v[72:75]
    ds_read_b64_tr_b16 v[118:119], v21 offset:17672
    ds_read_b64_tr_b16 v[120:121], v21 offset:16400
    v_mfma_f32_16x16x32_bf16 v[92:95], v[164:167], v[132:135], v[92:95]
    ds_read_b64_tr_b16 v[122:123], v21 offset:17680
    ds_read_b64_tr_b16 v[124:125], v21 offset:16408
    v_mfma_f32_16x16x32_bf16 v[76:79], v[160:163], v[136:139], v[76:79]
    ds_read_b64_tr_b16 v[126:127], v21 offset:17688
    ds_read_b64_tr_b16 v[128:129], v21 offset:16416
    v_mfma_f32_16x16x32_bf16 v[96:99], v[164:167], v[136:139], v[96:99]
    ds_read_b64_tr_b16 v[130:131], v21 offset:17696
    ds_read_b64_tr_b16 v[132:133], v23 offset:16384
    v_mfma_f32_16x16x32_bf16 v[80:83], v[160:163], v[140:143], v[80:83]
    ds_read_b64_tr_b16 v[134:135], v23 offset:17664
    ds_read_b64_tr_b16 v[136:137], v23 offset:16416
    v_mfma_f32_16x16x32_bf16 v[100:103], v[164:167], v[140:143], v[100:103]
    ds_read_b64_tr_b16 v[138:139], v23 offset:17696
    ds_read_b64_tr_b16 v[140:141], v23 offset:16448
    v_mfma_f32_16x16x32_bf16 v[84:87], v[160:163], v[144:147], v[84:87]
    ds_read_b64_tr_b16 v[142:143], v23 offset:17728
    s_add_u32 m0, s44, 36896
    v_mfma_f32_16x16x32_bf16 v[104:107], v[164:167], v[144:147], v[104:107]
    ds_read_b64_tr_b16 v[144:145], v23 offset:16480
    ds_read_b64_tr_b16 v[146:147], v23 offset:17760
    v_mfma_f32_16x16x32_bf16 v[88:91], v[160:163], v[148:151], v[88:91]
    buffer_load_dwordx4 v12, s[16:19], s42 offen lds
    buffer_load_dwordx4 v13, s[16:19], s42 offen offset:1024 lds
    v_mfma_f32_16x16x32_bf16 v[108:111], v[164:167], v[148:151], v[108:111]
    ds_read_b64_tr_b16 v[148:149], v23 offset:16512
    s_waitcnt lgkmcnt(9)
    v_mfma_f32_16x16x32_bf16 v[32:35], v[112:115], v[152:155], v[32:35]
    ds_read_b64_tr_b16 v[150:151], v23 offset:17792
    ds_read_b128 v[160:163], v19 offset:0
    v_mfma_f32_16x16x32_bf16 v[52:55], v[112:115], v[156:159], v[52:55]
    ds_read_b128 v[164:167], v19 offset:2048
    ds_read_b64_tr_b16 v[112:113], v21 offset:21504
    v_mfma_f32_16x16x32_bf16 v[36:39], v[116:119], v[152:155], v[36:39]
    ds_read_b64_tr_b16 v[114:115], v21 offset:22784
    buffer_load_dwordx4 v14, s[16:19], s42 offen offset:2048 lds
    v_mfma_f32_16x16x32_bf16 v[56:59], v[116:119], v[156:159], v[56:59]
    ds_read_b64_tr_b16 v[116:117], v21 offset:21512
    ds_read_b64_tr_b16 v[118:119], v21 offset:22792
    v_mfma_f32_16x16x32_bf16 v[40:43], v[120:123], v[152:155], v[40:43]
    buffer_load_dwordx4 v15, s[16:19], s42 offen offset:3072 lds
    s_add_u32 m0, s45, 36896
    v_mfma_f32_16x16x32_bf16 v[60:63], v[120:123], v[156:159], v[60:63]
    ds_read_b64_tr_b16 v[120:121], v21 offset:21520
    ds_read_b64_tr_b16 v[122:123], v21 offset:22800
    v_mfma_f32_16x16x32_bf16 v[44:47], v[124:127], v[152:155], v[44:47]
    buffer_load_dwordx4 v24, s[20:23], s43 offen lds
    buffer_load_dwordx4 v25, s[20:23], s43 offen offset:1024 lds
    v_mfma_f32_16x16x32_bf16 v[64:67], v[124:127], v[156:159], v[64:67]
    ds_read_b64_tr_b16 v[124:125], v21 offset:21528
    ds_read_b64_tr_b16 v[126:127], v21 offset:22808
    v_mfma_f32_16x16x32_bf16 v[48:51], v[128:131], v[152:155], v[48:51]
    buffer_load_dwordx4 v26, s[20:23], s43 offen offset:2048 lds
    buffer_load_dwordx4 v27, s[20:23], s43 offen offset:3072 lds
    v_mfma_f32_16x16x32_bf16 v[68:71], v[128:131], v[156:159], v[68:71]
    s_waitcnt lgkmcnt(10)
    ds_read_b64_tr_b16 v[128:129], v21 offset:21536
    v_mfma_f32_16x16x32_bf16 v[72:75], v[152:155], v[132:135], v[72:75]
    ds_read_b64_tr_b16 v[130:131], v21 offset:22816
    s_add_u32 m0, s45, 40992
    v_mfma_f32_16x16x32_bf16 v[92:95], v[156:159], v[132:135], v[92:95]
    ds_read_b64_tr_b16 v[132:133], v23 offset:21504
    ds_read_b64_tr_b16 v[134:135], v23 offset:22784
    v_mfma_f32_16x16x32_bf16 v[76:79], v[152:155], v[136:139], v[76:79]
    s_add_u32 s42, s42, 128
    buffer_load_dwordx4 v28, s[20:23], s43 offen lds
    v_mfma_f32_16x16x32_bf16 v[96:99], v[156:159], v[136:139], v[96:99]
    ds_read_b64_tr_b16 v[136:137], v23 offset:21536
    ds_read_b64_tr_b16 v[138:139], v23 offset:22816
    v_mfma_f32_16x16x32_bf16 v[80:83], v[152:155], v[140:143], v[80:83]
    s_add_u32 s43, s43, 245760
    v_mfma_f32_16x16x32_bf16 v[100:103], v[156:159], v[140:143], v[100:103]
    ds_read_b64_tr_b16 v[140:141], v23 offset:21568
    ds_read_b64_tr_b16 v[142:143], v23 offset:22848
    v_mfma_f32_16x16x32_bf16 v[84:87], v[152:155], v[144:147], v[84:87]
    v_mfma_f32_16x16x32_bf16 v[104:107], v[156:159], v[144:147], v[104:107]
    ds_read_b64_tr_b16 v[144:145], v23 offset:21600
    ds_read_b64_tr_b16 v[146:147], v23 offset:22880
    v_mfma_f32_16x16x32_bf16 v[88:91], v[152:155], v[148:151], v[88:91]
    v_mfma_f32_16x16x32_bf16 v[108:111], v[156:159], v[148:151], v[108:111]
    ds_read_b64_tr_b16 v[148:149], v23 offset:21632
    s_waitcnt lgkmcnt(9)
    v_mfma_f32_16x16x32_bf16 v[32:35], v[112:115], v[160:163], v[32:35]
    ds_read_b64_tr_b16 v[150:151], v23 offset:22912
    ds_read_b64_tr_b16 a[200:201], v29 offset:0
    v_mfma_f32_16x16x32_bf16 v[52:55], v[112:115], v[164:167], v[52:55]
    ds_read_b64_tr_b16 a[202:203], v29 offset:160
    ds_read_b64_tr_b16 a[204:205], v29 offset:320
    v_mfma_f32_16x16x32_bf16 v[36:39], v[116:119], v[160:163], v[36:39]
    ds_read_b64_tr_b16 a[206:207], v29 offset:480
    ds_read_b64_tr_b16 a[208:209], v29 offset:640
    v_mfma_f32_16x16x32_bf16 v[56:59], v[116:119], v[164:167], v[56:59]
    ds_read_b64_tr_b16 a[210:211], v29 offset:8
    ds_read_b64_tr_b16 a[212:213], v29 offset:168
    v_mfma_f32_16x16x32_bf16 v[40:43], v[120:123], v[160:163], v[40:43]
    ds_read_b64_tr_b16 a[214:215], v29 offset:328
    ds_read_b64_tr_b16 a[216:217], v29 offset:488
    v_mfma_f32_16x16x32_bf16 v[60:63], v[120:123], v[164:167], v[60:63]
    ds_read_b64_tr_b16 a[218:219], v29 offset:648
    ds_read_b64_tr_b16 a[220:221], v29 offset:16
    v_mfma_f32_16x16x32_bf16 v[44:47], v[124:127], v[160:163], v[44:47]
    s_waitcnt vmcnt(19)
    s_waitcnt lgkmcnt(0)
    s_barrier
    v_mfma_f32_16x16x32_bf16 v[64:67], v[124:127], v[164:167], v[64:67]
    ds_read_b128 v[152:155], v17 offset:36896
    ds_read_b128 v[156:159], v17 offset:38944
    v_mfma_f32_16x16x32_bf16 v[48:51], v[128:131], v[160:163], v[48:51]
    ds_read_b64_tr_b16 v[112:113], v21 offset:53280
    ds_read_b64_tr_b16 v[114:115], v21 offset:54560
    v_mfma_f32_16x16x32_bf16 v[68:71], v[128:131], v[164:167], v[68:71]
    ds_read_b64_tr_b16 v[116:117], v21 offset:53288
    v_mfma_f32_16x16x32_bf16 v[72:75], v[160:163], v[132:135], v[72:75]
    ds_read_b64_tr_b16 v[118:119], v21 offset:54568
    ds_read_b64_tr_b16 v[120:121], v21 offset:53296
    v_mfma_f32_16x16x32_bf16 v[92:95], v[164:167], v[132:135], v[92:95]
    ds_read_b64_tr_b16 v[122:123], v21 offset:54576
    ds_read_b64_tr_b16 v[124:125], v21 offset:53304
    v_mfma_f32_16x16x32_bf16 v[76:79], v[160:163], v[136:139], v[76:79]
    ds_read_b64_tr_b16 v[126:127], v21 offset:54584
    ds_read_b64_tr_b16 v[128:129], v21 offset:53312
    v_mfma_f32_16x16x32_bf16 v[96:99], v[164:167], v[136:139], v[96:99]
    ds_read_b64_tr_b16 v[130:131], v21 offset:54592
    ds_read_b64_tr_b16 v[132:133], v23 offset:53280
    v_mfma_f32_16x16x32_bf16 v[80:83], v[160:163], v[140:143], v[80:83]
    ds_read_b64_tr_b16 v[134:135], v23 offset:54560
    ds_read_b64_tr_b16 v[136:137], v23 offset:53312
    v_mfma_f32_16x16x32_bf16 v[100:103], v[164:167], v[140:143], v[100:103]
    ds_read_b64_tr_b16 v[138:139], v23 offset:54592
    ds_read_b64_tr_b16 v[140:141], v23 offset:53344
    v_mfma_f32_16x16x32_bf16 v[84:87], v[160:163], v[144:147], v[84:87]
    ds_read_b64_tr_b16 v[142:143], v23 offset:54624
    ds_read_b64_tr_b16 a[222:223], v29 offset:176
    v_mfma_f32_16x16x32_bf16 v[104:107], v[164:167], v[144:147], v[104:107]
    ds_read_b64_tr_b16 v[144:145], v23 offset:53376
    ds_read_b64_tr_b16 v[146:147], v23 offset:54656
    v_mfma_f32_16x16x32_bf16 v[88:91], v[160:163], v[148:151], v[88:91]
    ds_read_b64_tr_b16 a[224:225], v29 offset:336
    ds_read_b64_tr_b16 a[226:227], v29 offset:496
    v_mfma_f32_16x16x32_bf16 v[108:111], v[164:167], v[148:151], v[108:111]
    ds_read_b64_tr_b16 v[148:149], v23 offset:53408
    s_waitcnt lgkmcnt(12)
    v_mfma_f32_16x16x32_bf16 v[32:35], v[112:115], v[152:155], v[32:35]
    ds_read_b64_tr_b16 v[150:151], v23 offset:54688
    ds_read_b128 v[160:163], v19 offset:36896
    v_mfma_f32_16x16x32_bf16 v[52:55], v[112:115], v[156:159], v[52:55]
    ds_read_b128 v[164:167], v19 offset:38944
    ds_read_b64_tr_b16 v[112:113], v21 offset:58400
    v_mfma_f32_16x16x32_bf16 v[36:39], v[116:119], v[152:155], v[36:39]
    ds_read_b64_tr_b16 v[114:115], v21 offset:59680
    ds_read_b64_tr_b16 a[228:229], v29 offset:656
    v_mfma_f32_16x16x32_bf16 v[56:59], v[116:119], v[156:159], v[56:59]
    ds_read_b64_tr_b16 v[116:117], v21 offset:58408
    ds_read_b64_tr_b16 v[118:119], v21 offset:59688
    v_mfma_f32_16x16x32_bf16 v[40:43], v[120:123], v[152:155], v[40:43]
    ds_read_b64_tr_b16 a[230:231], v29 offset:24
    ds_read_b64_tr_b16 a[232:233], v29 offset:184
    v_mfma_f32_16x16x32_bf16 v[60:63], v[120:123], v[156:159], v[60:63]
    ds_read_b64_tr_b16 v[120:121], v21 offset:58416
    ds_read_b64_tr_b16 v[122:123], v21 offset:59696
    v_mfma_f32_16x16x32_bf16 v[44:47], v[124:127], v[152:155], v[44:47]
    ds_read_b64_tr_b16 a[234:235], v29 offset:344
    ds_read_b64_tr_b16 a[236:237], v29 offset:504
    v_mfma_f32_16x16x32_bf16 v[64:67], v[124:127], v[156:159], v[64:67]
    ds_read_b64_tr_b16 v[124:125], v21 offset:58424
    ds_read_b64_tr_b16 v[126:127], v21 offset:59704
    v_mfma_f32_16x16x32_bf16 v[48:51], v[128:131], v[152:155], v[48:51]
    ds_read_b64_tr_b16 a[238:239], v29 offset:664
    ds_read_b64_tr_b16 a[240:241], v29 offset:32
    v_mfma_f32_16x16x32_bf16 v[68:71], v[128:131], v[156:159], v[68:71]
    s_waitcnt lgkmcnt(15)
    ds_read_b64_tr_b16 v[128:129], v21 offset:58432
    v_mfma_f32_16x16x32_bf16 v[72:75], v[152:155], v[132:135], v[72:75]
    ds_read_b64_tr_b16 v[130:131], v21 offset:59712
    ds_read_b64_tr_b16 a[242:243], v29 offset:192
    v_mfma_f32_16x16x32_bf16 v[92:95], v[156:159], v[132:135], v[92:95]
    ds_read_b64_tr_b16 v[132:133], v23 offset:58400
    ds_read_b64_tr_b16 v[134:135], v23 offset:59680
    v_mfma_f32_16x16x32_bf16 v[76:79], v[152:155], v[136:139], v[76:79]
    ds_read_b64_tr_b16 a[244:245], v29 offset:352
    ds_read_b64_tr_b16 a[246:247], v29 offset:512
    v_mfma_f32_16x16x32_bf16 v[96:99], v[156:159], v[136:139], v[96:99]
    ds_read_b64_tr_b16 v[136:137], v23 offset:58432
    ds_read_b64_tr_b16 v[138:139], v23 offset:59712
    v_mfma_f32_16x16x32_bf16 v[80:83], v[152:155], v[140:143], v[80:83]
    ds_read_b64_tr_b16 a[248:249], v29 offset:672
    v_mfma_f32_16x16x32_bf16 v[100:103], v[156:159], v[140:143], v[100:103]
    ds_read_b64_tr_b16 v[140:141], v23 offset:58464
    ds_read_b64_tr_b16 v[142:143], v23 offset:59744
    v_mfma_f32_16x16x32_bf16 v[84:87], v[152:155], v[144:147], v[84:87]
    v_mfma_f32_16x16x32_bf16 v[104:107], v[156:159], v[144:147], v[104:107]
    ds_read_b64_tr_b16 v[144:145], v23 offset:58496
    ds_read_b64_tr_b16 v[146:147], v23 offset:59776
    v_mfma_f32_16x16x32_bf16 v[88:91], v[152:155], v[148:151], v[88:91]
    v_mfma_f32_16x16x32_bf16 v[108:111], v[156:159], v[148:151], v[108:111]
    ds_read_b64_tr_b16 v[148:149], v23 offset:58528
    s_waitcnt lgkmcnt(13)
    v_mfma_f32_16x16x32_bf16 v[32:35], v[112:115], v[160:163], v[32:35]
    ds_read_b64_tr_b16 v[150:151], v23 offset:59808
    s_cmp_lg_u32 s24, 0
    s_cbranch_scc1 s0p_3
    global_load_dword v31, v30, s[82:83] sc1
s0p_3:
    v_mfma_f32_16x16x32_bf16 v[52:55], v[112:115], v[164:167], v[52:55]
    v_mfma_f32_16x16x32_bf16 v[36:39], v[116:119], v[160:163], v[36:39]
    v_mfma_f32_16x16x32_bf16 v[56:59], v[116:119], v[164:167], v[56:59]
    v_mfma_f32_16x16x32_bf16 v[40:43], v[120:123], v[160:163], v[40:43]
    v_mfma_f32_16x16x32_bf16 v[60:63], v[120:123], v[164:167], v[60:63]
    v_mfma_f32_16x16x32_bf16 v[44:47], v[124:127], v[160:163], v[44:47]
    s_waitcnt vmcnt(10)
    s_waitcnt lgkmcnt(0)
    s_barrier
    v_mfma_f32_16x16x32_bf16 v[64:67], v[124:127], v[164:167], v[64:67]
    ds_read_b128 v[152:155], v16 offset:0
    ds_read_b128 v[156:159], v16 offset:2048
    v_mfma_f32_16x16x32_bf16 v[48:51], v[128:131], v[160:163], v[48:51]
    ds_read_b64_tr_b16 v[112:113], v20 offset:16384
    ds_read_b64_tr_b16 v[114:115], v20 offset:17664
    v_mfma_f32_16x16x32_bf16 v[68:71], v[128:131], v[164:167], v[68:71]
    ds_read_b64_tr_b16 v[116:117], v20 offset:16392
    v_mfma_f32_16x16x32_bf16 v[72:75], v[160:163], v[132:135], v[72:75]
    ds_read_b64_tr_b16 v[118:119], v20 offset:17672
    ds_read_b64_tr_b16 v[120:121], v20 offset:16400
    v_mfma_f32_16x16x32_bf16 v[92:95], v[164:167], v[132:135], v[92:95]
    ds_read_b64_tr_b16 v[122:123], v20 offset:17680
    ds_read_b64_tr_b16 v[124:125], v20 offset:16408
    v_mfma_f32_16x16x32_bf16 v[76:79], v[160:163], v[136:139], v[76:79]
    ds_read_b64_tr_b16 v[126:127], v20 offset:17688
    ds_read_b64_tr_b16 v[128:129], v20 offset:16416
    v_mfma_f32_16x16x32_bf16 v[96:99], v[164:167], v[136:139], v[96:99]
    ds_read_b64_tr_b16 v[130:131], v20 offset:17696
    ds_read_b64_tr_b16 v[132:133], v22 offset:16384
    v_mfma_f32_16x16x32_bf16 v[80:83], v[160:163], v[140:143], v[80:83]
    ds_read_b64_tr_b16 v[134:135], v22 offset:17664
    ds_read_b64_tr_b16 v[136:137], v22 offset:16416
    v_mfma_f32_16x16x32_bf16 v[100:103], v[164:167], v[140:143], v[100:103]
    ds_read_b64_tr_b16 v[138:139], v22 offset:17696
    ds_read_b64_tr_b16 v[140:141], v22 offset:16448
    v_mfma_f32_16x16x32_bf16 v[84:87], v[160:163], v[144:147], v[84:87]
    ds_read_b64_tr_b16 v[142:143], v22 offset:17728
    v_mfma_f32_16x16x32_bf16 v[104:107], v[164:167], v[144:147], v[104:107]
    ds_read_b64_tr_b16 v[144:145], v22 offset:16480
    ds_read_b64_tr_b16 v[146:147], v22 offset:17760
    v_mfma_f32_16x16x32_bf16 v[88:91], v[160:163], v[148:151], v[88:91]
    v_mfma_f32_16x16x32_bf16 v[108:111], v[164:167], v[148:151], v[108:111]
    ds_read_b64_tr_b16 v[148:149], v22 offset:16512
    s_waitcnt lgkmcnt(9)
    v_mfma_f32_16x16x32_bf16 v[32:35], v[112:115], v[152:155], v[32:35]
    ds_read_b64_tr_b16 v[150:151], v22 offset:17792
    ds_read_b128 v[160:163], v18 offset:0
    v_mfma_f32_16x16x32_bf16 v[52:55], v[112:115], v[156:159], v[52:55]
    ds_read_b128 v[164:167], v18 offset:2048
    ds_read_b64_tr_b16 v[112:113], v20 offset:21504
    v_mfma_f32_16x16x32_bf16 v[36:39], v[116:119], v[152:155], v[36:39]
    ds_read_b64_tr_b16 v[114:115], v20 offset:22784
    v_mfma_f32_16x16x32_bf16 v[56:59], v[116:119], v[156:159], v[56:59]
    ds_read_b64_tr_b16 v[116:117], v20 offset:21512
    ds_read_b64_tr_b16 v[118:119], v20 offset:22792
    v_mfma_f32_16x16x32_bf16 v[40:43], v[120:123], v[152:155], v[40:43]
    v_mfma_f32_16x16x32_bf16 v[60:63], v[120:123], v[156:159], v[60:63]
    ds_read_b64_tr_b16 v[120:121], v20 offset:21520
    ds_read_b64_tr_b16 v[122:123], v20 offset:22800
    v_mfma_f32_16x16x32_bf16 v[44:47], v[124:127], v[152:155], v[44:47]
    v_mfma_f32_16x16x32_bf16 v[64:67], v[124:127], v[156:159], v[64:67]
    ds_read_b64_tr_b16 v[124:125], v20 offset:21528
    ds_read_b64_tr_b16 v[126:127], v20 offset:22808
    v_mfma_f32_16x16x32_bf16 v[48:51], v[128:131], v[152:155], v[48:51]
    v_mfma_f32_16x16x32_bf16 v[68:71], v[128:131], v[156:159], v[68:71]
    s_waitcnt lgkmcnt(10)
    ds_read_b64_tr_b16 v[128:129], v20 offset:21536
    v_mfma_f32_16x16x32_bf16 v[72:75], v[152:155], v[132:135], v[72:75]
    ds_read_b64_tr_b16 v[130:131], v20 offset:22816
    v_mfma_f32_16x16x32_bf16 v[92:95], v[156:159], v[132:135], v[92:95]
    ds_read_b64_tr_b16 v[132:133], v22 offset:21504
    ds_read_b64_tr_b16 v[134:135], v22 offset:22784
    v_mfma_f32_16x16x32_bf16 v[76:79], v[152:155], v[136:139], v[76:79]
    v_mfma_f32_16x16x32_bf16 v[96:99], v[156:159], v[136:139], v[96:99]
    ds_read_b64_tr_b16 v[136:137], v22 offset:21536
    ds_read_b64_tr_b16 v[138:139], v22 offset:22816
    v_mfma_f32_16x16x32_bf16 v[80:83], v[152:155], v[140:143], v[80:83]
    v_mfma_f32_16x16x32_bf16 v[100:103], v[156:159], v[140:143], v[100:103]
    ds_read_b64_tr_b16 v[140:141], v22 offset:21568
    ds_read_b64_tr_b16 v[142:143], v22 offset:22848
    v_mfma_f32_16x16x32_bf16 v[84:87], v[152:155], v[144:147], v[84:87]
    v_mfma_f32_16x16x32_bf16 v[104:107], v[156:159], v[144:147], v[104:107]
    ds_read_b64_tr_b16 v[144:145], v22 offset:21600
    ds_read_b64_tr_b16 v[146:147], v22 offset:22880
    v_mfma_f32_16x16x32_bf16 v[88:91], v[152:155], v[148:151], v[88:91]
    v_mfma_f32_16x16x32_bf16 v[108:111], v[156:159], v[148:151], v[108:111]
    ds_read_b64_tr_b16 v[148:149], v22 offset:21632
    s_waitcnt lgkmcnt(9)
    v_mfma_f32_16x16x32_bf16 v[32:35], v[112:115], v[160:163], v[32:35]
    ds_read_b64_tr_b16 v[150:151], v22 offset:22912
    v_mfma_f32_16x16x32_bf16 v[52:55], v[112:115], v[164:167], v[52:55]
    v_mfma_f32_16x16x32_bf16 v[36:39], v[116:119], v[160:163], v[36:39]
    v_mfma_f32_16x16x32_bf16 v[56:59], v[116:119], v[164:167], v[56:59]
    v_mfma_f32_16x16x32_bf16 v[40:43], v[120:123], v[160:163], v[40:43]
    v_mfma_f32_16x16x32_bf16 v[60:63], v[120:123], v[164:167], v[60:63]
    v_mfma_f32_16x16x32_bf16 v[44:47], v[124:127], v[160:163], v[44:47]
    s_cmp_lg_u32 s24, 0
    s_cbranch_scc1 s0_4
    s_waitcnt vmcnt(0)
    v_cmp_eq_u32 vcc, 0, v31
    s_nop 1
    s_cbranch_vccz s0_4
    s_mov_b32 s29, 262144
go_5:
    global_load_dword v31, v30, s[82:83] sc1
    s_waitcnt vmcnt(0)
    v_cmp_eq_u32 vcc, 0, v31
    s_nop 1
    s_cbranch_vccz s0_4
    s_sleep 12
    s_sub_u32 s29, s29, 1
    s_cbranch_scc0 go_5
s0_4:
    s_waitcnt vmcnt(0)
    s_waitcnt lgkmcnt(0)
    s_barrier
    v_mfma_f32_16x16x32_bf16 v[64:67], v[124:127], v[164:167], v[64:67]
    ds_read_b128 v[152:155], v16 offset:36896
    ds_read_b128 v[156:159], v16 offset:38944
    v_mfma_f32_16x16x32_bf16 v[48:51], v[128:131], v[160:163], v[48:51]
    ds_read_b64_tr_b16 v[112:113], v20 offset:53280
    ds_read_b64_tr_b16 v[114:115], v20 offset:54560
    v_mfma_f32_16x16x32_bf16 v[68:71], v[128:131], v[164:167], v[68:71]
    ds_read_b64_tr_b16 v[116:117], v20 offset:53288
    v_mfma_f32_16x16x32_bf16 v[72:75], v[160:163], v[132:135], v[72:75]
    ds_read_b64_tr_b16 v[118:119], v20 offset:54568
    ds_read_b64_tr_b16 v[120:121], v20 offset:53296
    v_mfma_f32_16x16x32_bf16 v[92:95], v[164:167], v[132:135], v[92:95]
    ds_read_b64_tr_b16 v[122:123], v20 offset:54576
    ds_read_b64_tr_b16 v[124:125], v20 offset:53304
    v_mfma_f32_16x16x32_bf16 v[76:79], v[160:163], v[136:139], v[76:79]
    ds_read_b64_tr_b16 v[126:127], v20 offset:54584
    ds_read_b64_tr_b16 v[128:129], v20 offset:53312
    v_mfma_f32_16x16x32_bf16 v[96:99], v[164:167], v[136:139], v[96:99]
    ds_read_b64_tr_b16 v[130:131], v20 offset:54592
    ds_read_b64_tr_b16 v[132:133], v22 offset:53280
    v_mfma_f32_16x16x32_bf16 v[80:83], v[160:163], v[140:143], v[80:83]
    ds_read_b64_tr_b16 v[134:135], v22 offset:54560
    ds_read_b64_tr_b16 v[136:137], v22 offset:53312
    v_mfma_f32_16x16x32_bf16 v[100:103], v[164:167], v[140:143], v[100:103]
    ds_read_b64_tr_b16 v[138:139], v22 offset:54592
    ds_read_b64_tr_b16 v[140:141], v22 offset:53344
    v_mfma_f32_16x16x32_bf16 v[84:87], v[160:163], v[144:147], v[84:87]
    ds_read_b64_tr_b16 v[142:143], v22 offset:54624
    buffer_load_dword v168, v7, s[8:11], s50 offen offset:0 sc1
    v_mfma_f32_16x16x32_bf16 v[104:107], v[164:167], v[144:147], v[104:107]
    ds_read_b64_tr_b16 v[144:145], v22 offset:53376
    ds_read_b64_tr_b16 v[146:147], v22 offset:54656
    v_mfma_f32_16x16x32_bf16 v[88:91], v[160:163], v[148:151], v[88:91]
    buffer_load_dword v169, v7, s[8:11], s51 offen offset:0 sc1
    buffer_load_dword v170, v7, s[8:11], s50 offen offset:64 sc1
    v_mfma_f32_16x16x32_bf16 v[108:111], v[164:167], v[148:151], v[108:111]
    ds_read_b64_tr_b16 v[148:149], v22 offset:53408
    s_waitcnt lgkmcnt(9)
    v_mfma_f32_16x16x32_bf16 v[32:35], v[112:115], v[152:155], v[32:35]
    ds_read_b64_tr_b16 v[150:151], v22 offset:54688
    ds_read_b128 v[160:163], v18 offset:36896
    v_mfma_f32_16x16x32_bf16 v[52:55], v[112:115], v[156:159], v[52:55]
    ds_read_b128 v[164:167], v18 offset:38944
    ds_read_b64_tr_b16 v[112:113], v20 offset:58400
    v_mfma_f32_16x16x32_bf16 v[36:39], v[116:119], v[152:155], v[36:39]
    ds_read_b64_tr_b16 v[114:115], v20 offset:59680
    buffer_load_dword v171, v7, s[8:11], s51 offen offset:64 sc1
    v_mfma_f32_16x16x32_bf16 v[56:59], v[116:119], v[156:159], v[56:59]
    ds_read_b64_tr_b16 v[116:117], v20 offset:58408
    ds_read_b64_tr_b16 v[118:119], v20 offset:59688
    v_mfma_f32_16x16x32_bf16 v[40:43], v[120:123], v[152:155], v[40:43]
    buffer_load_dwordx4 v[172:175], v219, s[8:11], s52 offen offset:0 sc1
    buffer_load_dwordx4 v[220:223], v219, s[8:11], s53 offen offset:0 sc1
    v_mfma_f32_16x16x32_bf16 v[60:63], v[120:123], v[156:159], v[60:63]
    ds_read_b64_tr_b16 v[120:121], v20 offset:58416
    ds_read_b64_tr_b16 v[122:123], v20 offset:59696
    v_mfma_f32_16x16x32_bf16 v[44:47], v[124:127], v[152:155], v[44:47]
    buffer_load_dwordx4 v[176:179], v219, s[8:11], s52 offen offset:16 sc1
    buffer_load_dwordx4 v[224:227], v219, s[8:11], s53 offen offset:16 sc1
    v_mfma_f32_16x16x32_bf16 v[64:67], v[124:127], v[156:159], v[64:67]
    ds_read_b64_tr_b16 v[124:125], v20 offset:58424
    ds_read_b64_tr_b16 v[126:127], v20 offset:59704
    v_mfma_f32_16x16x32_bf16 v[48:51], v[128:131], v[152:155], v[48:51]
    buffer_load_dwordx4 v[180:183], v219, s[8:11], s52 offen offset:32 sc1
    buffer_load_dwordx4 v[228:231], v219, s[8:11], s53 offen offset:32 sc1
    v_mfma_f32_16x16x32_bf16 v[68:71], v[128:131], v[156:159], v[68:71]
    s_waitcnt lgkmcnt(10)
    ds_read_b64_tr_b16 v[128:129], v20 offset:58432
    v_mfma_f32_16x16x32_bf16 v[72:75], v[152:155], v[132:135], v[72:75]
    ds_read_b64_tr_b16 v[130:131], v20 offset:59712
    buffer_load_dwordx4 v[184:187], v219, s[8:11], s52 offen offset:48 sc1
    v_mfma_f32_16x16x32_bf16 v[92:95], v[156:159], v[132:135], v[92:95]
    ds_read_b64_tr_b16 v[132:133], v22 offset:58400
    ds_read_b64_tr_b16 v[134:135], v22 offset:59680
    v_mfma_f32_16x16x32_bf16 v[76:79], v[152:155], v[136:139], v[76:79]
    buffer_load_dwordx4 v[232:235], v219, s[8:11], s53 offen offset:48 sc1
    buffer_load_dwordx4 v[188:191], v219, s[8:11], s52 offen offset:64 sc1
    v_mfma_f32_16x16x32_bf16 v[96:99], v[156:159], v[136:139], v[96:99]
    ds_read_b64_tr_b16 v[136:137], v22 offset:58432
    ds_read_b64_tr_b16 v[138:139], v22 offset:59712
    v_mfma_f32_16x16x32_bf16 v[80:83], v[152:155], v[140:143], v[80:83]
    buffer_load_dwordx4 v[236:239], v219, s[8:11], s53 offen offset:64 sc1
    buffer_load_dword v192, v7, s[8:11], s52 offen offset:2560 sc1
    v_mfma_f32_16x16x32_bf16 v[100:103], v[156:159], v[140:143], v[100:103]
    ds_read_b64_tr_b16 v[140:141], v22 offset:58464
    ds_read_b64_tr_b16 v[142:143], v22 offset:59744
    v_mfma_f32_16x16x32_bf16 v[84:87], v[152:155], v[144:147], v[84:87]
    buffer_load_dword v193, v7, s[8:11], s53 offen offset:2560 sc1
    buffer_load_dword v194, v7, s[8:11], s52 offen offset:2624 sc1
    v_mfma_f32_16x16x32_bf16 v[104:107], v[156:159], v[144:147], v[104:107]
    ds_read_b64_tr_b16 v[144:145], v22 offset:58496
    ds_read_b64_tr_b16 v[146:147], v22 offset:59776
    v_mfma_f32_16x16x32_bf16 v[88:91], v[152:155], v[148:151], v[88:91]
    buffer_load_dword v195, v7, s[8:11], s53 offen offset:2624 sc1
    buffer_load_dword v196, v7, s[8:11], s52 offen offset:2688 sc1
    v_mfma_f32_16x16x32_bf16 v[108:111], v[156:159], v[148:151], v[108:111]
    ds_read_b64_tr_b16 v[148:149], v22 offset:58528
    s_waitcnt lgkmcnt(9)
    v_mfma_f32_16x16x32_bf16 v[32:35], v[112:115], v[160:163], v[32:35]
    ds_read_b64_tr_b16 v[150:151], v22 offset:59808
    buffer_load_dword v197, v7, s[8:11], s53 offen offset:2688 sc1
    v_mfma_f32_16x16x32_bf16 v[52:55], v[112:115], v[164:167], v[52:55]
    buffer_load_dword v198, v7, s[8:11], s52 offen offset:2752 sc1
    buffer_load_dword v199, v7, s[8:11], s53 offen offset:2752 sc1
    v_mfma_f32_16x16x32_bf16 v[36:39], v[116:119], v[160:163], v[36:39]
    buffer_load_dword v200, v7, s[8:11], s52 offen offset:2816 sc1
    buffer_load_dword v201, v7, s[8:11], s53 offen offset:2816 sc1
    v_mfma_f32_16x16x32_bf16 v[56:59], v[116:119], v[164:167], v[56:59]
    buffer_load_dwordx4 v[202:205], v218, s[8:11], s50 offen offset:0 sc1
    buffer_load_dwordx4 v[210:213], v218, s[8:11], s51 offen offset:0 sc1
    v_mfma_f32_16x16x32_bf16 v[40:43], v[120:123], v[160:163], v[40:43]
    buffer_load_dwordx4 v[206:209], v218, s[8:11], s50 offen offset:64 sc1
    buffer_load_dwordx4 v[214:217], v218, s[8:11], s51 offen offset:64 sc1
    v_mfma_f32_16x16x32_bf16 v[60:63], v[120:123], v[164:167], v[60:63]
    s_lshl_b32 s34, s26, 2
    s_add_u32 s34, s34, s24
    v_mfma_f32_16x16x32_bf16 v[44:47], v[124:127], v[160:163], v[44:47]
    s_mul_i32 s34, s34, 6400
    v_min_u32_e64 v31, 49, v2
    v_mfma_f32_16x16x32_bf16 v[64:67], v[124:127], v[164:167], v[64:67]
    v_lshlrev_b32_e64 v31, 7, v31
    buffer_load_dword v5, v31, s[8:11], s34 offen sc1
    v_mfma_f32_16x16x32_bf16 v[48:51], v[128:131], v[160:163], v[48:51]
    s_and_b32 s34, s26, 7
    s_lshl_b32 s34, s34, 2
    v_mfma_f32_16x16x32_bf16 v[68:71], v[128:131], v[164:167], v[68:71]
    s_waitcnt lgkmcnt(0)
    s_add_u32 s34, s34, s24
    v_mfma_f32_16x16x32_bf16 v[72:75], v[160:163], v[132:135], v[72:75]
    s_mul_i32 s34, s34, 256
    v_min_u32_e64 v31, 1, v2
    v_mfma_f32_16x16x32_bf16 v[92:95], v[164:167], v[132:135], v[92:95]
    v_lshl_add_u32 v31, v31, 7, s34
    v_min_u32 v31, L_C-L_join, v31
    v_mfma_f32_16x16x32_bf16 v[76:79], v[160:163], v[136:139], v[76:79]
    v_add_u32 v31, L_join-L_pc, v31
    global_load_dword v5, v31, s[6:7]
    v_mfma_f32_16x16x32_bf16 v[96:99], v[164:167], v[136:139], v[96:99]
    v_mfma_f32_16x16x32_bf16 v[80:83], v[160:163], v[140:143], v[80:83]
    v_mfma_f32_16x16x32_bf16 v[100:103], v[164:167], v[140:143], v[100:103]
    v_mfma_f32_16x16x32_bf16 v[84:87], v[160:163], v[144:147], v[84:87]
    v_mfma_f32_16x16x32_bf16 v[104:107], v[164:167], v[144:147], v[104:107]
    v_mfma_f32_16x16x32_bf16 v[88:91], v[160:163], v[148:151], v[88:91]
    v_mfma_f32_16x16x32_bf16 v[108:111], v[164:167], v[148:151], v[108:111]
L_ep_kv:
    s_waitcnt vmcnt(24)
    v_pk_add_f32 v[172:173], v[172:173], v[220:221]
    v_pk_add_f32 v[174:175], v[174:175], v[222:223]
    s_waitcnt vmcnt(22)
    v_pk_add_f32 v[176:177], v[176:177], v[224:225]
    v_pk_add_f32 v[178:179], v[178:179], v[226:227]
    s_waitcnt vmcnt(20)
    v_pk_add_f32 v[180:181], v[180:181], v[228:229]
    v_pk_add_f32 v[182:183], v[182:183], v[230:231]
    s_waitcnt vmcnt(18)
    v_pk_add_f32 v[184:185], v[184:185], v[232:233]
    v_pk_add_f32 v[186:187], v[186:187], v[234:235]
    s_waitcnt vmcnt(16)
    v_pk_add_f32 v[188:189], v[188:189], v[236:237]
    v_pk_add_f32 v[190:191], v[190:191], v[238:239]
    s_waitcnt vmcnt(14)
    v_add_f32 v192, v192, v193
    s_waitcnt vmcnt(12)
    v_add_f32 v194, v194, v195
    s_waitcnt vmcnt(10)
    v_add_f32 v196, v196, v197
    s_waitcnt vmcnt(8)
    v_add_f32 v198, v198, v199
    s_waitcnt vmcnt(6)
    v_add_f32_e64 v200, v200, v201
    v_pk_fma_f32 v[32:33], v[168:169], v[172:173], v[32:33] op_sel_hi:[0,1,1] neg_lo:[1,0,0] neg_hi:[1,0,0]
    v_pk_fma_f32 v[34:35], v[168:169], v[174:175], v[34:35] op_sel_hi:[0,1,1] neg_lo:[1,0,0] neg_hi:[1,0,0]
    v_pk_fma_f32 v[36:37], v[168:169], v[176:177], v[36:37] op_sel_hi:[0,1,1] neg_lo:[1,0,0] neg_hi:[1,0,0]
    v_pk_fma_f32 v[38:39], v[168:169], v[178:179], v[38:39] op_sel_hi:[0,1,1] neg_lo:[1,0,0] neg_hi:[1,0,0]
    v_pk_fma_f32 v[40:41], v[168:169], v[180:181], v[40:41] op_sel_hi:[0,1,1] neg_lo:[1,0,0] neg_hi:[1,0,0]
    v_pk_fma_f32 v[42:43], v[168:169], v[182:183], v[42:43] op_sel_hi:[0,1,1] neg_lo:[1,0,0] neg_hi:[1,0,0]
    v_pk_fma_f32 v[44:45], v[168:169], v[184:185], v[44:45] op_sel_hi:[0,1,1] neg_lo:[1,0,0] neg_hi:[1,0,0]
    v_pk_fma_f32 v[46:47], v[168:169], v[186:187], v[46:47] op_sel_hi:[0,1,1] neg_lo:[1,0,0] neg_hi:[1,0,0]
    v_pk_fma_f32 v[48:49], v[168:169], v[188:189], v[48:49] op_sel_hi:[0,1,1] neg_lo:[1,0,0] neg_hi:[1,0,0]
    buffer_load_dwordx4 a[0:3], v1, s[8:11], s54 offen sc1
    v_pk_fma_f32 v[50:51], v[168:169], v[190:191], v[50:51] op_sel_hi:[0,1,1] neg_lo:[1,0,0] neg_hi:[1,0,0]
    v_pk_fma_f32 v[52:53], v[170:171], v[172:173], v[52:53] op_sel_hi:[0,1,1] neg_lo:[1,0,0] neg_hi:[1,0,0]
    v_pk_fma_f32 v[54:55], v[170:171], v[174:175], v[54:55] op_sel_hi:[0,1,1] neg_lo:[1,0,0] neg_hi:[1,0,0]
    v_pk_fma_f32 v[56:57], v[170:171], v[176:177], v[56:57] op_sel_hi:[0,1,1] neg_lo:[1,0,0] neg_hi:[1,0,0]
    v_pk_fma_f32 v[58:59], v[170:171], v[178:179], v[58:59] op_sel_hi:[0,1,1] neg_lo:[1,0,0] neg_hi:[1,0,0]
    v_pk_fma_f32 v[60:61], v[170:171], v[180:181], v[60:61] op_sel_hi:[0,1,1] neg_lo:[1,0,0] neg_hi:[1,0,0]
    v_pk_fma_f32 v[62:63], v[170:171], v[182:183], v[62:63] op_sel_hi:[0,1,1] neg_lo:[1,0,0] neg_hi:[1,0,0]
    v_pk_fma_f32 v[64:65], v[170:171], v[184:185], v[64:65] op_sel_hi:[0,1,1] neg_lo:[1,0,0] neg_hi:[1,0,0]
    v_pk_fma_f32 v[66:67], v[170:171], v[186:187], v[66:67] op_sel_hi:[0,1,1] neg_lo:[1,0,0] neg_hi:[1,0,0]
    v_pk_fma_f32 v[68:69], v[170:171], v[188:189], v[68:69] op_sel_hi:[0,1,1] neg_lo:[1,0,0] neg_hi:[1,0,0]
    v_pk_fma_f32 v[70:71], v[170:171], v[190:191], v[70:71] op_sel_hi:[0,1,1] neg_lo:[1,0,0] neg_hi:[1,0,0]
    s_waitcnt vmcnt(6)
    s_nop 0
    v_pk_fma_f32 v[72:73], v[202:203], v[192:193], v[72:73] op_sel_hi:[1,0,1] neg_lo:[1,0,0] neg_hi:[1,0,0]
    buffer_load_dwordx4 a[4:7], v1, s[8:11], s54 offen offset:1024 sc1
    v_pk_fma_f32 v[74:75], v[204:205], v[192:193], v[74:75] op_sel_hi:[1,0,1] neg_lo:[1,0,0] neg_hi:[1,0,0]
    v_pk_fma_f32 v[76:77], v[202:203], v[194:195], v[76:77] op_sel_hi:[1,0,1] neg_lo:[1,0,0] neg_hi:[1,0,0]
    v_pk_fma_f32 v[78:79], v[204:205], v[194:195], v[78:79] op_sel_hi:[1,0,1] neg_lo:[1,0,0] neg_hi:[1,0,0]
    v_pk_fma_f32 v[80:81], v[202:203], v[196:197], v[80:81] op_sel_hi:[1,0,1] neg_lo:[1,0,0] neg_hi:[1,0,0]
    v_pk_fma_f32 v[82:83], v[204:205], v[196:197], v[82:83] op_sel_hi:[1,0,1] neg_lo:[1,0,0] neg_hi:[1,0,0]
    v_pk_fma_f32 v[84:85], v[202:203], v[198:199], v[84:85] op_sel_hi:[1,0,1] neg_lo:[1,0,0] neg_hi:[1,0,0]
    v_pk_fma_f32 v[86:87], v[204:205], v[198:199], v[86:87] op_sel_hi:[1,0,1] neg_lo:[1,0,0] neg_hi:[1,0,0]
    v_pk_fma_f32 v[88:89], v[202:203], v[200:201], v[88:89] op_sel_hi:[1,0,1] neg_lo:[1,0,0] neg_hi:[1,0,0]
    v_pk_fma_f32 v[90:91], v[204:205], v[200:201], v[90:91] op_sel_hi:[1,0,1] neg_lo:[1,0,0] neg_hi:[1,0,0]
    s_waitcnt vmcnt(5)
    s_nop 0
    v_pk_fma_f32 v[92:93], v[206:207], v[192:193], v[92:93] op_sel_hi:[1,0,1] neg_lo:[1,0,0] neg_hi:[1,0,0]
    v_pk_fma_f32 v[94:95], v[208:209], v[192:193], v[94:95] op_sel_hi:[1,0,1] neg_lo:[1,0,0] neg_hi:[1,0,0]
    v_pk_fma_f32 v[96:97], v[206:207], v[194:195], v[96:97] op_sel_hi:[1,0,1] neg_lo:[1,0,0] neg_hi:[1,0,0]
    buffer_load_dwordx4 a[8:11], v1, s[8:11], s54 offen offset:2048 sc1
    v_pk_fma_f32 v[98:99], v[208:209], v[194:195], v[98:99] op_sel_hi:[1,0,1] neg_lo:[1,0,0] neg_hi:[1,0,0]
    v_pk_fma_f32 v[100:101], v[206:207], v[196:197], v[100:101] op_sel_hi:[1,0,1] neg_lo:[1,0,0] neg_hi:[1,0,0]
    v_pk_fma_f32 v[102:103], v[208:209], v[196:197], v[102:103] op_sel_hi:[1,0,1] neg_lo:[1,0,0] neg_hi:[1,0,0]
    v_pk_fma_f32 v[104:105], v[206:207], v[198:199], v[104:105] op_sel_hi:[1,0,1] neg_lo:[1,0,0] neg_hi:[1,0,0]
    v_pk_fma_f32 v[106:107], v[208:209], v[198:199], v[106:107] op_sel_hi:[1,0,1] neg_lo:[1,0,0] neg_hi:[1,0,0]
    v_pk_fma_f32 v[108:109], v[206:207], v[200:201], v[108:109] op_sel_hi:[1,0,1] neg_lo:[1,0,0] neg_hi:[1,0,0]
    v_pk_fma_f32 v[110:111], v[208:209], v[200:201], v[110:111] op_sel_hi:[1,0,1] neg_lo:[1,0,0] neg_hi:[1,0,0]
    v_pk_mul_f32 v[72:73], v[72:73], v[210:211]
    v_pk_mul_f32 v[74:75], v[74:75], v[212:213]
    v_pk_mul_f32 v[76:77], v[76:77], v[210:211]
    v_pk_mul_f32 v[78:79], v[78:79], v[212:213]
    v_pk_mul_f32 v[80:81], v[80:81], v[210:211]
    buffer_load_dwordx4 a[12:15], v1, s[8:11], s54 offen offset:3072 sc1
    v_pk_mul_f32 v[82:83], v[82:83], v[212:213]
    v_pk_mul_f32 v[84:85], v[84:85], v[210:211]
    v_pk_mul_f32 v[86:87], v[86:87], v[212:213]
    v_pk_mul_f32 v[88:89], v[88:89], v[210:211]
    v_pk_mul_f32 v[90:91], v[90:91], v[212:213]
    s_waitcnt vmcnt(6)
    v_pk_mul_f32 v[92:93], v[92:93], v[214:215]
    v_pk_mul_f32 v[94:95], v[94:95], v[216:217]
    v_pk_mul_f32 v[96:97], v[96:97], v[214:215]
    v_pk_mul_f32 v[98:99], v[98:99], v[216:217]
    v_pk_mul_f32 v[100:101], v[100:101], v[214:215]
    v_pk_mul_f32 v[102:103], v[102:103], v[216:217]
    v_pk_mul_f32 v[104:105], v[104:105], v[214:215]
    s_add_u32 s54, s54, 4096
    buffer_load_dwordx4 a[16:19], v1, s[8:11], s54 offen sc1
    v_pk_mul_f32 v[106:107], v[106:107], v[216:217]
    v_pk_mul_f32 v[108:109], v[108:109], v[214:215]
    v_pk_mul_f32 v[110:111], v[110:111], v[216:217]
    v_cvt_pk_bf16_f32 v112, v32, v33
    v_cvt_pk_bf16_f32 v113, v34, v35
    v_cvt_pk_bf16_f32 v114, v36, v37
    v_cvt_pk_bf16_f32 v115, v38, v39
    v_cvt_pk_bf16_f32 v116, v40, v41
    v_cvt_pk_bf16_f32 v117, v42, v43
    v_cvt_pk_bf16_f32 v118, v44, v45
    v_cvt_pk_bf16_f32 v119, v46, v47
    v_cvt_pk_bf16_f32 v120, v48, v49
    buffer_load_dwordx4 a[20:23], v1, s[8:11], s54 offen offset:1024 sc1
    v_cvt_pk_bf16_f32 v121, v50, v51
    v_mfma_f32_16x16x32_bf16 v[220:223], a[200:203], v[112:115], 0
    v_cvt_pk_bf16_f32 v124, v52, v53
    v_cvt_pk_bf16_f32 v125, v54, v55
    v_mfma_f32_16x16x32_bf16 v[224:227], a[210:213], v[112:115], 0
    v_cvt_pk_bf16_f32 v126, v56, v57
    v_cvt_pk_bf16_f32 v127, v58, v59
    v_mfma_f32_16x16x32_bf16 v[228:231], a[220:223], v[112:115], 0
    v_cvt_pk_bf16_f32 v128, v60, v61
    v_cvt_pk_bf16_f32 v129, v62, v63
    v_mfma_f32_16x16x32_bf16 v[232:235], a[230:233], v[112:115], 0
    v_cvt_pk_bf16_f32 v130, v64, v65
    buffer_load_dwordx4 a[24:27], v1, s[8:11], s54 offen offset:2048 sc1
    v_cvt_pk_bf16_f32 v131, v66, v67
    v_mfma_f32_16x16x32_bf16 v[236:239], a[240:243], v[112:115], 0
    v_cvt_pk_bf16_f32 v132, v68, v69
    v_cvt_pk_bf16_f32 v133, v70, v71
    v_mfma_f32_16x16x32_bf16 v[220:223], a[204:207], v[116:119], v[220:223]
    v_cvt_pk_bf16_f32 v136, v72, v73
    v_cvt_pk_bf16_f32 v137, v74, v75
    v_mfma_f32_16x16x32_bf16 v[224:227], a[214:217], v[116:119], v[224:227]
    v_cvt_pk_bf16_f32 v138, v92, v93
    v_cvt_pk_bf16_f32 v139, v94, v95
    v_mfma_f32_16x16x32_bf16 v[228:231], a[224:227], v[116:119], v[228:231]
    v_cvt_pk_bf16_f32 v140, v76, v77
    buffer_load_dwordx4 a[28:31], v1, s[8:11], s54 offen offset:3072 sc1
    v_cvt_pk_bf16_f32 v141, v78, v79
    v_mfma_f32_16x16x32_bf16 v[232:235], a[234:237], v[116:119], v[232:235]
    v_cvt_pk_bf16_f32 v142, v96, v97
    v_cvt_pk_bf16_f32 v143, v98, v99
    v_mfma_f32_16x16x32_bf16 v[236:239], a[244:247], v[116:119], v[236:239]
    v_cvt_pk_bf16_f32 v144, v80, v81
    v_cvt_pk_bf16_f32 v145, v82, v83
    v_mfma_f32_16x16x16_bf16 v[220:223], a[208:209], v[120:121], v[220:223]
    v_cvt_pk_bf16_f32 v146, v100, v101
    v_cvt_pk_bf16_f32 v147, v102, v103
    v_mfma_f32_16x16x16_bf16 v[224:227], a[218:219], v[120:121], v[224:227]
    v_cvt_pk_bf16_f32 v148, v84, v85
    s_add_u32 s54, s54, 4096
    buffer_load_dwordx4 a[32:35], v1, s[8:11], s54 offen sc1
    v_cvt_pk_bf16_f32 v149, v86, v87
    v_mfma_f32_16x16x16_bf16 v[228:231], a[228:229], v[120:121], v[228:231]
    v_cvt_pk_bf16_f32 v150, v104, v105
    v_cvt_pk_bf16_f32 v151, v106, v107
    v_mfma_f32_16x16x16_bf16 v[232:235], a[238:239], v[120:121], v[232:235]
    v_cvt_pk_bf16_f32 v152, v88, v89
    v_cvt_pk_bf16_f32 v153, v90, v91
    v_mfma_f32_16x16x16_bf16 v[236:239], a[248:249], v[120:121], v[236:239]
    v_cvt_pk_bf16_f32 v154, v108, v109
    v_cvt_pk_bf16_f32 v155, v110, v111
    v_mfma_f32_16x16x32_bf16 v[12:15], a[200:203], v[124:127], 0
    ds_write_b128 v251, v[136:139] offset:0
    buffer_load_dwordx4 a[36:39], v1, s[8:11], s54 offen offset:1024 sc1
    ds_write_b128 v251, v[140:143] offset:4352
    v_mfma_f32_16x16x32_bf16 v[16:19], a[210:213], v[124:127], 0
    ds_write_b128 v251, v[144:147] offset:8704
    ds_write_b128 v251, v[148:151] offset:13056
    v_mfma_f32_16x16x32_bf16 v[20:23], a[220:223], v[124:127], 0
    ds_write_b128 v251, v[152:155] offset:17408
    v_mov_b32 v10, 0x3f803f80
    v_mfma_f32_16x16x32_bf16 v[24:27], a[230:233], v[124:127], 0
    ds_write_b32 v252, v10
    v_max3_f32 v158, v220, v221, v222
    v_mfma_f32_16x16x32_bf16 v[28:31], a[240:243], v[124:127], 0
    v_min3_f32 v160, v220, v221, v222
    buffer_load_dwordx4 a[40:43], v1, s[8:11], s54 offen offset:2048 sc1
    v_max3_f32 v158, v158, v223, v224
    v_mfma_f32_16x16x32_bf16 v[12:15], a[204:207], v[128:131], v[12:15]
    v_min3_f32 v160, v160, v223, v224
    v_max3_f32 v158, v158, v225, v226
    v_mfma_f32_16x16x32_bf16 v[16:19], a[214:217], v[128:131], v[16:19]
    v_min3_f32 v160, v160, v225, v226
    v_max3_f32 v158, v158, v227, v228
    v_mfma_f32_16x16x32_bf16 v[20:23], a[224:227], v[128:131], v[20:23]
    v_min3_f32 v160, v160, v227, v228
    v_max3_f32 v158, v158, v229, v230
    v_mfma_f32_16x16x32_bf16 v[24:27], a[234:237], v[128:131], v[24:27]
    v_min3_f32 v160, v160, v229, v230
    buffer_load_dwordx4 a[44:47], v1, s[8:11], s54 offen offset:3072 sc1
    v_max3_f32 v158, v158, v231, v232
    v_mfma_f32_16x16x32_bf16 v[28:31], a[244:247], v[128:131], v[28:31]
    v_min3_f32 v160, v160, v231, v232
    v_max3_f32 v158, v158, v233, v234
    v_mfma_f32_16x16x16_bf16 v[12:15], a[208:209], v[132:133], v[12:15]
    v_min3_f32 v160, v160, v233, v234
    v_max3_f32 v158, v158, v235, v236
    v_mfma_f32_16x16x16_bf16 v[16:19], a[218:219], v[132:133], v[16:19]
    v_min3_f32 v160, v160, v235, v236
    v_max3_f32 v158, v158, v237, v238
    v_mfma_f32_16x16x16_bf16 v[20:23], a[228:229], v[132:133], v[20:23]
    v_min3_f32 v160, v160, v237, v238
    s_add_u32 s54, s54, 4096
    buffer_load_dwordx4 a[48:51], v1, s[8:11], s54 offen sc1
    v_max_f32 v158, v158, v239
    v_mfma_f32_16x16x16_bf16 v[24:27], a[238:239], v[132:133], v[24:27]
    v_min_f32_e64 v160, v160, v239
    v_mfma_f32_16x16x16_bf16 v[28:31], a[248:249], v[132:133], v[28:31]
    v_mul_f32 v156, 0x3fb8aa3b, v169
    v_mul_f32 v158, v158, v156
    v_mul_f32 v160, v160, v156
    v_pk_fma_f32 v[32:33], v[220:221], v[156:157], v[158:159] op_sel_hi:[1,0,0] neg_lo:[0,0,1] neg_hi:[0,0,1]
    v_pk_fma_f32 v[34:35], v[222:223], v[156:157], v[158:159] op_sel_hi:[1,0,0] neg_lo:[0,0,1] neg_hi:[0,0,1]
    v_pk_fma_f32 v[36:37], v[224:225], v[156:157], v[158:159] op_sel_hi:[1,0,0] neg_lo:[0,0,1] neg_hi:[0,0,1]
    v_pk_fma_f32 v[38:39], v[226:227], v[156:157], v[158:159] op_sel_hi:[1,0,0] neg_lo:[0,0,1] neg_hi:[0,0,1]
    v_pk_fma_f32 v[40:41], v[228:229], v[156:157], v[158:159] op_sel_hi:[1,0,0] neg_lo:[0,0,1] neg_hi:[0,0,1]
    buffer_load_dwordx4 a[52:55], v1, s[8:11], s54 offen offset:1024 sc1
    v_pk_fma_f32 v[42:43], v[230:231], v[156:157], v[158:159] op_sel_hi:[1,0,0] neg_lo:[0,0,1] neg_hi:[0,0,1]
    v_pk_fma_f32 v[44:45], v[232:233], v[156:157], v[158:159] op_sel_hi:[1,0,0] neg_lo:[0,0,1] neg_hi:[0,0,1]
    v_pk_fma_f32 v[46:47], v[234:235], v[156:157], v[158:159] op_sel_hi:[1,0,0] neg_lo:[0,0,1] neg_hi:[0,0,1]
    v_pk_fma_f32 v[48:49], v[236:237], v[156:157], v[158:159] op_sel_hi:[1,0,0] neg_lo:[0,0,1] neg_hi:[0,0,1]
    v_pk_fma_f32 v[50:51], v[238:239], v[156:157], v[158:159] op_sel_hi:[1,0,0] neg_lo:[0,0,1] neg_hi:[0,0,1]
    v_pk_fma_f32 v[52:53], v[220:221], v[156:157], v[160:161] op_sel_hi:[1,0,0] neg_lo:[1,0,0] neg_hi:[1,0,0]
    v_pk_fma_f32 v[54:55], v[222:223], v[156:157], v[160:161] op_sel_hi:[1,0,0] neg_lo:[1,0,0] neg_hi:[1,0,0]
    v_pk_fma_f32 v[56:57], v[224:225], v[156:157], v[160:161] op_sel_hi:[1,0,0] neg_lo:[1,0,0] neg_hi:[1,0,0]
    v_pk_fma_f32 v[58:59], v[226:227], v[156:157], v[160:161] op_sel_hi:[1,0,0] neg_lo:[1,0,0] neg_hi:[1,0,0]
    v_pk_fma_f32 v[60:61], v[228:229], v[156:157], v[160:161] op_sel_hi:[1,0,0] neg_lo:[1,0,0] neg_hi:[1,0,0]
    v_pk_fma_f32 v[62:63], v[230:231], v[156:157], v[160:161] op_sel_hi:[1,0,0] neg_lo:[1,0,0] neg_hi:[1,0,0]
    v_pk_fma_f32 v[64:65], v[232:233], v[156:157], v[160:161] op_sel_hi:[1,0,0] neg_lo:[1,0,0] neg_hi:[1,0,0]
    buffer_load_dwordx4 a[56:59], v1, s[8:11], s54 offen offset:2048 sc1
    v_pk_fma_f32 v[66:67], v[234:235], v[156:157], v[160:161] op_sel_hi:[1,0,0] neg_lo:[1,0,0] neg_hi:[1,0,0]
    v_pk_fma_f32 v[68:69], v[236:237], v[156:157], v[160:161] op_sel_hi:[1,0,0] neg_lo:[1,0,0] neg_hi:[1,0,0]
    v_pk_fma_f32 v[70:71], v[238:239], v[156:157], v[160:161] op_sel_hi:[1,0,0] neg_lo:[1,0,0] neg_hi:[1,0,0]
    v_exp_f32 v32, v32
    v_exp_f32 v33, v33
    v_exp_f32 v34, v34
    v_exp_f32 v35, v35
    v_exp_f32 v36, v36
    v_exp_f32 v37, v37
    v_exp_f32 v38, v38
    v_exp_f32 v39, v39
    v_exp_f32_e64 v40, v40
    buffer_load_dwordx4 a[60:63], v1, s[8:11], s54 offen offset:3072 sc1
    v_exp_f32 v41, v41
    v_exp_f32 v42, v42
    v_exp_f32 v43, v43
    v_exp_f32 v44, v44
    v_exp_f32 v45, v45
    v_exp_f32 v46, v46
    v_exp_f32 v47, v47
    v_exp_f32 v48, v48
    v_exp_f32 v49, v49
    v_exp_f32 v50, v50
    v_exp_f32 v51, v51
    v_exp_f32 v52, v52
    s_add_u32 s54, s54, 4096
    buffer_load_dwordx4 a[64:67], v1, s[8:11], s54 offen sc1
    v_exp_f32 v53, v53
    v_exp_f32 v54, v54
    v_exp_f32 v55, v55
    v_exp_f32 v56, v56
    v_exp_f32 v57, v57
    v_exp_f32 v58, v58
    v_exp_f32 v59, v59
    v_exp_f32 v60, v60
    v_exp_f32 v61, v61
    v_exp_f32 v62, v62
    v_exp_f32 v63, v63
    v_exp_f32 v64, v64
    buffer_load_dwordx4 a[68:71], v1, s[8:11], s54 offen offset:1024 sc1
    v_exp_f32 v65, v65
    v_exp_f32 v66, v66
    v_exp_f32 v67, v67
    v_exp_f32 v68, v68
    v_exp_f32 v69, v69
    v_exp_f32 v70, v70
    v_exp_f32_e64 v71, v71
    v_pk_add_f32 v[162:163], v[32:33], v[34:35]
    v_pk_add_f32 v[164:165], v[52:53], v[54:55]
    v_pk_add_f32 v[162:163], v[162:163], v[36:37]
    v_pk_add_f32 v[164:165], v[164:165], v[56:57]
    v_pk_add_f32 v[162:163], v[162:163], v[38:39]
    buffer_load_dwordx4 a[72:75], v1, s[8:11], s54 offen offset:2048 sc1
    v_pk_add_f32 v[164:165], v[164:165], v[58:59]
    v_pk_add_f32 v[162:163], v[162:163], v[40:41]
    v_pk_add_f32 v[164:165], v[164:165], v[60:61]
    v_pk_add_f32 v[162:163], v[162:163], v[42:43]
    v_pk_add_f32 v[164:165], v[164:165], v[62:63]
    v_pk_add_f32 v[162:163], v[162:163], v[44:45]
    v_pk_add_f32 v[164:165], v[164:165], v[64:65]
    v_pk_add_f32 v[162:163], v[162:163], v[46:47]
    v_pk_add_f32 v[164:165], v[164:165], v[66:67]
    v_pk_add_f32 v[162:163], v[162:163], v[48:49]
    v_pk_add_f32 v[164:165], v[164:165], v[68:69]
    v_pk_add_f32 v[162:163], v[162:163], v[50:51]
    buffer_load_dwordx4 a[76:79], v1, s[8:11], s54 offen offset:3072 sc1
    v_pk_add_f32 v[164:165], v[164:165], v[70:71]
    v_add_f32 v162, v162, v163
    v_add_f32 v164, v164, v165
    v_rcp_f32 v162, v162
    v_rcp_f32 v164, v164
    v_pk_mul_f32 v[32:33], v[32:33], v[162:163] op_sel_hi:[1,0]
    v_pk_mul_f32 v[34:35], v[34:35], v[162:163] op_sel_hi:[1,0]
    v_pk_mul_f32 v[36:37], v[36:37], v[162:163] op_sel_hi:[1,0]
    v_pk_mul_f32 v[38:39], v[38:39], v[162:163] op_sel_hi:[1,0]
    v_pk_mul_f32 v[40:41], v[40:41], v[162:163] op_sel_hi:[1,0]
    v_pk_mul_f32 v[42:43], v[42:43], v[162:163] op_sel_hi:[1,0]
    v_pk_mul_f32 v[44:45], v[44:45], v[162:163] op_sel_hi:[1,0]
    s_add_u32 s54, s54, 4096
    buffer_load_dwordx4 a[80:83], v1, s[8:11], s54 offen sc1
    v_pk_mul_f32 v[46:47], v[46:47], v[162:163] op_sel_hi:[1,0]
    v_pk_mul_f32 v[48:49], v[48:49], v[162:163] op_sel_hi:[1,0]
    v_pk_mul_f32 v[50:51], v[50:51], v[162:163] op_sel_hi:[1,0]
    v_pk_mul_f32 v[52:53], v[52:53], v[164:165] op_sel_hi:[1,0]
    v_pk_mul_f32 v[54:55], v[54:55], v[164:165] op_sel_hi:[1,0]
    v_pk_mul_f32 v[56:57], v[56:57], v[164:165] op_sel_hi:[1,0]
    v_pk_mul_f32 v[58:59], v[58:59], v[164:165] op_sel_hi:[1,0]
    v_pk_mul_f32 v[60:61], v[60:61], v[164:165] op_sel_hi:[1,0]
    v_pk_mul_f32 v[62:63], v[62:63], v[164:165] op_sel_hi:[1,0]
    v_pk_mul_f32 v[64:65], v[64:65], v[164:165] op_sel_hi:[1,0]
    v_pk_mul_f32 v[66:67], v[66:67], v[164:165] op_sel_hi:[1,0]
    v_pk_mul_f32 v[68:69], v[68:69], v[164:165] op_sel_hi:[1,0]
    buffer_load_dwordx4 a[84:87], v1, s[8:11], s54 offen offset:1024 sc1
    v_pk_mul_f32 v[70:71], v[70:71], v[164:165] op_sel_hi:[1,0]
    v_cvt_pk_bf16_f32 v136, v32, v33
    v_cvt_pk_bf16_f32 v137, v34, v35
    v_cvt_pk_bf16_f32 v138, v36, v37
    v_cvt_pk_bf16_f32 v139, v38, v39
    v_cvt_pk_bf16_f32 v140, v40, v41
    v_cvt_pk_bf16_f32 v141, v42, v43
    v_cvt_pk_bf16_f32 v142, v44, v45
    v_cvt_pk_bf16_f32 v143, v46, v47
    v_cvt_pk_bf16_f32 v144, v48, v49
    v_cvt_pk_bf16_f32 v145, v50, v51
    v_cvt_pk_bf16_f32 v146, v52, v53
    buffer_load_dwordx4 a[88:91], v1, s[8:11], s54 offen offset:2048 sc1
    v_cvt_pk_bf16_f32 v147, v54, v55
    v_cvt_pk_bf16_f32 v148, v56, v57
    v_cvt_pk_bf16_f32 v149, v58, v59
    v_cvt_pk_bf16_f32 v150, v60, v61
    v_cvt_pk_bf16_f32 v151, v62, v63
    v_cvt_pk_bf16_f32 v152, v64, v65
    v_cvt_pk_bf16_f32 v153, v66, v67
    v_cvt_pk_bf16_f32 v154, v68, v69
    v_cvt_pk_bf16_f32 v155, v70, v71
    ds_write_b128 v253, v[136:139] offset:0
    ds_write_b128 v253, v[140:143] offset:16
    ds_write_b128 v253, v[144:147] offset:32
    buffer_load_dwordx4 a[92:95], v1, s[8:11], s54 offen offset:3072 sc1
    ds_write_b128 v253, v[148:151] offset:48
    ds_write_b128 v253, v[152:155] offset:64
    v_max3_f32 v158, v12, v13, v14
    v_min3_f32 v160, v12, v13, v14
    v_max3_f32 v158, v158, v15, v16
    v_min3_f32 v160, v160, v15, v16
    v_max3_f32 v158, v158, v17, v18
    v_min3_f32 v160, v160, v17, v18
    v_max3_f32 v158, v158, v19, v20
    v_min3_f32 v160, v160, v19, v20
    v_max3_f32 v158, v158, v21, v22
    v_min3_f32 v160, v160, v21, v22
    s_add_u32 s54, s54, 4096
    buffer_load_dwordx4 a[96:99], v1, s[8:11], s54 offen sc1
    v_max3_f32 v158, v158, v23, v24
    v_min3_f32 v160, v160, v23, v24
    v_max3_f32 v158, v158, v25, v26
    v_min3_f32 v160, v160, v25, v26
    v_max3_f32 v158, v158, v27, v28
    v_min3_f32 v160, v160, v27, v28
    v_max3_f32 v158, v158, v29, v30
    v_min3_f32 v160, v160, v29, v30
    v_max_f32 v158, v158, v31
    v_min_f32 v160, v160, v31
    v_mul_f32 v156, 0x3fb8aa3b, v171
    v_mul_f32_e64 v158, v158, v156
    buffer_load_dwordx4 a[100:103], v1, s[8:11], s54 offen offset:1024 sc1
    v_mul_f32_e64 v160, v160, v156
    v_pk_fma_f32 v[72:73], v[12:13], v[156:157], v[158:159] op_sel_hi:[1,0,0] neg_lo:[0,0,1] neg_hi:[0,0,1]
    v_pk_fma_f32 v[74:75], v[14:15], v[156:157], v[158:159] op_sel_hi:[1,0,0] neg_lo:[0,0,1] neg_hi:[0,0,1]
    v_pk_fma_f32 v[76:77], v[16:17], v[156:157], v[158:159] op_sel_hi:[1,0,0] neg_lo:[0,0,1] neg_hi:[0,0,1]
    v_pk_fma_f32 v[78:79], v[18:19], v[156:157], v[158:159] op_sel_hi:[1,0,0] neg_lo:[0,0,1] neg_hi:[0,0,1]
    v_pk_fma_f32 v[80:81], v[20:21], v[156:157], v[158:159] op_sel_hi:[1,0,0] neg_lo:[0,0,1] neg_hi:[0,0,1]
    v_pk_fma_f32 v[82:83], v[22:23], v[156:157], v[158:159] op_sel_hi:[1,0,0] neg_lo:[0,0,1] neg_hi:[0,0,1]
    v_pk_fma_f32 v[84:85], v[24:25], v[156:157], v[158:159] op_sel_hi:[1,0,0] neg_lo:[0,0,1] neg_hi:[0,0,1]
    v_pk_fma_f32 v[86:87], v[26:27], v[156:157], v[158:159] op_sel_hi:[1,0,0] neg_lo:[0,0,1] neg_hi:[0,0,1]
    v_pk_fma_f32 v[88:89], v[28:29], v[156:157], v[158:159] op_sel_hi:[1,0,0] neg_lo:[0,0,1] neg_hi:[0,0,1]
    v_pk_fma_f32 v[90:91], v[30:31], v[156:157], v[158:159] op_sel_hi:[1,0,0] neg_lo:[0,0,1] neg_hi:[0,0,1]
    v_pk_fma_f32 v[92:93], v[12:13], v[156:157], v[160:161] op_sel_hi:[1,0,0] neg_lo:[1,0,0] neg_hi:[1,0,0]
    buffer_load_dwordx4 a[104:107], v1, s[8:11], s54 offen offset:2048 sc1
    v_pk_fma_f32 v[94:95], v[14:15], v[156:157], v[160:161] op_sel_hi:[1,0,0] neg_lo:[1,0,0] neg_hi:[1,0,0]
    v_pk_fma_f32 v[96:97], v[16:17], v[156:157], v[160:161] op_sel_hi:[1,0,0] neg_lo:[1,0,0] neg_hi:[1,0,0]
    v_pk_fma_f32 v[98:99], v[18:19], v[156:157], v[160:161] op_sel_hi:[1,0,0] neg_lo:[1,0,0] neg_hi:[1,0,0]
    v_pk_fma_f32 v[100:101], v[20:21], v[156:157], v[160:161] op_sel_hi:[1,0,0] neg_lo:[1,0,0] neg_hi:[1,0,0]
    v_pk_fma_f32 v[102:103], v[22:23], v[156:157], v[160:161] op_sel_hi:[1,0,0] neg_lo:[1,0,0] neg_hi:[1,0,0]
    v_pk_fma_f32 v[104:105], v[24:25], v[156:157], v[160:161] op_sel_hi:[1,0,0] neg_lo:[1,0,0] neg_hi:[1,0,0]
    v_pk_fma_f32 v[106:107], v[26:27], v[156:157], v[160:161] op_sel_hi:[1,0,0] neg_lo:[1,0,0] neg_hi:[1,0,0]
    v_pk_fma_f32 v[108:109], v[28:29], v[156:157], v[160:161] op_sel_hi:[1,0,0] neg_lo:[1,0,0] neg_hi:[1,0,0]
    v_pk_fma_f32 v[110:111], v[30:31], v[156:157], v[160:161] op_sel_hi:[1,0,0] neg_lo:[1,0,0] neg_hi:[1,0,0]
    v_exp_f32 v72, v72
    v_exp_f32 v73, v73
    v_exp_f32_e64 v74, v74
    buffer_load_dwordx4 a[108:111], v1, s[8:11], s54 offen offset:3072 sc1
    v_exp_f32 v75, v75
    v_exp_f32 v76, v76
    v_exp_f32 v77, v77
    v_exp_f32 v78, v78
    v_exp_f32 v79, v79
    v_exp_f32 v80, v80
    v_exp_f32 v81, v81
    v_exp_f32 v82, v82
    v_exp_f32 v83, v83
    v_exp_f32 v84, v84
    v_exp_f32 v85, v85
    v_exp_f32 v86, v86
    s_add_u32 s54, s54, 4096
    buffer_load_dwordx4 a[112:115], v1, s[8:11], s54 offen sc1
    v_exp_f32 v87, v87
    v_exp_f32 v88, v88
    v_exp_f32 v89, v89
    v_exp_f32 v90, v90
    v_exp_f32 v91, v91
    v_exp_f32 v92, v92
    v_exp_f32 v93, v93
    v_exp_f32 v94, v94
    v_exp_f32 v95, v95
    v_exp_f32 v96, v96
    v_exp_f32 v97, v97
    v_exp_f32 v98, v98
    buffer_load_dwordx4 a[116:119], v1, s[8:11], s54 offen offset:1024 sc1
    v_exp_f32 v99, v99
    v_exp_f32 v100, v100
    v_exp_f32 v101, v101
    v_exp_f32 v102, v102
    v_exp_f32 v103, v103
    v_exp_f32 v104, v104
    v_exp_f32 v105, v105
    v_exp_f32 v106, v106
    v_exp_f32 v107, v107
    v_exp_f32 v108, v108
    v_exp_f32 v109, v109
    v_exp_f32 v110, v110
    v_exp_f32_e64 v111, v111
    v_pk_add_f32 v[162:163], v[72:73], v[74:75]
    v_pk_add_f32 v[164:165], v[92:93], v[94:95]
    v_pk_add_f32 v[162:163], v[162:163], v[76:77]
    v_pk_add_f32 v[164:165], v[164:165], v[96:97]
    v_pk_add_f32 v[162:163], v[162:163], v[78:79]
    v_pk_add_f32 v[164:165], v[164:165], v[98:99]
    v_pk_add_f32 v[162:163], v[162:163], v[80:81]
    v_pk_add_f32 v[164:165], v[164:165], v[100:101]
    v_pk_add_f32 v[162:163], v[162:163], v[82:83]
    v_pk_add_f32 v[164:165], v[164:165], v[102:103]
    v_pk_add_f32 v[162:163], v[162:163], v[84:85]
    v_pk_add_f32 v[164:165], v[164:165], v[104:105]
    v_pk_add_f32 v[162:163], v[162:163], v[86:87]
    v_pk_add_f32 v[164:165], v[164:165], v[106:107]
    v_pk_add_f32 v[162:163], v[162:163], v[88:89]
    v_pk_add_f32 v[164:165], v[164:165], v[108:109]
    v_pk_add_f32 v[162:163], v[162:163], v[90:91]
    v_pk_add_f32 v[164:165], v[164:165], v[110:111]
    v_add_f32 v162, v162, v163
    v_add_f32 v164, v164, v165
    v_rcp_f32 v162, v162
    v_rcp_f32 v164, v164
    v_pk_mul_f32 v[72:73], v[72:73], v[162:163] op_sel_hi:[1,0]
    v_pk_mul_f32 v[74:75], v[74:75], v[162:163] op_sel_hi:[1,0]
    v_pk_mul_f32 v[76:77], v[76:77], v[162:163] op_sel_hi:[1,0]
    v_pk_mul_f32 v[78:79], v[78:79], v[162:163] op_sel_hi:[1,0]
    v_pk_mul_f32 v[80:81], v[80:81], v[162:163] op_sel_hi:[1,0]
    v_pk_mul_f32 v[82:83], v[82:83], v[162:163] op_sel_hi:[1,0]
    v_pk_mul_f32 v[84:85], v[84:85], v[162:163] op_sel_hi:[1,0]
    v_pk_mul_f32 v[86:87], v[86:87], v[162:163] op_sel_hi:[1,0]
    v_pk_mul_f32 v[88:89], v[88:89], v[162:163] op_sel_hi:[1,0]
    v_pk_mul_f32 v[90:91], v[90:91], v[162:163] op_sel_hi:[1,0]
    v_pk_mul_f32 v[92:93], v[92:93], v[164:165] op_sel_hi:[1,0]
    v_pk_mul_f32 v[94:95], v[94:95], v[164:165] op_sel_hi:[1,0]
    v_pk_mul_f32 v[96:97], v[96:97], v[164:165] op_sel_hi:[1,0]
    v_pk_mul_f32 v[98:99], v[98:99], v[164:165] op_sel_hi:[1,0]
    v_pk_mul_f32 v[100:101], v[100:101], v[164:165] op_sel_hi:[1,0]
    v_pk_mul_f32 v[102:103], v[102:103], v[164:165] op_sel_hi:[1,0]
    v_pk_mul_f32 v[104:105], v[104:105], v[164:165] op_sel_hi:[1,0]
    v_pk_mul_f32 v[106:107], v[106:107], v[164:165] op_sel_hi:[1,0]
    v_pk_mul_f32 v[108:109], v[108:109], v[164:165] op_sel_hi:[1,0]
    v_pk_mul_f32 v[110:111], v[110:111], v[164:165] op_sel_hi:[1,0]
    v_cvt_pk_bf16_f32 v112, v72, v73
    v_cvt_pk_bf16_f32 v113, v74, v75
    v_cvt_pk_bf16_f32 v114, v76, v77
    v_cvt_pk_bf16_f32 v115, v78, v79
    v_cvt_pk_bf16_f32 v116, v80, v81
    v_cvt_pk_bf16_f32 v117, v82, v83
    v_cvt_pk_bf16_f32 v118, v84, v85
    v_cvt_pk_bf16_f32 v119, v86, v87
    v_cvt_pk_bf16_f32 v120, v88, v89
    v_cvt_pk_bf16_f32 v121, v90, v91
    v_cvt_pk_bf16_f32 v122, v92, v93
    v_cvt_pk_bf16_f32 v123, v94, v95
    v_cvt_pk_bf16_f32 v124, v96, v97
    v_cvt_pk_bf16_f32 v125, v98, v99
    v_cvt_pk_bf16_f32 v126, v100, v101
    v_cvt_pk_bf16_f32 v127, v102, v103
    v_cvt_pk_bf16_f32 v128, v104, v105
    v_cvt_pk_bf16_f32 v129, v106, v107
    v_cvt_pk_bf16_f32 v130, v108, v109
    v_cvt_pk_bf16_f32 v131, v110, v111
    ds_write_b128 v253, v[112:115] offset:5632
    ds_write_b128 v253, v[116:119] offset:5648
    ds_write_b128 v253, v[120:123] offset:5664
    ds_write_b128 v253, v[124:127] offset:5680
    ds_write_b128 v253, v[128:131] offset:5696
    s_waitcnt lgkmcnt(0)
    s_barrier
    ds_read_b128 v[32:35], v246 offset:0
    ds_read_b128 v[36:39], v247 offset:0
    ds_read_b64_tr_b16 v[64:65], v248 offset:0
    ds_read_b64_tr_b16 v[66:67], v248 offset:5632
    ds_read_b64_tr_b16 v[68:69], v248 offset:32
    ds_read_b64_tr_b16 v[70:71], v248 offset:5664
    ds_read_b64_tr_b16 v[72:73], v248 offset:64
    ds_read_b64_tr_b16 v[74:75], v248 offset:5696
    ds_read_b128 v[40:43], v246 offset:64
    buffer_load_dwordx4 a[120:123], v1, s[8:11], s54 offen offset:2048 sc1
    ds_read_b128 v[44:47], v247 offset:64
    ds_read_b64_tr_b16 v[76:77], v248 offset:11264
    ds_read_b64_tr_b16 v[78:79], v248 offset:16896
    ds_read_b64_tr_b16 v[80:81], v248 offset:11296
    ds_read_b64_tr_b16 v[82:83], v248 offset:16928
    ds_read_b64_tr_b16 v[84:85], v248 offset:11328
    ds_read_b64_tr_b16 v[86:87], v248 offset:16960
    s_waitcnt lgkmcnt(12)
    v_mfma_f32_16x16x32_bf16 v[220:223], v[64:67], v[32:35], 0
    ds_read_b128 v[48:51], v246 offset:128
    ds_read_b128 v[52:55], v247 offset:128
    buffer_load_dwordx4 a[124:127], v1, s[8:11], s54 offen offset:3072 sc1
    v_mfma_f32_16x16x32_bf16 v[232:235], v[64:67], v[36:39], 0
    ds_read_b64_tr_b16 v[88:89], v248 offset:22528
    ds_read_b64_tr_b16 v[90:91], v248 offset:28160
    s_waitcnt lgkmcnt(14)
    v_mfma_f32_16x16x32_bf16 v[224:227], v[68:71], v[32:35], 0
    ds_read_b64_tr_b16 v[92:93], v248 offset:22560
    ds_read_b64_tr_b16 v[94:95], v248 offset:28192
    v_mfma_f32_16x16x32_bf16 v[236:239], v[68:71], v[36:39], 0
    ds_read_b64_tr_b16 v[96:97], v248 offset:22592
    ds_read_b64_tr_b16 v[98:99], v248 offset:28224
    s_waitcnt lgkmcnt(15)
    v_mfma_f32_16x16x32_bf16 v[228:231], v[72:75], v[32:35], 0
    s_add_u32 s54, s54, 4096
    buffer_load_dwordx4 a[128:131], v1, s[8:11], s54 offen sc1
    v_mfma_f32_16x16x32_bf16 v[240:243], v[72:75], v[36:39], 0
    s_waitcnt lgkmcnt(12)
    v_mfma_f32_16x16x32_bf16 v[220:223], v[76:79], v[40:43], v[220:223]
    ds_read_b128 v[56:59], v246 offset:192
    ds_read_b128 v[60:63], v247 offset:192
    v_mfma_f32_16x16x32_bf16 v[232:235], v[76:79], v[44:47], v[232:235]
    ds_read_b64_tr_b16 v[100:101], v248 offset:33792
    ds_read_b64_tr_b16 v[102:103], v248 offset:39424
    s_waitcnt lgkmcnt(14)
    v_mfma_f32_16x16x32_bf16 v[224:227], v[80:83], v[40:43], v[224:227]
    ds_read_b64_tr_b16 v[104:105], v248 offset:33824
    ds_read_b64_tr_b16 v[106:107], v248 offset:39456
    buffer_load_dwordx4 a[132:135], v1, s[8:11], s54 offen offset:1024 sc1
    v_mfma_f32_16x16x32_bf16 v[236:239], v[80:83], v[44:47], v[236:239]
    ds_read_b64_tr_b16 v[108:109], v248 offset:33856
    ds_read_b64_tr_b16 v[110:111], v248 offset:39488
    s_waitcnt lgkmcnt(15)
    v_mfma_f32_16x16x32_bf16 v[228:231], v[84:87], v[40:43], v[228:231]
    v_mfma_f32_16x16x32_bf16 v[240:243], v[84:87], v[44:47], v[240:243]
    s_waitcnt lgkmcnt(12)
    v_mfma_f32_16x16x32_bf16 v[220:223], v[88:91], v[48:51], v[220:223]
    v_mfma_f32_16x16x32_bf16 v[232:235], v[88:91], v[52:55], v[232:235]
    s_waitcnt lgkmcnt(10)
    v_mfma_f32_16x16x32_bf16 v[224:227], v[92:95], v[48:51], v[224:227]
    v_mfma_f32_16x16x32_bf16 v[236:239], v[92:95], v[52:55], v[236:239]
    s_waitcnt lgkmcnt(8)
    v_mfma_f32_16x16x32_bf16 v[228:231], v[96:99], v[48:51], v[228:231]
    v_mfma_f32_16x16x32_bf16 v[240:243], v[96:99], v[52:55], v[240:243]
    s_waitcnt lgkmcnt(4)
    v_mfma_f32_16x16x32_bf16 v[220:223], v[100:103], v[56:59], v[220:223]
    v_mfma_f32_16x16x32_bf16 v[232:235], v[100:103], v[60:63], v[232:235]
    s_waitcnt lgkmcnt(2)
    v_mfma_f32_16x16x32_bf16 v[224:227], v[104:107], v[56:59], v[224:227]
    v_mfma_f32_16x16x32_bf16 v[236:239], v[104:107], v[60:63], v[236:239]
    s_waitcnt lgkmcnt(0)
    v_mfma_f32_16x16x32_bf16 v[228:231], v[108:111], v[56:59], v[228:231]
    v_mfma_f32_16x16x32_bf16 v[240:243], v[108:111], v[60:63], v[240:243]
    s_nop 0
    v_cvt_pk_bf16_f32 v220, v220, v221
    v_cvt_pk_bf16_f32 v221, v222, v223
    s_nop 0
    v_cvt_pk_bf16_f32 v224, v224, v225
    v_cvt_pk_bf16_f32 v225, v226, v227
    s_nop 0
    s_nop 0
    v_cvt_pk_bf16_f32 v228, v228, v229
    v_cvt_pk_bf16_f32 v229, v230, v231
    v_cvt_pk_bf16_f32 v232, v232, v233
    v_cvt_pk_bf16_f32 v233, v234, v235
    v_cvt_pk_bf16_f32 v236, v236, v237
    v_cvt_pk_bf16_f32 v237, v238, v239
    v_cvt_pk_bf16_f32 v240, v240, v241
    v_cvt_pk_bf16_f32 v241, v242, v243
    v_permlane32_swap_b32 v220, v221
    v_permlane32_swap_b32 v224, v225
    v_permlane32_swap_b32 v228, v229
    v_permlane32_swap_b32 v232, v233
    v_permlane32_swap_b32 v236, v237
    v_permlane32_swap_b32 v240, v241
    buffer_atomic_pk_add_bf16 v220, v249, s[8:11], s48 offen offset:0
    buffer_atomic_pk_add_bf16 v221, v249, s[8:11], s48 offen offset:384
    buffer_atomic_pk_add_bf16 v224, v249, s[8:11], s48 offen offset:768
    buffer_atomic_pk_add_bf16 v225, v249, s[8:11], s48 offen offset:1152
    buffer_atomic_pk_add_bf16 v228, v249, s[8:11], s48 offen offset:1536
    buffer_atomic_pk_add_bf16 v232, v250, s[8:11], s48 offen offset:256
    buffer_atomic_pk_add_bf16 v233, v250, s[8:11], s48 offen offset:640
    buffer_atomic_pk_add_bf16 v236, v250, s[8:11], s48 offen offset:1024
    buffer_atomic_pk_add_bf16 v237, v250, s[8:11], s48 offen offset:1408
    buffer_atomic_pk_add_bf16 v240, v250, s[8:11], s48 offen offset:1792
    buffer_load_dwordx4 a[136:139], v1, s[8:11], s54 offen offset:2048 sc1
    buffer_load_dwordx4 a[140:143], v1, s[8:11], s54 offen offset:3072 sc1
    s_add_u32 s54, s54, 4096
    buffer_load_dwordx4 a[144:147], v1, s[8:11], s54 offen sc1
    buffer_load_dwordx4 a[148:151], v1, s[8:11], s54 offen offset:1024 sc1
    buffer_load_dwordx4 a[152:155], v1, s[8:11], s54 offen offset:2048 sc1
    buffer_load_dwordx4 a[156:159], v1, s[8:11], s54 offen offset:3072 sc1
    s_add_u32 s54, s54, 4096
    buffer_load_dwordx4 a[160:163], v1, s[8:11], s54 offen sc1
    buffer_load_dwordx4 a[164:167], v1, s[8:11], s54 offen offset:1024 sc1
    buffer_load_dwordx4 a[168:171], v1, s[8:11], s54 offen offset:2048 sc1
    buffer_load_dwordx4 a[172:175], v1, s[8:11], s54 offen offset:3072 sc1
    s_add_u32 s54, s54, 4096
    buffer_load_dwordx4 a[176:179], v1, s[8:11], s54 offen sc1
    buffer_load_dwordx4 a[180:183], v1, s[8:11], s54 offen offset:1024 sc1
    buffer_load_dwordx4 a[184:187], v1, s[8:11], s54 offen offset:2048 sc1
    buffer_load_dwordx4 a[188:191], v1, s[8:11], s54 offen offset:3072 sc1
    s_add_u32 s54, s54, 4096
    buffer_load_dwordx4 a[192:195], v1, s[8:11], s54 offen sc1
    buffer_load_dwordx4 a[196:199], v1, s[8:11], s54 offen offset:1024 sc1
    s_lshl_b32 s30, s41, 7
    s_add_u32 s30, s30, s40
    s_add_u32 s30, s30, 22675456
    v_lshrrev_b32 v4, 5, v2
    v_lshlrev_b32 v3, 11, v2
    v_lshl_add_u32 v3, v4, 28, v3
    v_mov_b32_e64 v4, 1
    s_waitcnt vmcnt(16)
    s_barrier
    s_cmp_lg_u32 s24, 0
    s_cbranch_scc1 sig_6
    buffer_store_byte v4, v3, s[8:11], s30 offen sc1
sig_6:
    s_lshl_b32 s30, s25, 5
    s_add_u32 s30, s30, s26
    s_lshl_b32 s30, s30, 7
    s_add_u32 s30, s30, 22544384
    s_lshl_b32 s31, s25, 2
    s_lshr_b32 s28, s26, 3
    s_add_u32 s31, s31, s28
    s_lshl_b32 s31, s31, 11
    s_add_u32 s31, s31, 22676480
    s_cmp_lg_u32 s24, 1
    s_cbranch_scc1 sp_7_d
    s_nop 0
    s_mov_b32 s29, 262144
sp_7:
    s_load_dwordx4 s[64:67], s[84:85], s31 offset:0 glc
    s_load_dwordx4 s[68:71], s[84:85], s31 offset:128 glc
    s_load_dwordx4 s[72:75], s[84:85], s31 offset:256 glc
    s_load_dwordx4 s[76:79], s[84:85], s31 offset:384 glc
    s_waitcnt lgkmcnt(0)
    s_and_b32 s64, s64, s65
    s_and_b32 s64, s64, s66
    s_and_b32 s64, s64, s67
    s_and_b32 s64, s64, s68
    s_and_b32 s64, s64, s69
    s_and_b32 s64, s64, s70
    s_and_b32 s64, s64, s71
    s_and_b32 s64, s64, s72
    s_and_b32 s64, s64, s73
    s_and_b32 s64, s64, s74
    s_and_b32 s64, s64, s75
    s_and_b32 s64, s64, s76
    s_and_b32 s64, s64, s77
    s_and_b32 s64, s64, s78
    s_and_b32 s64, s64, s79
    s_cmp_eq_u32 s64, 0x01010101
    s_cbranch_scc1 sp_7_d
    s_sleep 2
    s_sub_u32 s29, s29, 1
    s_cbranch_scc0 sp_7
sp_7_d:
    s_cmp_lg_u32 s24, 0
    s_cbranch_scc1 sp_8_d
    s_mov_b32 s29, 262144
sp_8:
    s_load_dwordx4 s[64:67], s[84:85], s30 offset:0 glc
    s_waitcnt lgkmcnt(0)
    s_and_b32 s64, s64, s65
    s_and_b32 s64, s64, s66
    s_and_b32 s64, s64, s67
    s_cmp_eq_u32 s64, 0x01010101
    s_cbranch_scc1 sp_8_d
    s_sleep 2
    s_sub_u32 s29, s29, 1
    s_cbranch_scc0 sp_8
sp_8_d:
    s_barrier
    s_mov_b32 s12, s80
    s_mov_b32 s13, s81
    s_mov_b32 s14, 2621440
    s_mov_b32 s15, 0x20000
    s_branch L_join
L_notkv:
    s_cmp_ge_u32 s26, 24
    s_cbranch_scc1 L_side
    s_bfe_u32 s30, s26, 0x20001
    s_and_b32 s31, s26, 1
    s_and_b32 s32, s25, 1
    s_lshl_b32 s32, s32, 1
    s_add_u32 s41, s31, s32
    s_lshr_b32 s31, s25, 1
    s_lshl_b32 s31, s31, 2
    s_add_u32 s40, s30, s31
    s_lshl_b32 s30, s40, 2
    s_add_u32 s30, s30, s24
    s_mul_i32 s42, s30, 40960
    s_mul_i32 s43, s41, 320
    s_lshl_b32 s44, s24, 12
    s_lshr_b32 s31, s24, 1
    s_mul_i32 s31, s31, 10272
    s_and_b32 s32, s24, 1
    s_mul_i32 s32, s32, 5120
    s_add_u32 s31, s31, s32
    s_add_u32 s45, s31, 16384
    s_lshr_b32 s32, s25, 1
    s_mul_i32 s46, s32, 655360
    s_and_b32 s32, s25, 1
    s_mul_i32 s47, s32, 640
    s_mov_b32 m0, s44
    s_nop 0
    buffer_load_dwordx4 v12, s[16:19], s42 offen lds
    buffer_load_dwordx4 v13, s[16:19], s42 offen offset:1024 lds
    buffer_load_dwordx4 v14, s[16:19], s42 offen offset:2048 lds
    buffer_load_dwordx4 v15, s[16:19], s42 offen offset:3072 lds
    s_mov_b32 m0, s45
    s_nop 0
    s_nop 0
    buffer_load_dwordx4 v24, s[20:23], s43 offen lds
    buffer_load_dwordx4 v25, s[20:23], s43 offen offset:1024 lds
    buffer_load_dwordx4 v26, s[20:23], s43 offen offset:2048 lds
    buffer_load_dwordx4 v27, s[20:23], s43 offen offset:3072 lds
    s_add_u32 m0, s45, 4096
    s_add_u32 s42, s42, 128
    buffer_load_dwordx4 v28, s[20:23], s43 offen lds
    s_add_u32 s43, s43, 245760
    s_add_u32 m0, s44, 36896
    s_nop 0
    s_nop 0
    buffer_load_dwordx4 v12, s[16:19], s42 offen lds
    buffer_load_dwordx4 v13, s[16:19], s42 offen offset:1024 lds
    buffer_load_dwordx4 v14, s[16:19], s42 offen offset:2048 lds
    buffer_load_dwordx4 v15, s[16:19], s42 offen offset:3072 lds
    s_add_u32 m0, s45, 36896
    s_nop 0
    s_nop 0
    buffer_load_dwordx4 v24, s[20:23], s43 offen lds
    buffer_load_dwordx4 v25, s[20:23], s43 offen offset:1024 lds
    buffer_load_dwordx4 v26, s[20:23], s43 offen offset:2048 lds
    buffer_load_dwordx4 v27, s[20:23], s43 offen offset:3072 lds
    s_add_u32 m0, s45, 40992
    s_add_u32 s42, s42, 128
    buffer_load_dwordx4 v28, s[20:23], s43 offen lds
    s_add_u32 s43, s43, 245760
    s_and_b32 s30, s26, 3
    s_lshl_b32 s31, s30, 2
    s_add_u32 s31, s31, s24
    s_mul_i32 s54, s31, 51200
    s_lshr_b32 s32, s25, 1
    s_lshl_b32 s32, s32, 4
    s_add_u32 s32, s32, s31
    s_mul_i32 s27, s32, 61440
    s_lshr_b32 s32, s32, 2
    s_mul_i32 s55, s32, 192
    s_lshr_b32 s32, s24, 1
    s_mul_i32 s32, s32, 983040
    s_add_u32 s55, s55, s32
    s_add_u32 s55, s27, 1048576
    s_and_b32 s32, s25, 1
    s_lshl_b32 s32, s32, 4
    s_add_u32 s32, s32, s31
    s_mul_i32 s56, s32, 61440
    s_add_u32 s56, s56, 5242880
    s_mov_b32 s12, s68
    s_mov_b32 s13, s69
    s_mov_b32 s14, 25600
    s_mov_b32 s15, 0x20000
    s_mul_i32 s30, s41, 6400
    s_lshl_b32 s31, s24, 11
    s_add_u32 s30, s30, s31
    s_add_u32 m0, s31, 147584
    s_nop 0
    buffer_load_dwordx4 v1, s[12:15], s30 offen lds
    s_cmp_eq_u32 s24, 3
    s_cbranch_scc1 wp_10
    buffer_load_dwordx4 v1, s[12:15], s30 offen offset:1024 lds
wp_10:
    v_mov_b32 v32, 0
    v_mov_b32 v33, 0
    v_mov_b32 v34, 0
    v_mov_b32_e64 v35, 0
    v_add_u32 v8, 154752, v1
    ds_write_b128 v8, v[32:35]
    v_and_b32 v8, 15, v2
    v_lshrrev_b32 v9, 4, v2
    v_lshrrev_b32 v10, 1, v8
    v_xor_b32 v10, v10, v9
    v_lshlrev_b32_e64 v10, 4, v10
    v_lshl_add_u32 v10, v8, 7, v10
    s_lshr_b32 s30, s24, 1
    s_lshl_b32 s30, s30, 13
    v_add_u32 v16, s30, v10
    v_xor_b32 v18, 64, v16
    v_add_u32 v17, 73792, v16
    v_add_u32 v19, 73792, v18
    v_and_b32_e64 v10, 1, v9
    v_mul_u32_u24 v10, 10272, v10
    v_lshrrev_b32 v11, 5, v2
    v_lshlrev_b32 v11, 3, v11
    v_bfe_u32 v8, v2, 2, 2
    v_add_u32_e64 v11, v11, v8
    v_mul_u32_u24 v11, 320, v11
    v_add_u32 v10, v10, v11
    v_and_b32 v11, 3, v2
    v_mul_u32_u24 v20, 40, v11
    v_add_u32 v20, v20, v10
    v_add_u32 v22, 160, v20
    s_and_b32 s30, s24, 1
    s_mul_i32 s30, s30, 160
    v_add_u32 v20, s30, v20
    v_add_u32 v21, 73792, v20
    v_add_u32 v23, 73792, v22
    s_lshl_b32 s50, s40, 2
    s_and_b32 s51, s24, 2
    s_add_u32 s50, s50, s51
    s_lshl_b32 s50, s50, 7
    s_add_u32 s50, s50, 22151168
    s_add_u32 s51, s50, 8192
    v_and_b32 v7, 15, v2
    v_lshlrev_b32 v7, 2, v7
    v_lshrrev_b32_e64 v218, 4, v2
    v_mul_u32_u24 v219, 80, v218
    v_mov_b32 v254, v219
    v_lshlrev_b32 v218, 4, v218
    s_mul_i32 s52, s41, 640
    s_add_u32 s52, s52, 22183936
    s_and_b32 s53, s24, 1
    s_mul_i32 s53, s53, 320
    s_add_u32 s52, s52, s53
    s_add_u32 s53, s52, 7680
    v_lshrrev_b32 v8, 4, v2
    v_and_b32_e64 v9, 3, v2
    v_cmp_eq_u32 vcc, v8, v9
    v_mul_u32_u24 v8, 800, v8
    v_bfe_u32 v9, v2, 2, 2
    v_mul_u32_u24 v9, 40, v9
    v_add_u32 v8, v8, v9
    v_add_u32 v8, 147584, v8
    s_and_b32 s30, s24, 1
    s_mul_i32 s30, s30, 3200
    v_add_u32 v8, s30, v8
    v_mov_b32 v9, 154752
    v_cndmask_b32 v29, v9, v8, vcc
    v_add_u32 v8, 3200, v8
    v_cndmask_b32 v6, v9, v8, vcc
    s_waitcnt vmcnt(10)
    s_waitcnt lgkmcnt(0)
    s_barrier
    s_nop 0
    ds_read_b128 v[132:135], v16 offset:0
    ds_read_b128 v[136:139], v16 offset:2048
    ds_read_b128 v[140:143], v16 offset:4096
    ds_read_b128 v[144:147], v16 offset:6144
    ds_read_b64_tr_b16 v[112:113], v20 offset:16384
    ds_read_b64_tr_b16 v[114:115], v20 offset:17664
    ds_read_b64_tr_b16 v[116:117], v20 offset:16392
    ds_read_b64_tr_b16 v[118:119], v20 offset:17672
    ds_read_b64_tr_b16 v[120:121], v20 offset:16400
    ds_read_b64_tr_b16 v[122:123], v20 offset:17680
    ds_read_b64_tr_b16 v[124:125], v20 offset:16408
    ds_read_b64_tr_b16 v[126:127], v20 offset:17688
    ds_read_b64_tr_b16 v[128:129], v20 offset:16416
    ds_read_b64_tr_b16 v[130:131], v20 offset:17696
    s_waitcnt lgkmcnt(4)
    v_mfma_f32_16x16x32_bf16 v[32:35], v[112:115], v[132:135], 0
    ds_read_b128 v[148:151], v18 offset:0
    v_mfma_f32_16x16x32_bf16 v[52:55], v[112:115], v[136:139], 0
    s_add_u32 m0, s44, 73792
    s_nop 0
    buffer_load_dwordx4 v12, s[16:19], s42 offen lds
    v_mfma_f32_16x16x32_bf16 v[72:75], v[112:115], v[140:143], 0
    ds_read_b128 v[152:155], v18 offset:2048
    v_mfma_f32_16x16x32_bf16 v[92:95], v[112:115], v[144:147], 0
    ds_read_b64_tr_b16 v[112:113], v20 offset:21504
    v_mfma_f32_16x16x32_bf16 v[36:39], v[116:119], v[132:135], 0
    ds_read_b64_tr_b16 v[114:115], v20 offset:22784
    v_mfma_f32_16x16x32_bf16 v[56:59], v[116:119], v[136:139], 0
    ds_read_b128 v[156:159], v18 offset:4096
    v_mfma_f32_16x16x32_bf16 v[76:79], v[116:119], v[140:143], 0
    ds_read_b128 v[160:163], v18 offset:6144
    v_mfma_f32_16x16x32_bf16 v[96:99], v[116:119], v[144:147], 0
    ds_read_b64_tr_b16 v[116:117], v20 offset:21512
    v_mfma_f32_16x16x32_bf16 v[40:43], v[120:123], v[132:135], 0
    ds_read_b64_tr_b16 v[118:119], v20 offset:22792
    v_mfma_f32_16x16x32_bf16 v[60:63], v[120:123], v[136:139], 0
    buffer_load_dwordx4 v13, s[16:19], s42 offen offset:1024 lds
    buffer_load_dwordx4 v14, s[16:19], s42 offen offset:2048 lds
    v_mfma_f32_16x16x32_bf16 v[80:83], v[120:123], v[140:143], 0
    buffer_load_dwordx4 v15, s[16:19], s42 offen offset:3072 lds
    s_add_u32 m0, s45, 73792
    v_mfma_f32_16x16x32_bf16 v[100:103], v[120:123], v[144:147], 0
    s_waitcnt lgkmcnt(8)
    ds_read_b64_tr_b16 v[120:121], v20 offset:21520
    v_mfma_f32_16x16x32_bf16 v[44:47], v[124:127], v[132:135], 0
    ds_read_b64_tr_b16 v[122:123], v20 offset:22800
    v_mfma_f32_16x16x32_bf16 v[64:67], v[124:127], v[136:139], 0
    buffer_load_dwordx4 v24, s[20:23], s43 offen lds
    buffer_load_dwordx4 v25, s[20:23], s43 offen offset:1024 lds
    v_mfma_f32_16x16x32_bf16 v[84:87], v[124:127], v[140:143], 0
    buffer_load_dwordx4 v26, s[20:23], s43 offen offset:2048 lds
    buffer_load_dwordx4 v27, s[20:23], s43 offen offset:3072 lds
    v_mfma_f32_16x16x32_bf16 v[104:107], v[124:127], v[144:147], 0
    ds_read_b64_tr_b16 v[124:125], v20 offset:21528
    v_mfma_f32_16x16x32_bf16 v[48:51], v[128:131], v[132:135], 0
    ds_read_b64_tr_b16 v[126:127], v20 offset:22808
    v_mfma_f32_16x16x32_bf16 v[68:71], v[128:131], v[136:139], 0
    s_add_u32 m0, s45, 77888
    s_add_u32 s42, s42, 128
    v_mfma_f32_16x16x32_bf16 v[88:91], v[128:131], v[140:143], 0
    buffer_load_dwordx4 v28, s[20:23], s43 offen lds
    s_add_u32 s43, s43, 245760
    v_mfma_f32_16x16x32_bf16 v[108:111], v[128:131], v[144:147], 0
    ds_read_b64_tr_b16 v[128:129], v20 offset:21536
    s_waitcnt lgkmcnt(3)
    v_mfma_f32_16x16x32_bf16 v[32:35], v[112:115], v[148:151], v[32:35]
    ds_read_b64_tr_b16 v[130:131], v20 offset:22816
    v_mfma_f32_16x16x32_bf16 v[52:55], v[112:115], v[152:155], v[52:55]
    s_add_u32 m0, s44, 110688
    s_nop 0
    buffer_load_dwordx4 v12, s[16:19], s42 offen lds
    v_mfma_f32_16x16x32_bf16 v[72:75], v[112:115], v[156:159], v[72:75]
    buffer_load_dwordx4 v13, s[16:19], s42 offen offset:1024 lds
    buffer_load_dwordx4 v14, s[16:19], s42 offen offset:2048 lds
    v_mfma_f32_16x16x32_bf16 v[92:95], v[112:115], v[160:163], v[92:95]
    buffer_load_dwordx4 v15, s[16:19], s42 offen offset:3072 lds
    s_add_u32 m0, s45, 110688
    v_mfma_f32_16x16x32_bf16 v[36:39], v[116:119], v[148:151], v[36:39]
    buffer_load_dwordx4 v24, s[20:23], s43 offen lds
    buffer_load_dwordx4 v25, s[20:23], s43 offen offset:1024 lds
    v_mfma_f32_16x16x32_bf16 v[56:59], v[116:119], v[152:155], v[56:59]
    buffer_load_dwordx4 v26, s[20:23], s43 offen offset:2048 lds
    buffer_load_dwordx4 v27, s[20:23], s43 offen offset:3072 lds
    v_mfma_f32_16x16x32_bf16 v[76:79], v[116:119], v[156:159], v[76:79]
    s_waitcnt vmcnt(18)
    s_waitcnt lgkmcnt(0)
    s_barrier
    v_mfma_f32_16x16x32_bf16 v[96:99], v[116:119], v[160:163], v[96:99]
    ds_read_b128 v[132:135], v16 offset:36896
    v_mfma_f32_16x16x32_bf16 v[40:43], v[120:123], v[148:151], v[40:43]
    ds_read_b64_tr_b16 v[112:113], v20 offset:53280
    v_mfma_f32_16x16x32_bf16 v[60:63], v[120:123], v[152:155], v[60:63]
    ds_read_b64_tr_b16 v[114:115], v20 offset:54560
    v_mfma_f32_16x16x32_bf16 v[80:83], v[120:123], v[156:159], v[80:83]
    ds_read_b64_tr_b16 v[116:117], v20 offset:53288
    v_mfma_f32_16x16x32_bf16 v[100:103], v[120:123], v[160:163], v[100:103]
    ds_read_b64_tr_b16 v[118:119], v20 offset:54568
    v_mfma_f32_16x16x32_bf16 v[44:47], v[124:127], v[148:151], v[44:47]
    ds_read_b128 v[136:139], v16 offset:38944
    v_mfma_f32_16x16x32_bf16 v[64:67], v[124:127], v[152:155], v[64:67]
    ds_read_b128 v[140:143], v16 offset:40992
    v_mfma_f32_16x16x32_bf16 v[84:87], v[124:127], v[156:159], v[84:87]
    ds_read_b64_tr_b16 v[120:121], v20 offset:53296
    v_mfma_f32_16x16x32_bf16 v[104:107], v[124:127], v[160:163], v[104:107]
    ds_read_b64_tr_b16 v[122:123], v20 offset:54576
    v_mfma_f32_16x16x32_bf16 v[48:51], v[128:131], v[148:151], v[48:51]
    ds_read_b128 v[144:147], v16 offset:43040
    v_mfma_f32_16x16x32_bf16 v[68:71], v[128:131], v[152:155], v[68:71]
    ds_read_b64_tr_b16 v[124:125], v20 offset:53304
    v_mfma_f32_16x16x32_bf16 v[88:91], v[128:131], v[156:159], v[88:91]
    ds_read_b64_tr_b16 v[126:127], v20 offset:54584
    v_mfma_f32_16x16x32_bf16 v[108:111], v[128:131], v[160:163], v[108:111]
    ds_read_b64_tr_b16 v[128:129], v20 offset:53312
    s_waitcnt lgkmcnt(3)
    v_mfma_f32_16x16x32_bf16 v[32:35], v[112:115], v[132:135], v[32:35]
    ds_read_b64_tr_b16 v[130:131], v20 offset:54592
    v_mfma_f32_16x16x32_bf16 v[52:55], v[112:115], v[136:139], v[52:55]
    ds_read_b128 v[148:151], v18 offset:36896
    v_mfma_f32_16x16x32_bf16 v[72:75], v[112:115], v[140:143], v[72:75]
    ds_read_b128 v[152:155], v18 offset:38944
    v_mfma_f32_16x16x32_bf16 v[92:95], v[112:115], v[144:147], v[92:95]
    ds_read_b64_tr_b16 v[112:113], v20 offset:58400
    v_mfma_f32_16x16x32_bf16 v[36:39], v[116:119], v[132:135], v[36:39]
    ds_read_b64_tr_b16 v[114:115], v20 offset:59680
    v_mfma_f32_16x16x32_bf16 v[56:59], v[116:119], v[136:139], v[56:59]
    ds_read_b128 v[156:159], v18 offset:40992
    v_mfma_f32_16x16x32_bf16 v[76:79], v[116:119], v[140:143], v[76:79]
    ds_read_b128 v[160:163], v18 offset:43040
    v_mfma_f32_16x16x32_bf16 v[96:99], v[116:119], v[144:147], v[96:99]
    ds_read_b64_tr_b16 v[116:117], v20 offset:58408
    v_mfma_f32_16x16x32_bf16 v[40:43], v[120:123], v[132:135], v[40:43]
    ds_read_b64_tr_b16 v[118:119], v20 offset:59688
    v_mfma_f32_16x16x32_bf16 v[60:63], v[120:123], v[136:139], v[60:63]
    s_add_u32 m0, s45, 114784
    s_add_u32 s42, s42, 128
    v_mfma_f32_16x16x32_bf16 v[80:83], v[120:123], v[140:143], v[80:83]
    buffer_load_dwordx4 v28, s[20:23], s43 offen lds
    s_add_u32 s43, s43, 245760
    v_mfma_f32_16x16x32_bf16 v[100:103], v[120:123], v[144:147], v[100:103]
    s_waitcnt lgkmcnt(8)
    ds_read_b64_tr_b16 v[120:121], v20 offset:58416
    v_mfma_f32_16x16x32_bf16 v[44:47], v[124:127], v[132:135], v[44:47]
    ds_read_b64_tr_b16 v[122:123], v20 offset:59696
    v_mfma_f32_16x16x32_bf16 v[64:67], v[124:127], v[136:139], v[64:67]
    s_mov_b32 m0, s44
    s_nop 0
    buffer_load_dwordx4 v12, s[16:19], s42 offen lds
    v_mfma_f32_16x16x32_bf16 v[84:87], v[124:127], v[140:143], v[84:87]
    buffer_load_dwordx4 v13, s[16:19], s42 offen offset:1024 lds
    buffer_load_dwordx4 v14, s[16:19], s42 offen offset:2048 lds
    v_mfma_f32_16x16x32_bf16 v[104:107], v[124:127], v[144:147], v[104:107]
    ds_read_b64_tr_b16 v[124:125], v20 offset:58424
    v_mfma_f32_16x16x32_bf16 v[48:51], v[128:131], v[132:135], v[48:51]
    ds_read_b64_tr_b16 v[126:127], v20 offset:59704
    v_mfma_f32_16x16x32_bf16 v[68:71], v[128:131], v[136:139], v[68:71]
    buffer_load_dwordx4 v15, s[16:19], s42 offen offset:3072 lds
    s_mov_b32 m0, s45
    v_mfma_f32_16x16x32_bf16 v[88:91], v[128:131], v[140:143], v[88:91]
    buffer_load_dwordx4 v24, s[20:23], s43 offen lds
    buffer_load_dwordx4 v25, s[20:23], s43 offen offset:1024 lds
    v_mfma_f32_16x16x32_bf16 v[108:111], v[128:131], v[144:147], v[108:111]
    ds_read_b64_tr_b16 v[128:129], v20 offset:58432
    s_waitcnt lgkmcnt(3)
    v_mfma_f32_16x16x32_bf16 v[32:35], v[112:115], v[148:151], v[32:35]
    ds_read_b64_tr_b16 v[130:131], v20 offset:59712
    v_mfma_f32_16x16x32_bf16 v[52:55], v[112:115], v[152:155], v[52:55]
    buffer_load_dwordx4 v26, s[20:23], s43 offen offset:2048 lds
    buffer_load_dwordx4 v27, s[20:23], s43 offen offset:3072 lds
    v_mfma_f32_16x16x32_bf16 v[72:75], v[112:115], v[156:159], v[72:75]
    s_add_u32 m0, s45, 4096
    s_add_u32 s42, s42, 128
    v_mfma_f32_16x16x32_bf16 v[92:95], v[112:115], v[160:163], v[92:95]
    buffer_load_dwordx4 v28, s[20:23], s43 offen lds
    s_add_u32 s43, s43, 245760
    v_mfma_f32_16x16x32_bf16 v[36:39], v[116:119], v[148:151], v[36:39]
    v_mfma_f32_16x16x32_bf16 v[56:59], v[116:119], v[152:155], v[56:59]
    v_mfma_f32_16x16x32_bf16 v[76:79], v[116:119], v[156:159], v[76:79]
    s_waitcnt vmcnt(18)
    s_waitcnt lgkmcnt(0)
    s_barrier
    v_mfma_f32_16x16x32_bf16 v[96:99], v[116:119], v[160:163], v[96:99]
    ds_read_b128 v[132:135], v17 offset:0
    v_mfma_f32_16x16x32_bf16 v[40:43], v[120:123], v[148:151], v[40:43]
    ds_read_b64_tr_b16 v[112:113], v21 offset:16384
    v_mfma_f32_16x16x32_bf16 v[60:63], v[120:123], v[152:155], v[60:63]
    ds_read_b64_tr_b16 v[114:115], v21 offset:17664
    v_mfma_f32_16x16x32_bf16 v[80:83], v[120:123], v[156:159], v[80:83]
    ds_read_b64_tr_b16 v[116:117], v21 offset:16392
    v_mfma_f32_16x16x32_bf16 v[100:103], v[120:123], v[160:163], v[100:103]
    ds_read_b64_tr_b16 v[118:119], v21 offset:17672
    v_mfma_f32_16x16x32_bf16 v[44:47], v[124:127], v[148:151], v[44:47]
    ds_read_b128 v[136:139], v17 offset:2048
    v_mfma_f32_16x16x32_bf16 v[64:67], v[124:127], v[152:155], v[64:67]
    ds_read_b128 v[140:143], v17 offset:4096
    v_mfma_f32_16x16x32_bf16 v[84:87], v[124:127], v[156:159], v[84:87]
    ds_read_b64_tr_b16 v[120:121], v21 offset:16400
    v_mfma_f32_16x16x32_bf16 v[104:107], v[124:127], v[160:163], v[104:107]
    ds_read_b64_tr_b16 v[122:123], v21 offset:17680
    v_mfma_f32_16x16x32_bf16 v[48:51], v[128:131], v[148:151], v[48:51]
    ds_read_b128 v[144:147], v17 offset:6144
    v_mfma_f32_16x16x32_bf16 v[68:71], v[128:131], v[152:155], v[68:71]
    ds_read_b64_tr_b16 v[124:125], v21 offset:16408
    v_mfma_f32_16x16x32_bf16 v[88:91], v[128:131], v[156:159], v[88:91]
    ds_read_b64_tr_b16 v[126:127], v21 offset:17688
    v_mfma_f32_16x16x32_bf16 v[108:111], v[128:131], v[160:163], v[108:111]
    ds_read_b64_tr_b16 v[128:129], v21 offset:16416
    s_waitcnt lgkmcnt(3)
    v_mfma_f32_16x16x32_bf16 v[32:35], v[112:115], v[132:135], v[32:35]
    ds_read_b64_tr_b16 v[130:131], v21 offset:17696
    v_mfma_f32_16x16x32_bf16 v[52:55], v[112:115], v[136:139], v[52:55]
    ds_read_b128 v[148:151], v19 offset:0
    v_mfma_f32_16x16x32_bf16 v[72:75], v[112:115], v[140:143], v[72:75]
    ds_read_b128 v[152:155], v19 offset:2048
    v_mfma_f32_16x16x32_bf16 v[92:95], v[112:115], v[144:147], v[92:95]
    ds_read_b64_tr_b16 v[112:113], v21 offset:21504
    v_mfma_f32_16x16x32_bf16 v[36:39], v[116:119], v[132:135], v[36:39]
    ds_read_b64_tr_b16 v[114:115], v21 offset:22784
    v_mfma_f32_16x16x32_bf16 v[56:59], v[116:119], v[136:139], v[56:59]
    ds_read_b128 v[156:159], v19 offset:4096
    v_mfma_f32_16x16x32_bf16 v[76:79], v[116:119], v[140:143], v[76:79]
    ds_read_b128 v[160:163], v19 offset:6144
    v_mfma_f32_16x16x32_bf16 v[96:99], v[116:119], v[144:147], v[96:99]
    ds_read_b64_tr_b16 v[116:117], v21 offset:21512
    v_mfma_f32_16x16x32_bf16 v[40:43], v[120:123], v[132:135], v[40:43]
    ds_read_b64_tr_b16 v[118:119], v21 offset:22792
    v_mfma_f32_16x16x32_bf16 v[60:63], v[120:123], v[136:139], v[60:63]
    s_add_u32 m0, s44, 36896
    s_nop 0
    buffer_load_dwordx4 v12, s[16:19], s42 offen lds
    v_mfma_f32_16x16x32_bf16 v[80:83], v[120:123], v[140:143], v[80:83]
    buffer_load_dwordx4 v13, s[16:19], s42 offen offset:1024 lds
    buffer_load_dwordx4 v14, s[16:19], s42 offen offset:2048 lds
    v_mfma_f32_16x16x32_bf16 v[100:103], v[120:123], v[144:147], v[100:103]
    s_waitcnt lgkmcnt(8)
    ds_read_b64_tr_b16 v[120:121], v21 offset:21520
    v_mfma_f32_16x16x32_bf16 v[44:47], v[124:127], v[132:135], v[44:47]
    ds_read_b64_tr_b16 v[122:123], v21 offset:22800
    v_mfma_f32_16x16x32_bf16 v[64:67], v[124:127], v[136:139], v[64:67]
    buffer_load_dwordx4 v15, s[16:19], s42 offen offset:3072 lds
    s_add_u32 m0, s45, 36896
    v_mfma_f32_16x16x32_bf16 v[84:87], v[124:127], v[140:143], v[84:87]
    buffer_load_dwordx4 v24, s[20:23], s43 offen lds
    buffer_load_dwordx4 v25, s[20:23], s43 offen offset:1024 lds
    v_mfma_f32_16x16x32_bf16 v[104:107], v[124:127], v[144:147], v[104:107]
    ds_read_b64_tr_b16 v[124:125], v21 offset:21528
    v_mfma_f32_16x16x32_bf16 v[48:51], v[128:131], v[132:135], v[48:51]
    ds_read_b64_tr_b16 v[126:127], v21 offset:22808
    v_mfma_f32_16x16x32_bf16 v[68:71], v[128:131], v[136:139], v[68:71]
    buffer_load_dwordx4 v26, s[20:23], s43 offen offset:2048 lds
    buffer_load_dwordx4 v27, s[20:23], s43 offen offset:3072 lds
    v_mfma_f32_16x16x32_bf16 v[88:91], v[128:131], v[140:143], v[88:91]
    s_add_u32 m0, s45, 40992
    s_add_u32 s42, s42, 128
    v_mfma_f32_16x16x32_bf16 v[108:111], v[128:131], v[144:147], v[108:111]
    ds_read_b64_tr_b16 v[128:129], v21 offset:21536
    s_waitcnt lgkmcnt(3)
    v_mfma_f32_16x16x32_bf16 v[32:35], v[112:115], v[148:151], v[32:35]
    ds_read_b64_tr_b16 v[130:131], v21 offset:22816
    v_mfma_f32_16x16x32_bf16 v[52:55], v[112:115], v[152:155], v[52:55]
    buffer_load_dwordx4 v28, s[20:23], s43 offen lds
    s_add_u32 s43, s43, 245760
    v_mfma_f32_16x16x32_bf16 v[72:75], v[112:115], v[156:159], v[72:75]
    v_mfma_f32_16x16x32_bf16 v[92:95], v[112:115], v[160:163], v[92:95]
    v_mfma_f32_16x16x32_bf16 v[36:39], v[116:119], v[148:151], v[36:39]
    v_mfma_f32_16x16x32_bf16 v[56:59], v[116:119], v[152:155], v[56:59]
    v_mfma_f32_16x16x32_bf16 v[76:79], v[116:119], v[156:159], v[76:79]
    s_waitcnt vmcnt(18)
    s_waitcnt lgkmcnt(0)
    s_barrier
    v_mfma_f32_16x16x32_bf16 v[96:99], v[116:119], v[160:163], v[96:99]
    ds_read_b128 v[132:135], v17 offset:36896
    v_mfma_f32_16x16x32_bf16 v[40:43], v[120:123], v[148:151], v[40:43]
    ds_read_b64_tr_b16 v[112:113], v21 offset:53280
    v_mfma_f32_16x16x32_bf16 v[60:63], v[120:123], v[152:155], v[60:63]
    ds_read_b64_tr_b16 v[114:115], v21 offset:54560
    v_mfma_f32_16x16x32_bf16 v[80:83], v[120:123], v[156:159], v[80:83]
    ds_read_b64_tr_b16 v[116:117], v21 offset:53288
    v_mfma_f32_16x16x32_bf16 v[100:103], v[120:123], v[160:163], v[100:103]
    ds_read_b64_tr_b16 v[118:119], v21 offset:54568
    v_mfma_f32_16x16x32_bf16 v[44:47], v[124:127], v[148:151], v[44:47]
    ds_read_b128 v[136:139], v17 offset:38944
    v_mfma_f32_16x16x32_bf16 v[64:67], v[124:127], v[152:155], v[64:67]
    ds_read_b128 v[140:143], v17 offset:40992
    v_mfma_f32_16x16x32_bf16 v[84:87], v[124:127], v[156:159], v[84:87]
    ds_read_b64_tr_b16 v[120:121], v21 offset:53296
    v_mfma_f32_16x16x32_bf16 v[104:107], v[124:127], v[160:163], v[104:107]
    ds_read_b64_tr_b16 v[122:123], v21 offset:54576
    v_mfma_f32_16x16x32_bf16 v[48:51], v[128:131], v[148:151], v[48:51]
    ds_read_b128 v[144:147], v17 offset:43040
    v_mfma_f32_16x16x32_bf16 v[68:71], v[128:131], v[152:155], v[68:71]
    ds_read_b64_tr_b16 v[124:125], v21 offset:53304
    v_mfma_f32_16x16x32_bf16 v[88:91], v[128:131], v[156:159], v[88:91]
    ds_read_b64_tr_b16 v[126:127], v21 offset:54584
    v_mfma_f32_16x16x32_bf16 v[108:111], v[128:131], v[160:163], v[108:111]
    ds_read_b64_tr_b16 v[128:129], v21 offset:53312
    s_waitcnt lgkmcnt(3)
    v_mfma_f32_16x16x32_bf16 v[32:35], v[112:115], v[132:135], v[32:35]
    ds_read_b64_tr_b16 v[130:131], v21 offset:54592
    v_mfma_f32_16x16x32_bf16 v[52:55], v[112:115], v[136:139], v[52:55]
    ds_read_b128 v[148:151], v19 offset:36896
    v_mfma_f32_16x16x32_bf16 v[72:75], v[112:115], v[140:143], v[72:75]
    ds_read_b128 v[152:155], v19 offset:38944
    v_mfma_f32_16x16x32_bf16 v[92:95], v[112:115], v[144:147], v[92:95]
    ds_read_b64_tr_b16 v[112:113], v21 offset:58400
    v_mfma_f32_16x16x32_bf16 v[36:39], v[116:119], v[132:135], v[36:39]
    ds_read_b64_tr_b16 v[114:115], v21 offset:59680
    v_mfma_f32_16x16x32_bf16 v[56:59], v[116:119], v[136:139], v[56:59]
    ds_read_b128 v[156:159], v19 offset:40992
    v_mfma_f32_16x16x32_bf16 v[76:79], v[116:119], v[140:143], v[76:79]
    ds_read_b128 v[160:163], v19 offset:43040
    v_mfma_f32_16x16x32_bf16 v[96:99], v[116:119], v[144:147], v[96:99]
    ds_read_b64_tr_b16 v[116:117], v21 offset:58408
    v_mfma_f32_16x16x32_bf16 v[40:43], v[120:123], v[132:135], v[40:43]
    ds_read_b64_tr_b16 v[118:119], v21 offset:59688
    v_mfma_f32_16x16x32_bf16 v[60:63], v[120:123], v[136:139], v[60:63]
    s_add_u32 m0, s44, 73792
    s_nop 0
    buffer_load_dwordx4 v12, s[16:19], s42 offen lds
    v_mfma_f32_16x16x32_bf16 v[80:83], v[120:123], v[140:143], v[80:83]
    buffer_load_dwordx4 v13, s[16:19], s42 offen offset:1024 lds
    buffer_load_dwordx4 v14, s[16:19], s42 offen offset:2048 lds
    v_mfma_f32_16x16x32_bf16 v[100:103], v[120:123], v[144:147], v[100:103]
    s_waitcnt lgkmcnt(8)
    ds_read_b64_tr_b16 v[120:121], v21 offset:58416
    v_mfma_f32_16x16x32_bf16 v[44:47], v[124:127], v[132:135], v[44:47]
    ds_read_b64_tr_b16 v[122:123], v21 offset:59696
    v_mfma_f32_16x16x32_bf16 v[64:67], v[124:127], v[136:139], v[64:67]
    buffer_load_dwordx4 v15, s[16:19], s42 offen offset:3072 lds
    s_add_u32 m0, s45, 73792
    v_mfma_f32_16x16x32_bf16 v[84:87], v[124:127], v[140:143], v[84:87]
    buffer_load_dwordx4 v24, s[20:23], s43 offen lds
    buffer_load_dwordx4 v25, s[20:23], s43 offen offset:1024 lds
    v_mfma_f32_16x16x32_bf16 v[104:107], v[124:127], v[144:147], v[104:107]
    ds_read_b64_tr_b16 v[124:125], v21 offset:58424
    v_mfma_f32_16x16x32_bf16 v[48:51], v[128:131], v[132:135], v[48:51]
    ds_read_b64_tr_b16 v[126:127], v21 offset:59704
    v_mfma_f32_16x16x32_bf16 v[68:71], v[128:131], v[136:139], v[68:71]
    buffer_load_dwordx4 v26, s[20:23], s43 offen offset:2048 lds
    buffer_load_dwordx4 v27, s[20:23], s43 offen offset:3072 lds
    v_mfma_f32_16x16x32_bf16 v[88:91], v[128:131], v[140:143], v[88:91]
    s_add_u32 m0, s45, 77888
    s_add_u32 s42, s42, 128
    v_mfma_f32_16x16x32_bf16 v[108:111], v[128:131], v[144:147], v[108:111]
    ds_read_b64_tr_b16 v[128:129], v21 offset:58432
    s_waitcnt lgkmcnt(3)
    v_mfma_f32_16x16x32_bf16 v[32:35], v[112:115], v[148:151], v[32:35]
    ds_read_b64_tr_b16 v[130:131], v21 offset:59712
    v_mfma_f32_16x16x32_bf16 v[52:55], v[112:115], v[152:155], v[52:55]
    buffer_load_dwordx4 v28, s[20:23], s43 offen lds
    s_add_u32 s43, s43, 245760
    v_mfma_f32_16x16x32_bf16 v[72:75], v[112:115], v[156:159], v[72:75]
    v_mfma_f32_16x16x32_bf16 v[92:95], v[112:115], v[160:163], v[92:95]
    v_mfma_f32_16x16x32_bf16 v[36:39], v[116:119], v[148:151], v[36:39]
    v_mfma_f32_16x16x32_bf16 v[56:59], v[116:119], v[152:155], v[56:59]
    v_mfma_f32_16x16x32_bf16 v[76:79], v[116:119], v[156:159], v[76:79]
    s_waitcnt vmcnt(18)
    s_waitcnt lgkmcnt(0)
    s_barrier
    v_mfma_f32_16x16x32_bf16 v[96:99], v[116:119], v[160:163], v[96:99]
    ds_read_b128 v[132:135], v16 offset:0
    v_mfma_f32_16x16x32_bf16 v[40:43], v[120:123], v[148:151], v[40:43]
    ds_read_b64_tr_b16 v[112:113], v20 offset:16384
    v_mfma_f32_16x16x32_bf16 v[60:63], v[120:123], v[152:155], v[60:63]
    ds_read_b64_tr_b16 v[114:115], v20 offset:17664
    v_mfma_f32_16x16x32_bf16 v[80:83], v[120:123], v[156:159], v[80:83]
    ds_read_b64_tr_b16 v[116:117], v20 offset:16392
    v_mfma_f32_16x16x32_bf16 v[100:103], v[120:123], v[160:163], v[100:103]
    ds_read_b64_tr_b16 v[118:119], v20 offset:17672
    v_mfma_f32_16x16x32_bf16 v[44:47], v[124:127], v[148:151], v[44:47]
    ds_read_b128 v[136:139], v16 offset:2048
    v_mfma_f32_16x16x32_bf16 v[64:67], v[124:127], v[152:155], v[64:67]
    ds_read_b128 v[140:143], v16 offset:4096
    v_mfma_f32_16x16x32_bf16 v[84:87], v[124:127], v[156:159], v[84:87]
    ds_read_b64_tr_b16 v[120:121], v20 offset:16400
    v_mfma_f32_16x16x32_bf16 v[104:107], v[124:127], v[160:163], v[104:107]
    ds_read_b64_tr_b16 v[122:123], v20 offset:17680
    v_mfma_f32_16x16x32_bf16 v[48:51], v[128:131], v[148:151], v[48:51]
    ds_read_b128 v[144:147], v16 offset:6144
    v_mfma_f32_16x16x32_bf16 v[68:71], v[128:131], v[152:155], v[68:71]
    ds_read_b64_tr_b16 v[124:125], v20 offset:16408
    v_mfma_f32_16x16x32_bf16 v[88:91], v[128:131], v[156:159], v[88:91]
    ds_read_b64_tr_b16 v[126:127], v20 offset:17688
    v_mfma_f32_16x16x32_bf16 v[108:111], v[128:131], v[160:163], v[108:111]
    ds_read_b64_tr_b16 v[128:129], v20 offset:16416
    s_waitcnt lgkmcnt(3)
    v_mfma_f32_16x16x32_bf16 v[32:35], v[112:115], v[132:135], v[32:35]
    ds_read_b64_tr_b16 v[130:131], v20 offset:17696
    v_mfma_f32_16x16x32_bf16 v[52:55], v[112:115], v[136:139], v[52:55]
    ds_read_b128 v[148:151], v18 offset:0
    v_mfma_f32_16x16x32_bf16 v[72:75], v[112:115], v[140:143], v[72:75]
    ds_read_b128 v[152:155], v18 offset:2048
    v_mfma_f32_16x16x32_bf16 v[92:95], v[112:115], v[144:147], v[92:95]
    ds_read_b64_tr_b16 v[112:113], v20 offset:21504
    v_mfma_f32_16x16x32_bf16 v[36:39], v[116:119], v[132:135], v[36:39]
    ds_read_b64_tr_b16 v[114:115], v20 offset:22784
    v_mfma_f32_16x16x32_bf16 v[56:59], v[116:119], v[136:139], v[56:59]
    ds_read_b128 v[156:159], v18 offset:4096
    v_mfma_f32_16x16x32_bf16 v[76:79], v[116:119], v[140:143], v[76:79]
    ds_read_b128 v[160:163], v18 offset:6144
    v_mfma_f32_16x16x32_bf16 v[96:99], v[116:119], v[144:147], v[96:99]
    ds_read_b64_tr_b16 v[116:117], v20 offset:21512
    v_mfma_f32_16x16x32_bf16 v[40:43], v[120:123], v[132:135], v[40:43]
    ds_read_b64_tr_b16 v[118:119], v20 offset:22792
    v_mfma_f32_16x16x32_bf16 v[60:63], v[120:123], v[136:139], v[60:63]
    s_add_u32 m0, s44, 110688
    s_nop 0
    buffer_load_dwordx4 v12, s[16:19], s42 offen lds
    v_mfma_f32_16x16x32_bf16 v[80:83], v[120:123], v[140:143], v[80:83]
    buffer_load_dwordx4 v13, s[16:19], s42 offen offset:1024 lds
    buffer_load_dwordx4 v14, s[16:19], s42 offen offset:2048 lds
    v_mfma_f32_16x16x32_bf16 v[100:103], v[120:123], v[144:147], v[100:103]
    s_waitcnt lgkmcnt(8)
    ds_read_b64_tr_b16 v[120:121], v20 offset:21520
    v_mfma_f32_16x16x32_bf16 v[44:47], v[124:127], v[132:135], v[44:47]
    ds_read_b64_tr_b16 v[122:123], v20 offset:22800
    v_mfma_f32_16x16x32_bf16 v[64:67], v[124:127], v[136:139], v[64:67]
    buffer_load_dwordx4 v15, s[16:19], s42 offen offset:3072 lds
    s_add_u32 m0, s45, 110688
    v_mfma_f32_16x16x32_bf16 v[84:87], v[124:127], v[140:143], v[84:87]
    buffer_load_dwordx4 v24, s[20:23], s43 offen lds
    buffer_load_dwordx4 v25, s[20:23], s43 offen offset:1024 lds
    v_mfma_f32_16x16x32_bf16 v[104:107], v[124:127], v[144:147], v[104:107]
    ds_read_b64_tr_b16 v[124:125], v20 offset:21528
    v_mfma_f32_16x16x32_bf16 v[48:51], v[128:131], v[132:135], v[48:51]
    ds_read_b64_tr_b16 v[126:127], v20 offset:22808
    v_mfma_f32_16x16x32_bf16 v[68:71], v[128:131], v[136:139], v[68:71]
    buffer_load_dwordx4 v26, s[20:23], s43 offen offset:2048 lds
    buffer_load_dwordx4 v27, s[20:23], s43 offen offset:3072 lds
    v_mfma_f32_16x16x32_bf16 v[88:91], v[128:131], v[140:143], v[88:91]
    s_add_u32 m0, s45, 114784
    s_add_u32 s42, s42, 128
    v_mfma_f32_16x16x32_bf16 v[108:111], v[128:131], v[144:147], v[108:111]
    ds_read_b64_tr_b16 v[128:129], v20 offset:21536
    s_waitcnt lgkmcnt(3)
    v_mfma_f32_16x16x32_bf16 v[32:35], v[112:115], v[148:151], v[32:35]
    ds_read_b64_tr_b16 v[130:131], v20 offset:22816
    v_mfma_f32_16x16x32_bf16 v[52:55], v[112:115], v[152:155], v[52:55]
    buffer_load_dwordx4 v28, s[20:23], s43 offen lds
    s_add_u32 s43, s43, 245760
    v_mfma_f32_16x16x32_bf16 v[72:75], v[112:115], v[156:159], v[72:75]
    v_mfma_f32_16x16x32_bf16 v[92:95], v[112:115], v[160:163], v[92:95]
    v_mfma_f32_16x16x32_bf16 v[36:39], v[116:119], v[148:151], v[36:39]
    v_mfma_f32_16x16x32_bf16 v[56:59], v[116:119], v[152:155], v[56:59]
    v_mfma_f32_16x16x32_bf16 v[76:79], v[116:119], v[156:159], v[76:79]
    s_waitcnt vmcnt(18)
    s_waitcnt lgkmcnt(0)
    s_barrier
    v_mfma_f32_16x16x32_bf16 v[96:99], v[116:119], v[160:163], v[96:99]
    ds_read_b128 v[132:135], v16 offset:36896
    v_mfma_f32_16x16x32_bf16 v[40:43], v[120:123], v[148:151], v[40:43]
    ds_read_b64_tr_b16 v[112:113], v20 offset:53280
    v_mfma_f32_16x16x32_bf16 v[60:63], v[120:123], v[152:155], v[60:63]
    ds_read_b64_tr_b16 v[114:115], v20 offset:54560
    v_mfma_f32_16x16x32_bf16 v[80:83], v[120:123], v[156:159], v[80:83]
    ds_read_b64_tr_b16 v[116:117], v20 offset:53288
    v_mfma_f32_16x16x32_bf16 v[100:103], v[120:123], v[160:163], v[100:103]
    ds_read_b64_tr_b16 v[118:119], v20 offset:54568
    v_mfma_f32_16x16x32_bf16 v[44:47], v[124:127], v[148:151], v[44:47]
    ds_read_b128 v[136:139], v16 offset:38944
    v_mfma_f32_16x16x32_bf16 v[64:67], v[124:127], v[152:155], v[64:67]
    ds_read_b128 v[140:143], v16 offset:40992
    v_mfma_f32_16x16x32_bf16 v[84:87], v[124:127], v[156:159], v[84:87]
    ds_read_b64_tr_b16 v[120:121], v20 offset:53296
    v_mfma_f32_16x16x32_bf16 v[104:107], v[124:127], v[160:163], v[104:107]
    ds_read_b64_tr_b16 v[122:123], v20 offset:54576
    v_mfma_f32_16x16x32_bf16 v[48:51], v[128:131], v[148:151], v[48:51]
    ds_read_b128 v[144:147], v16 offset:43040
    v_mfma_f32_16x16x32_bf16 v[68:71], v[128:131], v[152:155], v[68:71]
    ds_read_b64_tr_b16 v[124:125], v20 offset:53304
    v_mfma_f32_16x16x32_bf16 v[88:91], v[128:131], v[156:159], v[88:91]
    ds_read_b64_tr_b16 v[126:127], v20 offset:54584
    v_mfma_f32_16x16x32_bf16 v[108:111], v[128:131], v[160:163], v[108:111]
    ds_read_b64_tr_b16 v[128:129], v20 offset:53312
    s_waitcnt lgkmcnt(3)
    v_mfma_f32_16x16x32_bf16 v[32:35], v[112:115], v[132:135], v[32:35]
    ds_read_b64_tr_b16 v[130:131], v20 offset:54592
    v_mfma_f32_16x16x32_bf16 v[52:55], v[112:115], v[136:139], v[52:55]
    ds_read_b128 v[148:151], v18 offset:36896
    v_mfma_f32_16x16x32_bf16 v[72:75], v[112:115], v[140:143], v[72:75]
    ds_read_b128 v[152:155], v18 offset:38944
    v_mfma_f32_16x16x32_bf16 v[92:95], v[112:115], v[144:147], v[92:95]
    ds_read_b64_tr_b16 v[112:113], v20 offset:58400
    v_mfma_f32_16x16x32_bf16 v[36:39], v[116:119], v[132:135], v[36:39]
    ds_read_b64_tr_b16 v[114:115], v20 offset:59680
    v_mfma_f32_16x16x32_bf16 v[56:59], v[116:119], v[136:139], v[56:59]
    ds_read_b128 v[156:159], v18 offset:40992
    v_mfma_f32_16x16x32_bf16 v[76:79], v[116:119], v[140:143], v[76:79]
    ds_read_b128 v[160:163], v18 offset:43040
    v_mfma_f32_16x16x32_bf16 v[96:99], v[116:119], v[144:147], v[96:99]
    ds_read_b64_tr_b16 v[116:117], v20 offset:58408
    v_mfma_f32_16x16x32_bf16 v[40:43], v[120:123], v[132:135], v[40:43]
    ds_read_b64_tr_b16 v[118:119], v20 offset:59688
    v_mfma_f32_16x16x32_bf16 v[60:63], v[120:123], v[136:139], v[60:63]
    s_mov_b32 m0, s44
    s_nop 0
    buffer_load_dwordx4 v12, s[16:19], s42 offen lds
    v_mfma_f32_16x16x32_bf16 v[80:83], v[120:123], v[140:143], v[80:83]
    buffer_load_dwordx4 v13, s[16:19], s42 offen offset:1024 lds
    buffer_load_dwordx4 v14, s[16:19], s42 offen offset:2048 lds
    v_mfma_f32_16x16x32_bf16 v[100:103], v[120:123], v[144:147], v[100:103]
    s_waitcnt lgkmcnt(8)
    ds_read_b64_tr_b16 v[120:121], v20 offset:58416
    v_mfma_f32_16x16x32_bf16 v[44:47], v[124:127], v[132:135], v[44:47]
    ds_read_b64_tr_b16 v[122:123], v20 offset:59696
    v_mfma_f32_16x16x32_bf16 v[64:67], v[124:127], v[136:139], v[64:67]
    buffer_load_dwordx4 v15, s[16:19], s42 offen offset:3072 lds
    s_mov_b32 m0, s45
    v_mfma_f32_16x16x32_bf16 v[84:87], v[124:127], v[140:143], v[84:87]
    buffer_load_dwordx4 v24, s[20:23], s43 offen lds
    buffer_load_dwordx4 v25, s[20:23], s43 offen offset:1024 lds
    v_mfma_f32_16x16x32_bf16 v[104:107], v[124:127], v[144:147], v[104:107]
    ds_read_b64_tr_b16 v[124:125], v20 offset:58424
    v_mfma_f32_16x16x32_bf16 v[48:51], v[128:131], v[132:135], v[48:51]
    ds_read_b64_tr_b16 v[126:127], v20 offset:59704
    v_mfma_f32_16x16x32_bf16 v[68:71], v[128:131], v[136:139], v[68:71]
    buffer_load_dwordx4 v26, s[20:23], s43 offen offset:2048 lds
    buffer_load_dwordx4 v27, s[20:23], s43 offen offset:3072 lds
    v_mfma_f32_16x16x32_bf16 v[88:91], v[128:131], v[140:143], v[88:91]
    s_add_u32 m0, s45, 4096
    s_add_u32 s42, s42, 128
    v_mfma_f32_16x16x32_bf16 v[108:111], v[128:131], v[144:147], v[108:111]
    ds_read_b64_tr_b16 v[128:129], v20 offset:58432
    s_waitcnt lgkmcnt(3)
    v_mfma_f32_16x16x32_bf16 v[32:35], v[112:115], v[148:151], v[32:35]
    ds_read_b64_tr_b16 v[130:131], v20 offset:59712
    v_mfma_f32_16x16x32_bf16 v[52:55], v[112:115], v[152:155], v[52:55]
    buffer_load_dwordx4 v28, s[20:23], s43 offen lds
    s_add_u32 s43, s43, 245760
    v_mfma_f32_16x16x32_bf16 v[72:75], v[112:115], v[156:159], v[72:75]
    s_and_b32 s34, s26, 7
    s_lshl_b32 s34, s34, 2
    v_mfma_f32_16x16x32_bf16 v[92:95], v[112:115], v[160:163], v[92:95]
    s_add_u32 s34, s34, s24
    s_mul_i32 s34, s34, 256
    v_mfma_f32_16x16x32_bf16 v[36:39], v[116:119], v[148:151], v[36:39]
    v_min_u32 v168, 1, v2
    v_lshl_add_u32 v168, v168, 7, s34
    v_mfma_f32_16x16x32_bf16 v[56:59], v[116:119], v[152:155], v[56:59]
    v_min_u32 v168, L_side-L_ep_q, v168
    v_add_u32 v168, L_ep_q-L_pc, v168
    v_mfma_f32_16x16x32_bf16 v[76:79], v[116:119], v[156:159], v[76:79]
    s_waitcnt vmcnt(18)
    s_waitcnt lgkmcnt(0)
    s_barrier
    v_mfma_f32_16x16x32_bf16 v[96:99], v[116:119], v[160:163], v[96:99]
    ds_read_b128 v[132:135], v17 offset:0
    v_mfma_f32_16x16x32_bf16 v[40:43], v[120:123], v[148:151], v[40:43]
    ds_read_b64_tr_b16 v[112:113], v21 offset:16384
    v_mfma_f32_16x16x32_bf16 v[60:63], v[120:123], v[152:155], v[60:63]
    ds_read_b64_tr_b16 v[114:115], v21 offset:17664
    v_mfma_f32_16x16x32_bf16 v[80:83], v[120:123], v[156:159], v[80:83]
    ds_read_b64_tr_b16 v[116:117], v21 offset:16392
    v_mfma_f32_16x16x32_bf16 v[100:103], v[120:123], v[160:163], v[100:103]
    ds_read_b64_tr_b16 v[118:119], v21 offset:17672
    v_mfma_f32_16x16x32_bf16 v[44:47], v[124:127], v[148:151], v[44:47]
    ds_read_b128 v[136:139], v17 offset:2048
    v_mfma_f32_16x16x32_bf16 v[64:67], v[124:127], v[152:155], v[64:67]
    ds_read_b128 v[140:143], v17 offset:4096
    v_mfma_f32_16x16x32_bf16 v[84:87], v[124:127], v[156:159], v[84:87]
    ds_read_b64_tr_b16 v[120:121], v21 offset:16400
    v_mfma_f32_16x16x32_bf16 v[104:107], v[124:127], v[160:163], v[104:107]
    ds_read_b64_tr_b16 v[122:123], v21 offset:17680
    v_mfma_f32_16x16x32_bf16 v[48:51], v[128:131], v[148:151], v[48:51]
    ds_read_b128 v[144:147], v17 offset:6144
    v_mfma_f32_16x16x32_bf16 v[68:71], v[128:131], v[152:155], v[68:71]
    ds_read_b64_tr_b16 v[124:125], v21 offset:16408
    v_mfma_f32_16x16x32_bf16 v[88:91], v[128:131], v[156:159], v[88:91]
    ds_read_b64_tr_b16 v[126:127], v21 offset:17688
    v_mfma_f32_16x16x32_bf16 v[108:111], v[128:131], v[160:163], v[108:111]
    ds_read_b64_tr_b16 v[128:129], v21 offset:16416
    s_waitcnt lgkmcnt(3)
    v_mfma_f32_16x16x32_bf16 v[32:35], v[112:115], v[132:135], v[32:35]
    ds_read_b64_tr_b16 v[130:131], v21 offset:17696
    v_mfma_f32_16x16x32_bf16 v[52:55], v[112:115], v[136:139], v[52:55]
    ds_read_b128 v[148:151], v19 offset:0
    v_mfma_f32_16x16x32_bf16 v[72:75], v[112:115], v[140:143], v[72:75]
    ds_read_b128 v[152:155], v19 offset:2048
    v_mfma_f32_16x16x32_bf16 v[92:95], v[112:115], v[144:147], v[92:95]
    ds_read_b64_tr_b16 v[112:113], v21 offset:21504
    v_mfma_f32_16x16x32_bf16 v[36:39], v[116:119], v[132:135], v[36:39]
    ds_read_b64_tr_b16 v[114:115], v21 offset:22784
    v_mfma_f32_16x16x32_bf16 v[56:59], v[116:119], v[136:139], v[56:59]
    ds_read_b128 v[156:159], v19 offset:4096
    v_mfma_f32_16x16x32_bf16 v[76:79], v[116:119], v[140:143], v[76:79]
    ds_read_b128 v[160:163], v19 offset:6144
    v_mfma_f32_16x16x32_bf16 v[96:99], v[116:119], v[144:147], v[96:99]
    ds_read_b64_tr_b16 v[116:117], v21 offset:21512
    v_mfma_f32_16x16x32_bf16 v[40:43], v[120:123], v[132:135], v[40:43]
    ds_read_b64_tr_b16 v[118:119], v21 offset:22792
    v_mfma_f32_16x16x32_bf16 v[60:63], v[120:123], v[136:139], v[60:63]
    global_load_dword v5, v168, s[6:7]
    s_add_u32 m0, s44, 36896
    v_mfma_f32_16x16x32_bf16 v[80:83], v[120:123], v[140:143], v[80:83]
    buffer_load_dwordx4 v12, s[16:19], s42 offen lds
    buffer_load_dwordx4 v13, s[16:19], s42 offen offset:1024 lds
    v_mfma_f32_16x16x32_bf16 v[100:103], v[120:123], v[144:147], v[100:103]
    s_waitcnt lgkmcnt(8)
    ds_read_b64_tr_b16 v[120:121], v21 offset:21520
    v_mfma_f32_16x16x32_bf16 v[44:47], v[124:127], v[132:135], v[44:47]
    ds_read_b64_tr_b16 v[122:123], v21 offset:22800
    v_mfma_f32_16x16x32_bf16 v[64:67], v[124:127], v[136:139], v[64:67]
    buffer_load_dwordx4 v14, s[16:19], s42 offen offset:2048 lds
    buffer_load_dwordx4 v15, s[16:19], s42 offen offset:3072 lds
    v_mfma_f32_16x16x32_bf16 v[84:87], v[124:127], v[140:143], v[84:87]
    s_add_u32 m0, s45, 36896
    s_nop 0
    buffer_load_dwordx4 v24, s[20:23], s43 offen lds
    v_mfma_f32_16x16x32_bf16 v[104:107], v[124:127], v[144:147], v[104:107]
    ds_read_b64_tr_b16 v[124:125], v21 offset:21528
    v_mfma_f32_16x16x32_bf16 v[48:51], v[128:131], v[132:135], v[48:51]
    ds_read_b64_tr_b16 v[126:127], v21 offset:22808
    v_mfma_f32_16x16x32_bf16 v[68:71], v[128:131], v[136:139], v[68:71]
    buffer_load_dwordx4 v25, s[20:23], s43 offen offset:1024 lds
    buffer_load_dwordx4 v26, s[20:23], s43 offen offset:2048 lds
    v_mfma_f32_16x16x32_bf16 v[88:91], v[128:131], v[140:143], v[88:91]
    buffer_load_dwordx4 v27, s[20:23], s43 offen offset:3072 lds
    s_add_u32 m0, s45, 40992
    v_mfma_f32_16x16x32_bf16 v[108:111], v[128:131], v[144:147], v[108:111]
    ds_read_b64_tr_b16 v[128:129], v21 offset:21536
    s_waitcnt lgkmcnt(3)
    v_mfma_f32_16x16x32_bf16 v[32:35], v[112:115], v[148:151], v[32:35]
    ds_read_b64_tr_b16 v[130:131], v21 offset:22816
    v_mfma_f32_16x16x32_bf16 v[52:55], v[112:115], v[152:155], v[52:55]
    s_add_u32 s42, s42, 128
    buffer_load_dwordx4 v28, s[20:23], s43 offen lds
    v_mfma_f32_16x16x32_bf16 v[72:75], v[112:115], v[156:159], v[72:75]
    s_add_u32 s43, s43, 245760
    ds_read_b64_tr_b16 a[200:201], v29 offset:0
    v_mfma_f32_16x16x32_bf16 v[92:95], v[112:115], v[160:163], v[92:95]
    ds_read_b64_tr_b16 a[202:203], v29 offset:160
    ds_read_b64_tr_b16 a[204:205], v29 offset:320
    v_mfma_f32_16x16x32_bf16 v[36:39], v[116:119], v[148:151], v[36:39]
    ds_read_b64_tr_b16 a[206:207], v29 offset:480
    ds_read_b64_tr_b16 a[208:209], v29 offset:640
    v_mfma_f32_16x16x32_bf16 v[56:59], v[116:119], v[152:155], v[56:59]
    ds_read_b64_tr_b16 a[210:211], v29 offset:8
    ds_read_b64_tr_b16 a[212:213], v29 offset:168
    v_mfma_f32_16x16x32_bf16 v[76:79], v[116:119], v[156:159], v[76:79]
    s_waitcnt vmcnt(19)
    s_waitcnt lgkmcnt(0)
    s_barrier
    v_mfma_f32_16x16x32_bf16 v[96:99], v[116:119], v[160:163], v[96:99]
    ds_read_b128 v[132:135], v17 offset:36896
    v_mfma_f32_16x16x32_bf16 v[40:43], v[120:123], v[148:151], v[40:43]
    ds_read_b64_tr_b16 v[112:113], v21 offset:53280
    v_mfma_f32_16x16x32_bf16 v[60:63], v[120:123], v[152:155], v[60:63]
    ds_read_b64_tr_b16 v[114:115], v21 offset:54560
    v_mfma_f32_16x16x32_bf16 v[80:83], v[120:123], v[156:159], v[80:83]
    ds_read_b64_tr_b16 v[116:117], v21 offset:53288
    v_mfma_f32_16x16x32_bf16 v[100:103], v[120:123], v[160:163], v[100:103]
    ds_read_b64_tr_b16 v[118:119], v21 offset:54568
    v_mfma_f32_16x16x32_bf16 v[44:47], v[124:127], v[148:151], v[44:47]
    ds_read_b128 v[136:139], v17 offset:38944
    v_mfma_f32_16x16x32_bf16 v[64:67], v[124:127], v[152:155], v[64:67]
    ds_read_b128 v[140:143], v17 offset:40992
    v_mfma_f32_16x16x32_bf16 v[84:87], v[124:127], v[156:159], v[84:87]
    ds_read_b64_tr_b16 v[120:121], v21 offset:53296
    v_mfma_f32_16x16x32_bf16 v[104:107], v[124:127], v[160:163], v[104:107]
    ds_read_b64_tr_b16 v[122:123], v21 offset:54576
    v_mfma_f32_16x16x32_bf16 v[48:51], v[128:131], v[148:151], v[48:51]
    ds_read_b128 v[144:147], v17 offset:43040
    v_mfma_f32_16x16x32_bf16 v[68:71], v[128:131], v[152:155], v[68:71]
    ds_read_b64_tr_b16 v[124:125], v21 offset:53304
    v_mfma_f32_16x16x32_bf16 v[88:91], v[128:131], v[156:159], v[88:91]
    ds_read_b64_tr_b16 v[126:127], v21 offset:54584
    v_mfma_f32_16x16x32_bf16 v[108:111], v[128:131], v[160:163], v[108:111]
    ds_read_b64_tr_b16 v[128:129], v21 offset:53312
    s_waitcnt lgkmcnt(3)
    v_mfma_f32_16x16x32_bf16 v[32:35], v[112:115], v[132:135], v[32:35]
    ds_read_b64_tr_b16 v[130:131], v21 offset:54592
    v_mfma_f32_16x16x32_bf16 v[52:55], v[112:115], v[136:139], v[52:55]
    ds_read_b128 v[148:151], v19 offset:36896
    v_mfma_f32_16x16x32_bf16 v[72:75], v[112:115], v[140:143], v[72:75]
    ds_read_b128 v[152:155], v19 offset:38944
    v_mfma_f32_16x16x32_bf16 v[92:95], v[112:115], v[144:147], v[92:95]
    ds_read_b64_tr_b16 v[112:113], v21 offset:58400
    v_mfma_f32_16x16x32_bf16 v[36:39], v[116:119], v[132:135], v[36:39]
    ds_read_b64_tr_b16 v[114:115], v21 offset:59680
    v_mfma_f32_16x16x32_bf16 v[56:59], v[116:119], v[136:139], v[56:59]
    ds_read_b128 v[156:159], v19 offset:40992
    v_mfma_f32_16x16x32_bf16 v[76:79], v[116:119], v[140:143], v[76:79]
    ds_read_b128 v[160:163], v19 offset:43040
    v_mfma_f32_16x16x32_bf16 v[96:99], v[116:119], v[144:147], v[96:99]
    ds_read_b64_tr_b16 v[116:117], v21 offset:58408
    v_mfma_f32_16x16x32_bf16 v[40:43], v[120:123], v[132:135], v[40:43]
    ds_read_b64_tr_b16 v[118:119], v21 offset:59688
    v_mfma_f32_16x16x32_bf16 v[60:63], v[120:123], v[136:139], v[60:63]
    ds_read_b64_tr_b16 a[214:215], v29 offset:328
    ds_read_b64_tr_b16 a[216:217], v29 offset:488
    v_mfma_f32_16x16x32_bf16 v[80:83], v[120:123], v[140:143], v[80:83]
    ds_read_b64_tr_b16 a[218:219], v29 offset:648
    ds_read_b64_tr_b16 a[220:221], v29 offset:16
    v_mfma_f32_16x16x32_bf16 v[100:103], v[120:123], v[144:147], v[100:103]
    s_waitcnt lgkmcnt(12)
    ds_read_b64_tr_b16 v[120:121], v21 offset:58416
    v_mfma_f32_16x16x32_bf16 v[44:47], v[124:127], v[132:135], v[44:47]
    ds_read_b64_tr_b16 v[122:123], v21 offset:59696
    v_mfma_f32_16x16x32_bf16 v[64:67], v[124:127], v[136:139], v[64:67]
    ds_read_b64_tr_b16 a[222:223], v29 offset:176
    ds_read_b64_tr_b16 a[224:225], v29 offset:336
    v_mfma_f32_16x16x32_bf16 v[84:87], v[124:127], v[140:143], v[84:87]
    ds_read_b64_tr_b16 a[226:227], v29 offset:496
    ds_read_b64_tr_b16 a[228:229], v29 offset:656
    v_mfma_f32_16x16x32_bf16 v[104:107], v[124:127], v[144:147], v[104:107]
    ds_read_b64_tr_b16 v[124:125], v21 offset:58424
    v_mfma_f32_16x16x32_bf16 v[48:51], v[128:131], v[132:135], v[48:51]
    ds_read_b64_tr_b16 v[126:127], v21 offset:59704
    v_mfma_f32_16x16x32_bf16 v[68:71], v[128:131], v[136:139], v[68:71]
    ds_read_b64_tr_b16 a[230:231], v29 offset:24
    ds_read_b64_tr_b16 a[232:233], v29 offset:184
    v_mfma_f32_16x16x32_bf16 v[88:91], v[128:131], v[140:143], v[88:91]
    ds_read_b64_tr_b16 a[234:235], v29 offset:344
    ds_read_b64_tr_b16 a[236:237], v29 offset:504
    v_mfma_f32_16x16x32_bf16 v[108:111], v[128:131], v[144:147], v[108:111]
    ds_read_b64_tr_b16 v[128:129], v21 offset:58432
    s_waitcnt lgkmcnt(11)
    v_mfma_f32_16x16x32_bf16 v[32:35], v[112:115], v[148:151], v[32:35]
    ds_read_b64_tr_b16 v[130:131], v21 offset:59712
    v_mfma_f32_16x16x32_bf16 v[52:55], v[112:115], v[152:155], v[52:55]
    s_cmp_lg_u32 s24, 0
    s_cbranch_scc1 s0p_11
    global_load_dword v31, v30, s[82:83] sc1
s0p_11:
    v_mfma_f32_16x16x32_bf16 v[72:75], v[112:115], v[156:159], v[72:75]
    ds_read_b64_tr_b16 a[238:239], v29 offset:664
    ds_read_b64_tr_b16 a[240:241], v29 offset:32
    v_mfma_f32_16x16x32_bf16 v[92:95], v[112:115], v[160:163], v[92:95]
    ds_read_b64_tr_b16 a[242:243], v29 offset:192
    ds_read_b64_tr_b16 a[244:245], v29 offset:352
    v_mfma_f32_16x16x32_bf16 v[36:39], v[116:119], v[148:151], v[36:39]
    ds_read_b64_tr_b16 a[246:247], v29 offset:512
    ds_read_b64_tr_b16 a[248:249], v29 offset:672
    v_mfma_f32_16x16x32_bf16 v[56:59], v[116:119], v[152:155], v[56:59]
    v_mfma_f32_16x16x32_bf16 v[76:79], v[116:119], v[156:159], v[76:79]
    s_waitcnt vmcnt(10)
    s_waitcnt lgkmcnt(0)
    s_barrier
    v_mfma_f32_16x16x32_bf16 v[96:99], v[116:119], v[160:163], v[96:99]
    ds_read_b128 v[132:135], v16 offset:0
    v_mfma_f32_16x16x32_bf16 v[40:43], v[120:123], v[148:151], v[40:43]
    ds_read_b64_tr_b16 v[112:113], v20 offset:16384
    v_mfma_f32_16x16x32_bf16 v[60:63], v[120:123], v[152:155], v[60:63]
    ds_read_b64_tr_b16 v[114:115], v20 offset:17664
    v_mfma_f32_16x16x32_bf16 v[80:83], v[120:123], v[156:159], v[80:83]
    ds_read_b64_tr_b16 v[116:117], v20 offset:16392
    v_mfma_f32_16x16x32_bf16 v[100:103], v[120:123], v[160:163], v[100:103]
    ds_read_b64_tr_b16 v[118:119], v20 offset:17672
    v_mfma_f32_16x16x32_bf16 v[44:47], v[124:127], v[148:151], v[44:47]
    ds_read_b128 v[136:139], v16 offset:2048
    v_mfma_f32_16x16x32_bf16 v[64:67], v[124:127], v[152:155], v[64:67]
    ds_read_b128 v[140:143], v16 offset:4096
    v_mfma_f32_16x16x32_bf16 v[84:87], v[124:127], v[156:159], v[84:87]
    ds_read_b64_tr_b16 v[120:121], v20 offset:16400
    v_mfma_f32_16x16x32_bf16 v[104:107], v[124:127], v[160:163], v[104:107]
    ds_read_b64_tr_b16 v[122:123], v20 offset:17680
    v_mfma_f32_16x16x32_bf16 v[48:51], v[128:131], v[148:151], v[48:51]
    ds_read_b128 v[144:147], v16 offset:6144
    v_mfma_f32_16x16x32_bf16 v[68:71], v[128:131], v[152:155], v[68:71]
    ds_read_b64_tr_b16 v[124:125], v20 offset:16408
    v_mfma_f32_16x16x32_bf16 v[88:91], v[128:131], v[156:159], v[88:91]
    ds_read_b64_tr_b16 v[126:127], v20 offset:17688
    v_mfma_f32_16x16x32_bf16 v[108:111], v[128:131], v[160:163], v[108:111]
    ds_read_b64_tr_b16 v[128:129], v20 offset:16416
    s_waitcnt lgkmcnt(3)
    v_mfma_f32_16x16x32_bf16 v[32:35], v[112:115], v[132:135], v[32:35]
    ds_read_b64_tr_b16 v[130:131], v20 offset:17696
    v_mfma_f32_16x16x32_bf16 v[52:55], v[112:115], v[136:139], v[52:55]
    ds_read_b128 v[148:151], v18 offset:0
    v_mfma_f32_16x16x32_bf16 v[72:75], v[112:115], v[140:143], v[72:75]
    ds_read_b128 v[152:155], v18 offset:2048
    v_mfma_f32_16x16x32_bf16 v[92:95], v[112:115], v[144:147], v[92:95]
    ds_read_b64_tr_b16 v[112:113], v20 offset:21504
    v_mfma_f32_16x16x32_bf16 v[36:39], v[116:119], v[132:135], v[36:39]
    ds_read_b64_tr_b16 v[114:115], v20 offset:22784
    v_mfma_f32_16x16x32_bf16 v[56:59], v[116:119], v[136:139], v[56:59]
    ds_read_b128 v[156:159], v18 offset:4096
    v_mfma_f32_16x16x32_bf16 v[76:79], v[116:119], v[140:143], v[76:79]
    ds_read_b128 v[160:163], v18 offset:6144
    v_mfma_f32_16x16x32_bf16 v[96:99], v[116:119], v[144:147], v[96:99]
    ds_read_b64_tr_b16 v[116:117], v20 offset:21512
    v_mfma_f32_16x16x32_bf16 v[40:43], v[120:123], v[132:135], v[40:43]
    ds_read_b64_tr_b16 v[118:119], v20 offset:22792
    v_mfma_f32_16x16x32_bf16 v[60:63], v[120:123], v[136:139], v[60:63]
    v_mfma_f32_16x16x32_bf16 v[80:83], v[120:123], v[140:143], v[80:83]
    v_mfma_f32_16x16x32_bf16 v[100:103], v[120:123], v[144:147], v[100:103]
    s_waitcnt lgkmcnt(8)
    ds_read_b64_tr_b16 v[120:121], v20 offset:21520
    v_mfma_f32_16x16x32_bf16 v[44:47], v[124:127], v[132:135], v[44:47]
    ds_read_b64_tr_b16 v[122:123], v20 offset:22800
    v_mfma_f32_16x16x32_bf16 v[64:67], v[124:127], v[136:139], v[64:67]
    v_mfma_f32_16x16x32_bf16 v[84:87], v[124:127], v[140:143], v[84:87]
    v_mfma_f32_16x16x32_bf16 v[104:107], v[124:127], v[144:147], v[104:107]
    ds_read_b64_tr_b16 v[124:125], v20 offset:21528
    v_mfma_f32_16x16x32_bf16 v[48:51], v[128:131], v[132:135], v[48:51]
    ds_read_b64_tr_b16 v[126:127], v20 offset:22808
    v_mfma_f32_16x16x32_bf16 v[68:71], v[128:131], v[136:139], v[68:71]
    v_mfma_f32_16x16x32_bf16 v[88:91], v[128:131], v[140:143], v[88:91]
    v_mfma_f32_16x16x32_bf16 v[108:111], v[128:131], v[144:147], v[108:111]
    ds_read_b64_tr_b16 v[128:129], v20 offset:21536
    s_waitcnt lgkmcnt(3)
    v_mfma_f32_16x16x32_bf16 v[32:35], v[112:115], v[148:151], v[32:35]
    ds_read_b64_tr_b16 v[130:131], v20 offset:22816
    v_mfma_f32_16x16x32_bf16 v[52:55], v[112:115], v[152:155], v[52:55]
    v_mfma_f32_16x16x32_bf16 v[72:75], v[112:115], v[156:159], v[72:75]
    v_mfma_f32_16x16x32_bf16 v[92:95], v[112:115], v[160:163], v[92:95]
    v_mfma_f32_16x16x32_bf16 v[36:39], v[116:119], v[148:151], v[36:39]
    v_mfma_f32_16x16x32_bf16 v[56:59], v[116:119], v[152:155], v[56:59]
    v_mfma_f32_16x16x32_bf16 v[76:79], v[116:119], v[156:159], v[76:79]
    s_cmp_lg_u32 s24, 0
    s_cbranch_scc1 s0_12
    s_waitcnt vmcnt(0)
    v_cmp_eq_u32 vcc, 0, v31
    s_nop 1
    s_cbranch_vccz s0_12
    s_mov_b32 s29, 262144
go_13:
    global_load_dword v31, v30, s[82:83] sc1
    s_waitcnt vmcnt(0)
    v_cmp_eq_u32 vcc, 0, v31
    s_nop 1
    s_cbranch_vccz s0_12
    s_sleep 12
    s_sub_u32 s29, s29, 1
    s_cbranch_scc0 go_13
s0_12:
    s_waitcnt vmcnt(0)
    s_waitcnt lgkmcnt(0)
    s_barrier
    v_mfma_f32_16x16x32_bf16 v[96:99], v[116:119], v[160:163], v[96:99]
    ds_read_b128 v[132:135], v16 offset:36896
    v_mfma_f32_16x16x32_bf16 v[40:43], v[120:123], v[148:151], v[40:43]
    ds_read_b64_tr_b16 v[112:113], v20 offset:53280
    v_mfma_f32_16x16x32_bf16 v[60:63], v[120:123], v[152:155], v[60:63]
    ds_read_b64_tr_b16 v[114:115], v20 offset:54560
    v_mfma_f32_16x16x32_bf16 v[80:83], v[120:123], v[156:159], v[80:83]
    ds_read_b64_tr_b16 v[116:117], v20 offset:53288
    v_mfma_f32_16x16x32_bf16 v[100:103], v[120:123], v[160:163], v[100:103]
    ds_read_b64_tr_b16 v[118:119], v20 offset:54568
    v_mfma_f32_16x16x32_bf16 v[44:47], v[124:127], v[148:151], v[44:47]
    ds_read_b128 v[136:139], v16 offset:38944
    v_mfma_f32_16x16x32_bf16 v[64:67], v[124:127], v[152:155], v[64:67]
    ds_read_b128 v[140:143], v16 offset:40992
    v_mfma_f32_16x16x32_bf16 v[84:87], v[124:127], v[156:159], v[84:87]
    ds_read_b64_tr_b16 v[120:121], v20 offset:53296
    v_mfma_f32_16x16x32_bf16 v[104:107], v[124:127], v[160:163], v[104:107]
    ds_read_b64_tr_b16 v[122:123], v20 offset:54576
    v_mfma_f32_16x16x32_bf16 v[48:51], v[128:131], v[148:151], v[48:51]
    ds_read_b128 v[144:147], v16 offset:43040
    v_mfma_f32_16x16x32_bf16 v[68:71], v[128:131], v[152:155], v[68:71]
    ds_read_b64_tr_b16 v[124:125], v20 offset:53304
    v_mfma_f32_16x16x32_bf16 v[88:91], v[128:131], v[156:159], v[88:91]
    ds_read_b64_tr_b16 v[126:127], v20 offset:54584
    v_mfma_f32_16x16x32_bf16 v[108:111], v[128:131], v[160:163], v[108:111]
    ds_read_b64_tr_b16 v[128:129], v20 offset:53312
    s_waitcnt lgkmcnt(3)
    v_mfma_f32_16x16x32_bf16 v[32:35], v[112:115], v[132:135], v[32:35]
    ds_read_b64_tr_b16 v[130:131], v20 offset:54592
    v_mfma_f32_16x16x32_bf16 v[52:55], v[112:115], v[136:139], v[52:55]
    ds_read_b128 v[148:151], v18 offset:36896
    v_mfma_f32_16x16x32_bf16 v[72:75], v[112:115], v[140:143], v[72:75]
    ds_read_b128 v[152:155], v18 offset:38944
    v_mfma_f32_16x16x32_bf16 v[92:95], v[112:115], v[144:147], v[92:95]
    ds_read_b64_tr_b16 v[112:113], v20 offset:58400
    v_mfma_f32_16x16x32_bf16 v[36:39], v[116:119], v[132:135], v[36:39]
    ds_read_b64_tr_b16 v[114:115], v20 offset:59680
    v_mfma_f32_16x16x32_bf16 v[56:59], v[116:119], v[136:139], v[56:59]
    ds_read_b128 v[156:159], v18 offset:40992
    v_mfma_f32_16x16x32_bf16 v[76:79], v[116:119], v[140:143], v[76:79]
    ds_read_b128 v[160:163], v18 offset:43040
    v_mfma_f32_16x16x32_bf16 v[96:99], v[116:119], v[144:147], v[96:99]
    ds_read_b64_tr_b16 v[116:117], v20 offset:58408
    v_mfma_f32_16x16x32_bf16 v[40:43], v[120:123], v[132:135], v[40:43]
    ds_read_b64_tr_b16 v[118:119], v20 offset:59688
    v_mfma_f32_16x16x32_bf16 v[60:63], v[120:123], v[136:139], v[60:63]
    buffer_load_dword v168, v7, s[8:11], s50 offen offset:0 sc1
    buffer_load_dword v169, v7, s[8:11], s51 offen offset:0 sc1
    v_mfma_f32_16x16x32_bf16 v[80:83], v[120:123], v[140:143], v[80:83]
    buffer_load_dword v170, v7, s[8:11], s50 offen offset:64 sc1
    buffer_load_dword v171, v7, s[8:11], s51 offen offset:64 sc1
    v_mfma_f32_16x16x32_bf16 v[100:103], v[120:123], v[144:147], v[100:103]
    s_waitcnt lgkmcnt(8)
    ds_read_b64_tr_b16 v[120:121], v20 offset:58416
    v_mfma_f32_16x16x32_bf16 v[44:47], v[124:127], v[132:135], v[44:47]
    ds_read_b64_tr_b16 v[122:123], v20 offset:59696
    v_mfma_f32_16x16x32_bf16 v[64:67], v[124:127], v[136:139], v[64:67]
    buffer_load_dword v192, v7, s[8:11], s50 offen offset:128 sc1
    buffer_load_dword v193, v7, s[8:11], s51 offen offset:128 sc1
    v_mfma_f32_16x16x32_bf16 v[84:87], v[124:127], v[140:143], v[84:87]
    buffer_load_dword v194, v7, s[8:11], s50 offen offset:192 sc1
    buffer_load_dword v195, v7, s[8:11], s51 offen offset:192 sc1
    v_mfma_f32_16x16x32_bf16 v[104:107], v[124:127], v[144:147], v[104:107]
    ds_read_b64_tr_b16 v[124:125], v20 offset:58424
    v_mfma_f32_16x16x32_bf16 v[48:51], v[128:131], v[132:135], v[48:51]
    ds_read_b64_tr_b16 v[126:127], v20 offset:59704
    v_mfma_f32_16x16x32_bf16 v[68:71], v[128:131], v[136:139], v[68:71]
    buffer_load_dwordx4 v[172:175], v219, s[8:11], s52 offen offset:0 sc1
    buffer_load_dwordx4 v[220:223], v219, s[8:11], s53 offen offset:0 sc1
    v_mfma_f32_16x16x32_bf16 v[88:91], v[128:131], v[140:143], v[88:91]
    buffer_load_dwordx4 v[176:179], v219, s[8:11], s52 offen offset:16 sc1
    buffer_load_dwordx4 v[224:227], v219, s[8:11], s53 offen offset:16 sc1
    v_mfma_f32_16x16x32_bf16 v[108:111], v[128:131], v[144:147], v[108:111]
    ds_read_b64_tr_b16 v[128:129], v20 offset:58432
    s_waitcnt lgkmcnt(3)
    v_mfma_f32_16x16x32_bf16 v[32:35], v[112:115], v[148:151], v[32:35]
    ds_read_b64_tr_b16 v[130:131], v20 offset:59712
    v_mfma_f32_16x16x32_bf16 v[52:55], v[112:115], v[152:155], v[52:55]
    buffer_load_dwordx4 v[180:183], v219, s[8:11], s52 offen offset:32 sc1
    buffer_load_dwordx4 v[228:231], v219, s[8:11], s53 offen offset:32 sc1
    v_mfma_f32_16x16x32_bf16 v[72:75], v[112:115], v[156:159], v[72:75]
    buffer_load_dwordx4 v[184:187], v219, s[8:11], s52 offen offset:48 sc1
    buffer_load_dwordx4 v[232:235], v219, s[8:11], s53 offen offset:48 sc1
    v_mfma_f32_16x16x32_bf16 v[92:95], v[112:115], v[160:163], v[92:95]
    buffer_load_dwordx4 v[188:191], v219, s[8:11], s52 offen offset:64 sc1
    buffer_load_dwordx4 v[236:239], v219, s[8:11], s53 offen offset:64 sc1
    v_mfma_f32_16x16x32_bf16 v[36:39], v[116:119], v[148:151], v[36:39]
    s_lshl_b32 s34, s26, 2
    s_add_u32 s34, s34, s24
    v_mfma_f32_16x16x32_bf16 v[56:59], v[116:119], v[152:155], v[56:59]
    s_mul_i32 s34, s34, 6400
    v_min_u32_e64 v31, 49, v2
    v_mfma_f32_16x16x32_bf16 v[76:79], v[116:119], v[156:159], v[76:79]
    v_lshlrev_b32_e64 v31, 7, v31
    buffer_load_dword v5, v31, s[8:11], s34 offen sc1
    v_mfma_f32_16x16x32_bf16 v[96:99], v[116:119], v[160:163], v[96:99]
    v_mfma_f32_16x16x32_bf16 v[40:43], v[120:123], v[148:151], v[40:43]
    s_and_b32 s34, s26, 7
    s_lshl_b32 s34, s34, 2
    v_mfma_f32_16x16x32_bf16 v[60:63], v[120:123], v[152:155], v[60:63]
    s_add_u32 s34, s34, s24
    s_mul_i32 s34, s34, 256
    v_mfma_f32_16x16x32_bf16 v[80:83], v[120:123], v[156:159], v[80:83]
    v_min_u32 v31, 1, v2
    v_lshl_add_u32 v31, v31, 7, s34
    v_mfma_f32_16x16x32_bf16 v[100:103], v[120:123], v[160:163], v[100:103]
    s_waitcnt lgkmcnt(0)
    v_min_u32 v31, L_C-L_join, v31
    v_mfma_f32_16x16x32_bf16 v[44:47], v[124:127], v[148:151], v[44:47]
    v_add_u32 v31, L_join-L_pc, v31
    global_load_dword v5, v31, s[6:7]
    v_mfma_f32_16x16x32_bf16 v[64:67], v[124:127], v[152:155], v[64:67]
    v_mfma_f32_16x16x32_bf16 v[84:87], v[124:127], v[156:159], v[84:87]
    v_mfma_f32_16x16x32_bf16 v[104:107], v[124:127], v[160:163], v[104:107]
    v_mfma_f32_16x16x32_bf16 v[48:51], v[128:131], v[148:151], v[48:51]
    v_mfma_f32_16x16x32_bf16 v[68:71], v[128:131], v[152:155], v[68:71]
    v_mfma_f32_16x16x32_bf16 v[88:91], v[128:131], v[156:159], v[88:91]
    v_mfma_f32_16x16x32_bf16 v[108:111], v[128:131], v[160:163], v[108:111]
L_ep_q:
    s_waitcnt vmcnt(10)
    v_pk_add_f32 v[172:173], v[172:173], v[220:221]
    v_pk_add_f32 v[174:175], v[174:175], v[222:223]
    s_waitcnt vmcnt(8)
    v_pk_add_f32 v[176:177], v[176:177], v[224:225]
    v_pk_add_f32 v[178:179], v[178:179], v[226:227]
    s_waitcnt vmcnt(6)
    v_pk_add_f32 v[180:181], v[180:181], v[228:229]
    v_pk_add_f32 v[182:183], v[182:183], v[230:231]
    s_waitcnt vmcnt(4)
    v_pk_add_f32 v[184:185], v[184:185], v[232:233]
    v_pk_add_f32 v[186:187], v[186:187], v[234:235]
    s_waitcnt vmcnt(2)
    v_pk_add_f32 v[188:189], v[188:189], v[236:237]
    v_pk_add_f32 v[190:191], v[190:191], v[238:239]
    v_and_b32 v8, 15, v2
    v_lshlrev_b32 v8, 4, v8
    v_lshrrev_b32_e64 v9, 5, v2
    v_mul_u32_u24 v9, 5120, v9
    v_add_u32_e64 v8, v8, v9
    v_bfe_u32 v10, v2, 4, 1
    v_lshl_add_u32 v9, v10, 9, v8
    v_add_u32 v9, 4096, v9
    v_lshl_add_u32 v8, v10, 11, v8
    s_lshl_b32 s30, s40, 2
    s_and_b32 s31, s24, 2
    s_add_u32 s30, s30, s31
    s_mul_i32 s30, s30, 81920
    s_mul_i32 s31, s41, 20480
    s_add_u32 s30, s30, s31
    s_and_b32 s31, s24, 1
    s_mul_i32 s31, s31, 10240
    s_add_u32 s30, s30, s31
    s_add_u32 s36, s30, 7340032
    s_add_u32 s37, s36, 81920
    v_pk_fma_f32 v[32:33], v[168:169], v[172:173], v[32:33] op_sel_hi:[0,1,1] neg_lo:[1,0,0] neg_hi:[1,0,0]
    v_pk_fma_f32 v[34:35], v[168:169], v[174:175], v[34:35] op_sel_hi:[0,1,1] neg_lo:[1,0,0] neg_hi:[1,0,0]
    v_pk_fma_f32 v[36:37], v[168:169], v[176:177], v[36:37] op_sel_hi:[0,1,1] neg_lo:[1,0,0] neg_hi:[1,0,0]
    v_pk_fma_f32 v[38:39], v[168:169], v[178:179], v[38:39] op_sel_hi:[0,1,1] neg_lo:[1,0,0] neg_hi:[1,0,0]
    v_pk_fma_f32 v[40:41], v[168:169], v[180:181], v[40:41] op_sel_hi:[0,1,1] neg_lo:[1,0,0] neg_hi:[1,0,0]
    v_pk_fma_f32 v[42:43], v[168:169], v[182:183], v[42:43] op_sel_hi:[0,1,1] neg_lo:[1,0,0] neg_hi:[1,0,0]
    v_pk_fma_f32 v[44:45], v[168:169], v[184:185], v[44:45] op_sel_hi:[0,1,1] neg_lo:[1,0,0] neg_hi:[1,0,0]
    v_pk_fma_f32 v[46:47], v[168:169], v[186:187], v[46:47] op_sel_hi:[0,1,1] neg_lo:[1,0,0] neg_hi:[1,0,0]
    v_pk_fma_f32 v[48:49], v[168:169], v[188:189], v[48:49] op_sel_hi:[0,1,1] neg_lo:[1,0,0] neg_hi:[1,0,0]
    v_pk_fma_f32 v[50:51], v[168:169], v[190:191], v[50:51] op_sel_hi:[0,1,1] neg_lo:[1,0,0] neg_hi:[1,0,0]
    v_pk_fma_f32 v[52:53], v[170:171], v[172:173], v[52:53] op_sel_hi:[0,1,1] neg_lo:[1,0,0] neg_hi:[1,0,0]
    v_pk_fma_f32 v[54:55], v[170:171], v[174:175], v[54:55] op_sel_hi:[0,1,1] neg_lo:[1,0,0] neg_hi:[1,0,0]
    v_pk_fma_f32 v[56:57], v[170:171], v[176:177], v[56:57] op_sel_hi:[0,1,1] neg_lo:[1,0,0] neg_hi:[1,0,0]
    v_pk_fma_f32 v[58:59], v[170:171], v[178:179], v[58:59] op_sel_hi:[0,1,1] neg_lo:[1,0,0] neg_hi:[1,0,0]
    v_pk_fma_f32 v[60:61], v[170:171], v[180:181], v[60:61] op_sel_hi:[0,1,1] neg_lo:[1,0,0] neg_hi:[1,0,0]
    v_pk_fma_f32 v[62:63], v[170:171], v[182:183], v[62:63] op_sel_hi:[0,1,1] neg_lo:[1,0,0] neg_hi:[1,0,0]
    v_pk_fma_f32 v[64:65], v[170:171], v[184:185], v[64:65] op_sel_hi:[0,1,1] neg_lo:[1,0,0] neg_hi:[1,0,0]
    v_pk_fma_f32 v[66:67], v[170:171], v[186:187], v[66:67] op_sel_hi:[0,1,1] neg_lo:[1,0,0] neg_hi:[1,0,0]
    v_pk_fma_f32 v[68:69], v[170:171], v[188:189], v[68:69] op_sel_hi:[0,1,1] neg_lo:[1,0,0] neg_hi:[1,0,0]
    v_pk_fma_f32 v[70:71], v[170:171], v[190:191], v[70:71] op_sel_hi:[0,1,1] neg_lo:[1,0,0] neg_hi:[1,0,0]
    v_pk_fma_f32 v[72:73], v[192:193], v[172:173], v[72:73] op_sel_hi:[0,1,1] neg_lo:[1,0,0] neg_hi:[1,0,0]
    v_pk_fma_f32 v[74:75], v[192:193], v[174:175], v[74:75] op_sel_hi:[0,1,1] neg_lo:[1,0,0] neg_hi:[1,0,0]
    v_pk_fma_f32 v[76:77], v[192:193], v[176:177], v[76:77] op_sel_hi:[0,1,1] neg_lo:[1,0,0] neg_hi:[1,0,0]
    v_pk_fma_f32 v[78:79], v[192:193], v[178:179], v[78:79] op_sel_hi:[0,1,1] neg_lo:[1,0,0] neg_hi:[1,0,0]
    v_pk_fma_f32 v[80:81], v[192:193], v[180:181], v[80:81] op_sel_hi:[0,1,1] neg_lo:[1,0,0] neg_hi:[1,0,0]
    v_pk_fma_f32 v[82:83], v[192:193], v[182:183], v[82:83] op_sel_hi:[0,1,1] neg_lo:[1,0,0] neg_hi:[1,0,0]
    v_pk_fma_f32 v[84:85], v[192:193], v[184:185], v[84:85] op_sel_hi:[0,1,1] neg_lo:[1,0,0] neg_hi:[1,0,0]
    v_pk_fma_f32 v[86:87], v[192:193], v[186:187], v[86:87] op_sel_hi:[0,1,1] neg_lo:[1,0,0] neg_hi:[1,0,0]
    v_pk_fma_f32 v[88:89], v[192:193], v[188:189], v[88:89] op_sel_hi:[0,1,1] neg_lo:[1,0,0] neg_hi:[1,0,0]
    v_pk_fma_f32 v[90:91], v[192:193], v[190:191], v[90:91] op_sel_hi:[0,1,1] neg_lo:[1,0,0] neg_hi:[1,0,0]
    buffer_load_dwordx4 a[0:3], v1, s[8:11], s54 offen sc1
    v_pk_fma_f32 v[92:93], v[194:195], v[172:173], v[92:93] op_sel_hi:[0,1,1] neg_lo:[1,0,0] neg_hi:[1,0,0]
    v_pk_fma_f32 v[94:95], v[194:195], v[174:175], v[94:95] op_sel_hi:[0,1,1] neg_lo:[1,0,0] neg_hi:[1,0,0]
    v_pk_fma_f32 v[96:97], v[194:195], v[176:177], v[96:97] op_sel_hi:[0,1,1] neg_lo:[1,0,0] neg_hi:[1,0,0]
    v_pk_fma_f32 v[98:99], v[194:195], v[178:179], v[98:99] op_sel_hi:[0,1,1] neg_lo:[1,0,0] neg_hi:[1,0,0]
    v_pk_fma_f32 v[100:101], v[194:195], v[180:181], v[100:101] op_sel_hi:[0,1,1] neg_lo:[1,0,0] neg_hi:[1,0,0]
    v_pk_fma_f32 v[102:103], v[194:195], v[182:183], v[102:103] op_sel_hi:[0,1,1] neg_lo:[1,0,0] neg_hi:[1,0,0]
    v_pk_fma_f32 v[104:105], v[194:195], v[184:185], v[104:105] op_sel_hi:[0,1,1] neg_lo:[1,0,0] neg_hi:[1,0,0]
    v_pk_fma_f32 v[106:107], v[194:195], v[186:187], v[106:107] op_sel_hi:[0,1,1] neg_lo:[1,0,0] neg_hi:[1,0,0]
    v_pk_fma_f32 v[108:109], v[194:195], v[188:189], v[108:109] op_sel_hi:[0,1,1] neg_lo:[1,0,0] neg_hi:[1,0,0]
    v_pk_fma_f32 v[110:111], v[194:195], v[190:191], v[110:111] op_sel_hi:[0,1,1] neg_lo:[1,0,0] neg_hi:[1,0,0]
    buffer_load_dwordx4 a[4:7], v1, s[8:11], s54 offen offset:1024 sc1
    v_cvt_pk_bf16_f32 v112, v32, v33
    v_cvt_pk_bf16_f32 v113, v34, v35
    v_cvt_pk_bf16_f32 v114, v36, v37
    v_cvt_pk_bf16_f32 v115, v38, v39
    v_cvt_pk_bf16_f32 v116, v40, v41
    v_cvt_pk_bf16_f32 v117, v42, v43
    v_cvt_pk_bf16_f32 v118, v44, v45
    v_cvt_pk_bf16_f32 v119, v46, v47
    v_cvt_pk_bf16_f32 v120, v48, v49
    v_cvt_pk_bf16_f32 v121, v50, v51
    buffer_load_dwordx4 a[8:11], v1, s[8:11], s54 offen offset:2048 sc1
    v_mfma_f32_16x16x32_bf16 v[220:223], a[200:203], v[112:115], 0
    v_cvt_pk_bf16_f32 v124, v52, v53
    v_cvt_pk_bf16_f32 v125, v54, v55
    v_mfma_f32_16x16x32_bf16 v[224:227], a[210:213], v[112:115], 0
    v_cvt_pk_bf16_f32 v126, v56, v57
    v_cvt_pk_bf16_f32 v127, v58, v59
    v_mfma_f32_16x16x32_bf16 v[228:231], a[220:223], v[112:115], 0
    v_cvt_pk_bf16_f32 v128, v60, v61
    v_cvt_pk_bf16_f32 v129, v62, v63
    v_mfma_f32_16x16x32_bf16 v[232:235], a[230:233], v[112:115], 0
    buffer_load_dwordx4 a[12:15], v1, s[8:11], s54 offen offset:3072 sc1
    v_cvt_pk_bf16_f32 v130, v64, v65
    v_cvt_pk_bf16_f32 v131, v66, v67
    v_mfma_f32_16x16x32_bf16 v[236:239], a[240:243], v[112:115], 0
    v_cvt_pk_bf16_f32 v132, v68, v69
    v_cvt_pk_bf16_f32 v133, v70, v71
    v_mfma_f32_16x16x32_bf16 v[220:223], a[204:207], v[116:119], v[220:223]
    v_mfma_f32_16x16x32_bf16 v[224:227], a[214:217], v[116:119], v[224:227]
    v_mfma_f32_16x16x32_bf16 v[228:231], a[224:227], v[116:119], v[228:231]
    v_mfma_f32_16x16x32_bf16 v[232:235], a[234:237], v[116:119], v[232:235]
    v_mfma_f32_16x16x32_bf16 v[236:239], a[244:247], v[116:119], v[236:239]
    s_add_u32 s54, s54, 4096
    buffer_load_dwordx4 a[16:19], v1, s[8:11], s54 offen sc1
    v_mfma_f32_16x16x16_bf16 v[220:223], a[208:209], v[120:121], v[220:223]
    v_mfma_f32_16x16x16_bf16 v[224:227], a[218:219], v[120:121], v[224:227]
    v_mfma_f32_16x16x16_bf16 v[228:231], a[228:229], v[120:121], v[228:231]
    v_mfma_f32_16x16x16_bf16 v[232:235], a[238:239], v[120:121], v[232:235]
    v_mfma_f32_16x16x16_bf16 v[236:239], a[248:249], v[120:121], v[236:239]
    v_mfma_f32_16x16x32_bf16 v[12:15], a[200:203], v[124:127], 0
    s_nop 2
    v_max3_f32 v158, v220, v221, v222
    v_min3_f32 v160, v220, v221, v222
    v_mfma_f32_16x16x32_bf16 v[16:19], a[210:213], v[124:127], 0
    v_max3_f32 v158, v158, v223, v224
    buffer_load_dwordx4 a[20:23], v1, s[8:11], s54 offen offset:1024 sc1
    v_min3_f32 v160, v160, v223, v224
    v_mfma_f32_16x16x32_bf16 v[20:23], a[220:223], v[124:127], 0
    v_max3_f32 v158, v158, v225, v226
    v_min3_f32 v160, v160, v225, v226
    v_mfma_f32_16x16x32_bf16 v[24:27], a[230:233], v[124:127], 0
    v_max3_f32 v158, v158, v227, v228
    v_min3_f32 v160, v160, v227, v228
    v_mfma_f32_16x16x32_bf16 v[28:31], a[240:243], v[124:127], 0
    v_max3_f32 v158, v158, v229, v230
    v_min3_f32 v160, v160, v229, v230
    buffer_load_dwordx4 a[24:27], v1, s[8:11], s54 offen offset:2048 sc1
    v_mfma_f32_16x16x32_bf16 v[12:15], a[204:207], v[128:131], v[12:15]
    v_max3_f32 v158, v158, v231, v232
    v_min3_f32 v160, v160, v231, v232
    v_mfma_f32_16x16x32_bf16 v[16:19], a[214:217], v[128:131], v[16:19]
    v_max3_f32 v158, v158, v233, v234
    v_min3_f32 v160, v160, v233, v234
    v_mfma_f32_16x16x32_bf16 v[20:23], a[224:227], v[128:131], v[20:23]
    v_max3_f32 v158, v158, v235, v236
    v_min3_f32 v160, v160, v235, v236
    v_mfma_f32_16x16x32_bf16 v[24:27], a[234:237], v[128:131], v[24:27]
    buffer_load_dwordx4 a[28:31], v1, s[8:11], s54 offen offset:3072 sc1
    v_max3_f32 v158, v158, v237, v238
    v_min3_f32 v160, v160, v237, v238
    v_mfma_f32_16x16x32_bf16 v[28:31], a[244:247], v[128:131], v[28:31]
    v_max_f32 v158, v158, v239
    v_min_f32_e64 v160, v160, v239
    v_mfma_f32_16x16x16_bf16 v[12:15], a[208:209], v[132:133], v[12:15]
    v_mfma_f32_16x16x16_bf16 v[16:19], a[218:219], v[132:133], v[16:19]
    v_mfma_f32_16x16x16_bf16 v[20:23], a[228:229], v[132:133], v[20:23]
    v_mfma_f32_16x16x16_bf16 v[24:27], a[238:239], v[132:133], v[24:27]
    v_mfma_f32_16x16x16_bf16 v[28:31], a[248:249], v[132:133], v[28:31]
    s_add_u32 s54, s54, 4096
    buffer_load_dwordx4 a[32:35], v1, s[8:11], s54 offen sc1
    v_mul_f32 v156, 0x3fb8aa3b, v169
    v_mul_f32 v158, v158, v156
    v_mul_f32 v160, v160, v156
    v_pk_fma_f32 v[32:33], v[220:221], v[156:157], v[158:159] op_sel_hi:[1,0,0] neg_lo:[0,0,1] neg_hi:[0,0,1]
    v_pk_fma_f32 v[34:35], v[222:223], v[156:157], v[158:159] op_sel_hi:[1,0,0] neg_lo:[0,0,1] neg_hi:[0,0,1]
    v_pk_fma_f32 v[36:37], v[224:225], v[156:157], v[158:159] op_sel_hi:[1,0,0] neg_lo:[0,0,1] neg_hi:[0,0,1]
    v_pk_fma_f32 v[38:39], v[226:227], v[156:157], v[158:159] op_sel_hi:[1,0,0] neg_lo:[0,0,1] neg_hi:[0,0,1]
    v_pk_fma_f32 v[40:41], v[228:229], v[156:157], v[158:159] op_sel_hi:[1,0,0] neg_lo:[0,0,1] neg_hi:[0,0,1]
    v_pk_fma_f32 v[42:43], v[230:231], v[156:157], v[158:159] op_sel_hi:[1,0,0] neg_lo:[0,0,1] neg_hi:[0,0,1]
    v_pk_fma_f32 v[44:45], v[232:233], v[156:157], v[158:159] op_sel_hi:[1,0,0] neg_lo:[0,0,1] neg_hi:[0,0,1]
    buffer_load_dwordx4 a[36:39], v1, s[8:11], s54 offen offset:1024 sc1
    v_pk_fma_f32 v[46:47], v[234:235], v[156:157], v[158:159] op_sel_hi:[1,0,0] neg_lo:[0,0,1] neg_hi:[0,0,1]
    v_pk_fma_f32 v[48:49], v[236:237], v[156:157], v[158:159] op_sel_hi:[1,0,0] neg_lo:[0,0,1] neg_hi:[0,0,1]
    v_pk_fma_f32 v[50:51], v[238:239], v[156:157], v[158:159] op_sel_hi:[1,0,0] neg_lo:[0,0,1] neg_hi:[0,0,1]
    v_pk_fma_f32 v[52:53], v[220:221], v[156:157], v[160:161] op_sel_hi:[1,0,0] neg_lo:[1,0,0] neg_hi:[1,0,0]
    v_pk_fma_f32 v[54:55], v[222:223], v[156:157], v[160:161] op_sel_hi:[1,0,0] neg_lo:[1,0,0] neg_hi:[1,0,0]
    v_pk_fma_f32 v[56:57], v[224:225], v[156:157], v[160:161] op_sel_hi:[1,0,0] neg_lo:[1,0,0] neg_hi:[1,0,0]
    v_pk_fma_f32 v[58:59], v[226:227], v[156:157], v[160:161] op_sel_hi:[1,0,0] neg_lo:[1,0,0] neg_hi:[1,0,0]
    v_pk_fma_f32 v[60:61], v[228:229], v[156:157], v[160:161] op_sel_hi:[1,0,0] neg_lo:[1,0,0] neg_hi:[1,0,0]
    v_pk_fma_f32 v[62:63], v[230:231], v[156:157], v[160:161] op_sel_hi:[1,0,0] neg_lo:[1,0,0] neg_hi:[1,0,0]
    v_pk_fma_f32 v[64:65], v[232:233], v[156:157], v[160:161] op_sel_hi:[1,0,0] neg_lo:[1,0,0] neg_hi:[1,0,0]
    buffer_load_dwordx4 a[40:43], v1, s[8:11], s54 offen offset:2048 sc1
    v_pk_fma_f32 v[66:67], v[234:235], v[156:157], v[160:161] op_sel_hi:[1,0,0] neg_lo:[1,0,0] neg_hi:[1,0,0]
    v_pk_fma_f32 v[68:69], v[236:237], v[156:157], v[160:161] op_sel_hi:[1,0,0] neg_lo:[1,0,0] neg_hi:[1,0,0]
    v_pk_fma_f32 v[70:71], v[238:239], v[156:157], v[160:161] op_sel_hi:[1,0,0] neg_lo:[1,0,0] neg_hi:[1,0,0]
    v_exp_f32 v32, v32
    v_exp_f32 v33, v33
    v_exp_f32 v34, v34
    v_exp_f32 v35, v35
    v_exp_f32 v36, v36
    v_exp_f32 v37, v37
    v_exp_f32_e64 v38, v38
    buffer_load_dwordx4 a[44:47], v1, s[8:11], s54 offen offset:3072 sc1
    v_exp_f32 v39, v39
    v_exp_f32 v40, v40
    v_exp_f32 v41, v41
    v_exp_f32 v42, v42
    v_exp_f32 v43, v43
    v_exp_f32 v44, v44
    v_exp_f32 v45, v45
    v_exp_f32 v46, v46
    v_exp_f32 v47, v47
    v_exp_f32 v48, v48
    s_add_u32 s54, s54, 4096
    buffer_load_dwordx4 a[48:51], v1, s[8:11], s54 offen sc1
    v_exp_f32 v49, v49
    v_exp_f32 v50, v50
    v_exp_f32 v51, v51
    v_exp_f32 v52, v52
    v_exp_f32 v53, v53
    v_exp_f32 v54, v54
    v_exp_f32 v55, v55
    v_exp_f32 v56, v56
    v_exp_f32 v57, v57
    v_exp_f32 v58, v58
    buffer_load_dwordx4 a[52:55], v1, s[8:11], s54 offen offset:1024 sc1
    v_exp_f32 v59, v59
    v_exp_f32 v60, v60
    v_exp_f32 v61, v61
    v_exp_f32 v62, v62
    v_exp_f32 v63, v63
    v_exp_f32 v64, v64
    v_exp_f32 v65, v65
    v_exp_f32 v66, v66
    v_exp_f32 v67, v67
    v_exp_f32 v68, v68
    buffer_load_dwordx4 a[56:59], v1, s[8:11], s54 offen offset:2048 sc1
    v_exp_f32 v69, v69
    v_exp_f32 v70, v70
    v_exp_f32_e64 v71, v71
    v_pk_add_f32 v[162:163], v[32:33], v[34:35]
    v_pk_add_f32 v[164:165], v[52:53], v[54:55]
    v_pk_add_f32 v[162:163], v[162:163], v[36:37]
    v_pk_add_f32 v[164:165], v[164:165], v[56:57]
    v_pk_add_f32 v[162:163], v[162:163], v[38:39]
    v_pk_add_f32 v[164:165], v[164:165], v[58:59]
    v_pk_add_f32 v[162:163], v[162:163], v[40:41]
    buffer_load_dwordx4 a[60:63], v1, s[8:11], s54 offen offset:3072 sc1
    v_pk_add_f32 v[164:165], v[164:165], v[60:61]
    v_pk_add_f32 v[162:163], v[162:163], v[42:43]
    v_pk_add_f32 v[164:165], v[164:165], v[62:63]
    v_pk_add_f32 v[162:163], v[162:163], v[44:45]
    v_pk_add_f32 v[164:165], v[164:165], v[64:65]
    v_pk_add_f32 v[162:163], v[162:163], v[46:47]
    v_pk_add_f32 v[164:165], v[164:165], v[66:67]
    v_pk_add_f32 v[162:163], v[162:163], v[48:49]
    v_pk_add_f32 v[164:165], v[164:165], v[68:69]
    v_pk_add_f32 v[162:163], v[162:163], v[50:51]
    s_add_u32 s54, s54, 4096
    buffer_load_dwordx4 a[64:67], v1, s[8:11], s54 offen sc1
    v_pk_add_f32 v[164:165], v[164:165], v[70:71]
    v_add_f32 v162, v162, v163
    v_add_f32 v164, v164, v165
    v_rcp_f32 v162, v162
    v_rcp_f32 v164, v164
    v_pk_mul_f32 v[32:33], v[32:33], v[162:163] op_sel_hi:[1,0]
    v_pk_mul_f32 v[34:35], v[34:35], v[162:163] op_sel_hi:[1,0]
    v_pk_mul_f32 v[36:37], v[36:37], v[162:163] op_sel_hi:[1,0]
    v_pk_mul_f32 v[38:39], v[38:39], v[162:163] op_sel_hi:[1,0]
    v_pk_mul_f32 v[40:41], v[40:41], v[162:163] op_sel_hi:[1,0]
    v_pk_mul_f32 v[42:43], v[42:43], v[162:163] op_sel_hi:[1,0]
    v_pk_mul_f32 v[44:45], v[44:45], v[162:163] op_sel_hi:[1,0]
    v_pk_mul_f32 v[46:47], v[46:47], v[162:163] op_sel_hi:[1,0]
    v_pk_mul_f32 v[48:49], v[48:49], v[162:163] op_sel_hi:[1,0]
    v_pk_mul_f32 v[50:51], v[50:51], v[162:163] op_sel_hi:[1,0]
    v_pk_mul_f32 v[52:53], v[52:53], v[164:165] op_sel_hi:[1,0]
    v_pk_mul_f32 v[54:55], v[54:55], v[164:165] op_sel_hi:[1,0]
    v_pk_mul_f32 v[56:57], v[56:57], v[164:165] op_sel_hi:[1,0]
    v_pk_mul_f32 v[58:59], v[58:59], v[164:165] op_sel_hi:[1,0]
    v_pk_mul_f32 v[60:61], v[60:61], v[164:165] op_sel_hi:[1,0]
    v_pk_mul_f32 v[62:63], v[62:63], v[164:165] op_sel_hi:[1,0]
    v_pk_mul_f32 v[64:65], v[64:65], v[164:165] op_sel_hi:[1,0]
    v_pk_mul_f32 v[66:67], v[66:67], v[164:165] op_sel_hi:[1,0]
    v_pk_mul_f32 v[68:69], v[68:69], v[164:165] op_sel_hi:[1,0]
    v_pk_mul_f32 v[70:71], v[70:71], v[164:165] op_sel_hi:[1,0]
    v_cvt_pk_bf16_f32 v136, v32, v33
    v_cvt_pk_bf16_f32 v137, v34, v35
    v_cvt_pk_bf16_f32 v138, v36, v37
    v_cvt_pk_bf16_f32 v139, v38, v39
    v_cvt_pk_bf16_f32 v140, v40, v41
    v_cvt_pk_bf16_f32 v141, v42, v43
    v_cvt_pk_bf16_f32 v142, v44, v45
    v_cvt_pk_bf16_f32 v143, v46, v47
    v_cvt_pk_bf16_f32 v144, v48, v49
    v_cvt_pk_bf16_f32 v145, v50, v51
    v_cvt_pk_bf16_f32 v146, v52, v53
    v_cvt_pk_bf16_f32 v147, v54, v55
    v_cvt_pk_bf16_f32 v148, v56, v57
    v_cvt_pk_bf16_f32 v149, v58, v59
    v_cvt_pk_bf16_f32 v150, v60, v61
    v_cvt_pk_bf16_f32 v151, v62, v63
    v_cvt_pk_bf16_f32 v152, v64, v65
    v_cvt_pk_bf16_f32 v153, v66, v67
    v_cvt_pk_bf16_f32 v154, v68, v69
    v_cvt_pk_bf16_f32 v155, v70, v71
    v_max3_f32 v158, v12, v13, v14
    v_min3_f32 v160, v12, v13, v14
    v_max3_f32 v158, v158, v15, v16
    v_min3_f32 v160, v160, v15, v16
    v_max3_f32 v158, v158, v17, v18
    v_min3_f32 v160, v160, v17, v18
    v_max3_f32 v158, v158, v19, v20
    v_min3_f32 v160, v160, v19, v20
    v_max3_f32 v158, v158, v21, v22
    v_min3_f32 v160, v160, v21, v22
    v_max3_f32 v158, v158, v23, v24
    buffer_load_dwordx4 a[68:71], v1, s[8:11], s54 offen offset:1024 sc1
    v_min3_f32 v160, v160, v23, v24
    v_max3_f32 v158, v158, v25, v26
    v_min3_f32 v160, v160, v25, v26
    v_max3_f32 v158, v158, v27, v28
    v_min3_f32 v160, v160, v27, v28
    v_max3_f32 v158, v158, v29, v30
    v_min3_f32 v160, v160, v29, v30
    v_max_f32 v158, v158, v31
    v_min_f32 v160, v160, v31
    v_mul_f32 v156, 0x3fb8aa3b, v171
    v_mul_f32_e64 v158, v158, v156
    buffer_load_dwordx4 a[72:75], v1, s[8:11], s54 offen offset:2048 sc1
    v_mul_f32_e64 v160, v160, v156
    v_pk_fma_f32 v[32:33], v[12:13], v[156:157], v[158:159] op_sel_hi:[1,0,0] neg_lo:[0,0,1] neg_hi:[0,0,1]
    v_pk_fma_f32 v[34:35], v[14:15], v[156:157], v[158:159] op_sel_hi:[1,0,0] neg_lo:[0,0,1] neg_hi:[0,0,1]
    v_pk_fma_f32 v[36:37], v[16:17], v[156:157], v[158:159] op_sel_hi:[1,0,0] neg_lo:[0,0,1] neg_hi:[0,0,1]
    v_pk_fma_f32 v[38:39], v[18:19], v[156:157], v[158:159] op_sel_hi:[1,0,0] neg_lo:[0,0,1] neg_hi:[0,0,1]
    v_pk_fma_f32 v[40:41], v[20:21], v[156:157], v[158:159] op_sel_hi:[1,0,0] neg_lo:[0,0,1] neg_hi:[0,0,1]
    v_pk_fma_f32 v[42:43], v[22:23], v[156:157], v[158:159] op_sel_hi:[1,0,0] neg_lo:[0,0,1] neg_hi:[0,0,1]
    v_pk_fma_f32 v[44:45], v[24:25], v[156:157], v[158:159] op_sel_hi:[1,0,0] neg_lo:[0,0,1] neg_hi:[0,0,1]
    v_pk_fma_f32 v[46:47], v[26:27], v[156:157], v[158:159] op_sel_hi:[1,0,0] neg_lo:[0,0,1] neg_hi:[0,0,1]
    v_pk_fma_f32 v[48:49], v[28:29], v[156:157], v[158:159] op_sel_hi:[1,0,0] neg_lo:[0,0,1] neg_hi:[0,0,1]
    v_pk_fma_f32 v[50:51], v[30:31], v[156:157], v[158:159] op_sel_hi:[1,0,0] neg_lo:[0,0,1] neg_hi:[0,0,1]
    buffer_store_dwordx4 v[136:139], v8, s[8:11], s36 offen offset:0 sc1
    v_pk_fma_f32 v[52:53], v[12:13], v[156:157], v[160:161] op_sel_hi:[1,0,0] neg_lo:[1,0,0] neg_hi:[1,0,0]
    v_pk_fma_f32 v[54:55], v[14:15], v[156:157], v[160:161] op_sel_hi:[1,0,0] neg_lo:[1,0,0] neg_hi:[1,0,0]
    v_pk_fma_f32 v[56:57], v[16:17], v[156:157], v[160:161] op_sel_hi:[1,0,0] neg_lo:[1,0,0] neg_hi:[1,0,0]
    v_pk_fma_f32 v[58:59], v[18:19], v[156:157], v[160:161] op_sel_hi:[1,0,0] neg_lo:[1,0,0] neg_hi:[1,0,0]
    v_pk_fma_f32 v[60:61], v[20:21], v[156:157], v[160:161] op_sel_hi:[1,0,0] neg_lo:[1,0,0] neg_hi:[1,0,0]
    v_pk_fma_f32 v[62:63], v[22:23], v[156:157], v[160:161] op_sel_hi:[1,0,0] neg_lo:[1,0,0] neg_hi:[1,0,0]
    v_pk_fma_f32 v[64:65], v[24:25], v[156:157], v[160:161] op_sel_hi:[1,0,0] neg_lo:[1,0,0] neg_hi:[1,0,0]
    v_pk_fma_f32 v[66:67], v[26:27], v[156:157], v[160:161] op_sel_hi:[1,0,0] neg_lo:[1,0,0] neg_hi:[1,0,0]
    v_pk_fma_f32 v[68:69], v[28:29], v[156:157], v[160:161] op_sel_hi:[1,0,0] neg_lo:[1,0,0] neg_hi:[1,0,0]
    v_pk_fma_f32 v[70:71], v[30:31], v[156:157], v[160:161] op_sel_hi:[1,0,0] neg_lo:[1,0,0] neg_hi:[1,0,0]
    v_exp_f32_e64 v32, v32
    buffer_load_dwordx4 a[76:79], v1, s[8:11], s54 offen offset:3072 sc1
    v_exp_f32 v33, v33
    v_exp_f32 v34, v34
    v_exp_f32 v35, v35
    v_exp_f32 v36, v36
    v_exp_f32 v37, v37
    v_exp_f32 v38, v38
    v_exp_f32 v39, v39
    v_exp_f32 v40, v40
    v_exp_f32 v41, v41
    v_exp_f32 v42, v42
    v_exp_f32_e64 v43, v43
    s_add_u32 s54, s54, 4096
    buffer_load_dwordx4 a[80:83], v1, s[8:11], s54 offen sc1
    v_exp_f32 v44, v44
    v_exp_f32 v45, v45
    v_exp_f32 v46, v46
    v_exp_f32 v47, v47
    v_exp_f32 v48, v48
    v_exp_f32 v49, v49
    v_exp_f32 v50, v50
    v_exp_f32 v51, v51
    v_exp_f32 v52, v52
    v_exp_f32 v53, v53
    v_exp_f32_e64 v54, v54
    buffer_store_dwordx4 v[140:143], v8, s[8:11], s36 offen offset:512 sc1
    v_exp_f32 v55, v55
    v_exp_f32 v56, v56
    v_exp_f32 v57, v57
    v_exp_f32 v58, v58
    v_exp_f32 v59, v59
    v_exp_f32 v60, v60
    v_exp_f32 v61, v61
    v_exp_f32 v62, v62
    v_exp_f32 v63, v63
    v_exp_f32 v64, v64
    v_exp_f32_e64 v65, v65
    buffer_load_dwordx4 a[84:87], v1, s[8:11], s54 offen offset:1024 sc1
    v_exp_f32 v66, v66
    v_exp_f32 v67, v67
    v_exp_f32 v68, v68
    v_exp_f32 v69, v69
    v_exp_f32 v70, v70
    v_exp_f32 v71, v71
    v_pk_add_f32 v[162:163], v[32:33], v[34:35]
    v_pk_add_f32 v[164:165], v[52:53], v[54:55]
    v_pk_add_f32 v[162:163], v[162:163], v[36:37]
    v_pk_add_f32 v[164:165], v[164:165], v[56:57]
    v_pk_add_f32 v[162:163], v[162:163], v[38:39]
    buffer_store_dwordx4 v[144:147], v8, s[8:11], s36 offen offset:1024 sc1
    v_pk_add_f32 v[164:165], v[164:165], v[58:59]
    v_pk_add_f32 v[162:163], v[162:163], v[40:41]
    v_pk_add_f32 v[164:165], v[164:165], v[60:61]
    v_pk_add_f32 v[162:163], v[162:163], v[42:43]
    v_pk_add_f32 v[164:165], v[164:165], v[62:63]
    v_pk_add_f32 v[162:163], v[162:163], v[44:45]
    v_pk_add_f32 v[164:165], v[164:165], v[64:65]
    v_pk_add_f32 v[162:163], v[162:163], v[46:47]
    v_pk_add_f32 v[164:165], v[164:165], v[66:67]
    v_pk_add_f32 v[162:163], v[162:163], v[48:49]
    v_pk_add_f32 v[164:165], v[164:165], v[68:69]
    buffer_store_dwordx4 v[148:151], v8, s[8:11], s36 offen offset:1536 sc1
    v_pk_add_f32 v[162:163], v[162:163], v[50:51]
    v_pk_add_f32 v[164:165], v[164:165], v[70:71]
    v_add_f32 v162, v162, v163
    v_add_f32 v164, v164, v165
    v_rcp_f32 v162, v162
    v_rcp_f32 v164, v164
    v_pk_mul_f32 v[32:33], v[32:33], v[162:163] op_sel_hi:[1,0]
    v_pk_mul_f32 v[34:35], v[34:35], v[162:163] op_sel_hi:[1,0]
    v_pk_mul_f32 v[36:37], v[36:37], v[162:163] op_sel_hi:[1,0]
    v_pk_mul_f32 v[38:39], v[38:39], v[162:163] op_sel_hi:[1,0]
    v_pk_mul_f32 v[40:41], v[40:41], v[162:163] op_sel_hi:[1,0]
    buffer_store_dwordx4 v[152:155], v9, s[8:11], s36 offen offset:0 sc1
    v_pk_mul_f32 v[42:43], v[42:43], v[162:163] op_sel_hi:[1,0]
    v_pk_mul_f32 v[44:45], v[44:45], v[162:163] op_sel_hi:[1,0]
    v_pk_mul_f32 v[46:47], v[46:47], v[162:163] op_sel_hi:[1,0]
    v_pk_mul_f32 v[48:49], v[48:49], v[162:163] op_sel_hi:[1,0]
    v_pk_mul_f32 v[50:51], v[50:51], v[162:163] op_sel_hi:[1,0]
    v_pk_mul_f32 v[52:53], v[52:53], v[164:165] op_sel_hi:[1,0]
    v_pk_mul_f32 v[54:55], v[54:55], v[164:165] op_sel_hi:[1,0]
    v_pk_mul_f32 v[56:57], v[56:57], v[164:165] op_sel_hi:[1,0]
    v_pk_mul_f32 v[58:59], v[58:59], v[164:165] op_sel_hi:[1,0]
    v_pk_mul_f32 v[60:61], v[60:61], v[164:165] op_sel_hi:[1,0]
    v_pk_mul_f32 v[62:63], v[62:63], v[164:165] op_sel_hi:[1,0]
    v_pk_mul_f32 v[64:65], v[64:65], v[164:165] op_sel_hi:[1,0]
    v_pk_mul_f32 v[66:67], v[66:67], v[164:165] op_sel_hi:[1,0]
    v_pk_mul_f32 v[68:69], v[68:69], v[164:165] op_sel_hi:[1,0]
    v_pk_mul_f32 v[70:71], v[70:71], v[164:165] op_sel_hi:[1,0]
    v_cvt_pk_bf16_f32 v172, v32, v33
    v_cvt_pk_bf16_f32 v173, v34, v35
    v_cvt_pk_bf16_f32 v174, v36, v37
    v_cvt_pk_bf16_f32 v175, v38, v39
    v_cvt_pk_bf16_f32 v176, v40, v41
    v_cvt_pk_bf16_f32 v177, v42, v43
    v_cvt_pk_bf16_f32 v178, v44, v45
    v_cvt_pk_bf16_f32 v179, v46, v47
    v_cvt_pk_bf16_f32 v180, v48, v49
    v_cvt_pk_bf16_f32 v181, v50, v51
    v_cvt_pk_bf16_f32 v182, v52, v53
    v_cvt_pk_bf16_f32 v183, v54, v55
    v_cvt_pk_bf16_f32 v184, v56, v57
    v_cvt_pk_bf16_f32 v185, v58, v59
    v_cvt_pk_bf16_f32 v186, v60, v61
    v_cvt_pk_bf16_f32 v187, v62, v63
    v_cvt_pk_bf16_f32 v188, v64, v65
    v_cvt_pk_bf16_f32 v189, v66, v67
    v_cvt_pk_bf16_f32 v190, v68, v69
    v_cvt_pk_bf16_f32 v191, v70, v71
    v_cvt_pk_bf16_f32 v112, v72, v73
    v_cvt_pk_bf16_f32 v113, v74, v75
    v_cvt_pk_bf16_f32 v114, v76, v77
    v_cvt_pk_bf16_f32 v115, v78, v79
    v_cvt_pk_bf16_f32 v116, v80, v81
    v_cvt_pk_bf16_f32 v117, v82, v83
    v_cvt_pk_bf16_f32 v118, v84, v85
    v_cvt_pk_bf16_f32 v119, v86, v87
    v_cvt_pk_bf16_f32 v120, v88, v89
    v_cvt_pk_bf16_f32 v121, v90, v91
    v_mfma_f32_16x16x32_bf16 v[220:223], a[200:203], v[112:115], 0
    v_cvt_pk_bf16_f32 v124, v92, v93
    v_cvt_pk_bf16_f32 v125, v94, v95
    v_mfma_f32_16x16x32_bf16 v[224:227], a[210:213], v[112:115], 0
    v_cvt_pk_bf16_f32 v126, v96, v97
    buffer_load_dwordx4 a[88:91], v1, s[8:11], s54 offen offset:2048 sc1
    v_cvt_pk_bf16_f32 v127, v98, v99
    v_mfma_f32_16x16x32_bf16 v[228:231], a[220:223], v[112:115], 0
    v_cvt_pk_bf16_f32 v128, v100, v101
    v_cvt_pk_bf16_f32 v129, v102, v103
    v_mfma_f32_16x16x32_bf16 v[232:235], a[230:233], v[112:115], 0
    v_cvt_pk_bf16_f32 v130, v104, v105
    v_cvt_pk_bf16_f32 v131, v106, v107
    v_mfma_f32_16x16x32_bf16 v[236:239], a[240:243], v[112:115], 0
    v_cvt_pk_bf16_f32 v132, v108, v109
    v_cvt_pk_bf16_f32 v133, v110, v111
    v_mfma_f32_16x16x32_bf16 v[220:223], a[204:207], v[116:119], v[220:223]
    v_mfma_f32_16x16x32_bf16 v[224:227], a[214:217], v[116:119], v[224:227]
    v_mfma_f32_16x16x32_bf16 v[228:231], a[224:227], v[116:119], v[228:231]
    v_mfma_f32_16x16x32_bf16 v[232:235], a[234:237], v[116:119], v[232:235]
    v_mfma_f32_16x16x32_bf16 v[236:239], a[244:247], v[116:119], v[236:239]
    buffer_load_dwordx4 a[92:95], v1, s[8:11], s54 offen offset:3072 sc1
    s_nop 0
    v_mfma_f32_16x16x16_bf16 v[220:223], a[208:209], v[120:121], v[220:223]
    v_mfma_f32_16x16x16_bf16 v[224:227], a[218:219], v[120:121], v[224:227]
    v_mfma_f32_16x16x16_bf16 v[228:231], a[228:229], v[120:121], v[228:231]
    v_mfma_f32_16x16x16_bf16 v[232:235], a[238:239], v[120:121], v[232:235]
    v_mfma_f32_16x16x16_bf16 v[236:239], a[248:249], v[120:121], v[236:239]
    v_mfma_f32_16x16x32_bf16 v[12:15], a[200:203], v[124:127], 0
    s_nop 2
    v_max3_f32 v158, v220, v221, v222
    v_min3_f32 v160, v220, v221, v222
    v_mfma_f32_16x16x32_bf16 v[16:19], a[210:213], v[124:127], 0
    v_max3_f32 v158, v158, v223, v224
    v_min3_f32 v160, v160, v223, v224
    v_mfma_f32_16x16x32_bf16 v[20:23], a[220:223], v[124:127], 0
    v_max3_f32 v158, v158, v225, v226
    v_min3_f32 v160, v160, v225, v226
    v_mfma_f32_16x16x32_bf16 v[24:27], a[230:233], v[124:127], 0
    buffer_store_dwordx4 v[172:175], v8, s[8:11], s36 offen offset:256 sc1
    v_max3_f32 v158, v158, v227, v228
    v_min3_f32 v160, v160, v227, v228
    v_mfma_f32_16x16x32_bf16 v[28:31], a[240:243], v[124:127], 0
    v_max3_f32 v158, v158, v229, v230
    v_min3_f32 v160, v160, v229, v230
    v_mfma_f32_16x16x32_bf16 v[12:15], a[204:207], v[128:131], v[12:15]
    v_max3_f32 v158, v158, v231, v232
    v_min3_f32 v160, v160, v231, v232
    v_mfma_f32_16x16x32_bf16 v[16:19], a[214:217], v[128:131], v[16:19]
    v_max3_f32 v158, v158, v233, v234
    v_min3_f32 v160, v160, v233, v234
    v_mfma_f32_16x16x32_bf16 v[20:23], a[224:227], v[128:131], v[20:23]
    v_max3_f32 v158, v158, v235, v236
    v_min3_f32 v160, v160, v235, v236
    v_mfma_f32_16x16x32_bf16 v[24:27], a[234:237], v[128:131], v[24:27]
    s_add_u32 s54, s54, 4096
    buffer_load_dwordx4 a[96:99], v1, s[8:11], s54 offen sc1
    v_max3_f32 v158, v158, v237, v238
    v_min3_f32 v160, v160, v237, v238
    v_mfma_f32_16x16x32_bf16 v[28:31], a[244:247], v[128:131], v[28:31]
    v_max_f32 v158, v158, v239
    v_min_f32 v160, v160, v239
    v_mfma_f32_16x16x16_bf16 v[12:15], a[208:209], v[132:133], v[12:15]
    v_mfma_f32_16x16x16_bf16 v[16:19], a[218:219], v[132:133], v[16:19]
    v_mfma_f32_16x16x16_bf16 v[20:23], a[228:229], v[132:133], v[20:23]
    v_mfma_f32_16x16x16_bf16 v[24:27], a[238:239], v[132:133], v[24:27]
    v_mfma_f32_16x16x16_bf16 v[28:31], a[248:249], v[132:133], v[28:31]
    v_mul_f32 v156, 0x3fb8aa3b, v193
    v_mul_f32 v158, v158, v156
    v_mul_f32 v160, v160, v156
    v_pk_fma_f32 v[72:73], v[220:221], v[156:157], v[158:159] op_sel_hi:[1,0,0] neg_lo:[0,0,1] neg_hi:[0,0,1]
    v_pk_fma_f32 v[74:75], v[222:223], v[156:157], v[158:159] op_sel_hi:[1,0,0] neg_lo:[0,0,1] neg_hi:[0,0,1]
    buffer_load_dwordx4 a[100:103], v1, s[8:11], s54 offen offset:1024 sc1
    v_pk_fma_f32 v[76:77], v[224:225], v[156:157], v[158:159] op_sel_hi:[1,0,0] neg_lo:[0,0,1] neg_hi:[0,0,1]
    v_pk_fma_f32 v[78:79], v[226:227], v[156:157], v[158:159] op_sel_hi:[1,0,0] neg_lo:[0,0,1] neg_hi:[0,0,1]
    v_pk_fma_f32 v[80:81], v[228:229], v[156:157], v[158:159] op_sel_hi:[1,0,0] neg_lo:[0,0,1] neg_hi:[0,0,1]
    v_pk_fma_f32 v[82:83], v[230:231], v[156:157], v[158:159] op_sel_hi:[1,0,0] neg_lo:[0,0,1] neg_hi:[0,0,1]
    v_pk_fma_f32 v[84:85], v[232:233], v[156:157], v[158:159] op_sel_hi:[1,0,0] neg_lo:[0,0,1] neg_hi:[0,0,1]
    v_pk_fma_f32 v[86:87], v[234:235], v[156:157], v[158:159] op_sel_hi:[1,0,0] neg_lo:[0,0,1] neg_hi:[0,0,1]
    v_pk_fma_f32 v[88:89], v[236:237], v[156:157], v[158:159] op_sel_hi:[1,0,0] neg_lo:[0,0,1] neg_hi:[0,0,1]
    v_pk_fma_f32 v[90:91], v[238:239], v[156:157], v[158:159] op_sel_hi:[1,0,0] neg_lo:[0,0,1] neg_hi:[0,0,1]
    v_pk_fma_f32 v[92:93], v[220:221], v[156:157], v[160:161] op_sel_hi:[1,0,0] neg_lo:[1,0,0] neg_hi:[1,0,0]
    v_pk_fma_f32 v[94:95], v[222:223], v[156:157], v[160:161] op_sel_hi:[1,0,0] neg_lo:[1,0,0] neg_hi:[1,0,0]
    v_pk_fma_f32 v[96:97], v[224:225], v[156:157], v[160:161] op_sel_hi:[1,0,0] neg_lo:[1,0,0] neg_hi:[1,0,0]
    v_pk_fma_f32 v[98:99], v[226:227], v[156:157], v[160:161] op_sel_hi:[1,0,0] neg_lo:[1,0,0] neg_hi:[1,0,0]
    v_pk_fma_f32 v[100:101], v[228:229], v[156:157], v[160:161] op_sel_hi:[1,0,0] neg_lo:[1,0,0] neg_hi:[1,0,0]
    v_pk_fma_f32 v[102:103], v[230:231], v[156:157], v[160:161] op_sel_hi:[1,0,0] neg_lo:[1,0,0] neg_hi:[1,0,0]
    v_pk_fma_f32 v[104:105], v[232:233], v[156:157], v[160:161] op_sel_hi:[1,0,0] neg_lo:[1,0,0] neg_hi:[1,0,0]
    buffer_store_dwordx4 v[176:179], v8, s[8:11], s36 offen offset:768 sc1
    v_pk_fma_f32 v[106:107], v[234:235], v[156:157], v[160:161] op_sel_hi:[1,0,0] neg_lo:[1,0,0] neg_hi:[1,0,0]
    v_pk_fma_f32 v[108:109], v[236:237], v[156:157], v[160:161] op_sel_hi:[1,0,0] neg_lo:[1,0,0] neg_hi:[1,0,0]
    v_pk_fma_f32 v[110:111], v[238:239], v[156:157], v[160:161] op_sel_hi:[1,0,0] neg_lo:[1,0,0] neg_hi:[1,0,0]
    v_exp_f32 v72, v72
    v_exp_f32 v73, v73
    v_exp_f32 v74, v74
    v_exp_f32 v75, v75
    v_exp_f32 v76, v76
    v_exp_f32 v77, v77
    v_exp_f32 v78, v78
    v_exp_f32 v79, v79
    v_exp_f32 v80, v80
    v_exp_f32 v81, v81
    v_exp_f32 v82, v82
    v_exp_f32 v83, v83
    buffer_load_dwordx4 a[104:107], v1, s[8:11], s54 offen offset:2048 sc1
    v_exp_f32 v84, v84
    v_exp_f32 v85, v85
    v_exp_f32 v86, v86
    v_exp_f32 v87, v87
    v_exp_f32 v88, v88
    v_exp_f32 v89, v89
    v_exp_f32 v90, v90
    v_exp_f32 v91, v91
    v_exp_f32 v92, v92
    v_exp_f32 v93, v93
    v_exp_f32 v94, v94
    v_exp_f32 v95, v95
    v_exp_f32 v96, v96
    v_exp_f32 v97, v97
    v_exp_f32_e64 v98, v98
    buffer_store_dwordx4 v[180:183], v8, s[8:11], s36 offen offset:1280 sc1
    v_exp_f32 v99, v99
    v_exp_f32 v100, v100
    v_exp_f32 v101, v101
    v_exp_f32 v102, v102
    v_exp_f32 v103, v103
    v_exp_f32 v104, v104
    v_exp_f32 v105, v105
    v_exp_f32 v106, v106
    v_exp_f32 v107, v107
    v_exp_f32 v108, v108
    v_exp_f32 v109, v109
    v_exp_f32 v110, v110
    v_exp_f32_e64 v111, v111
    v_pk_add_f32 v[162:163], v[72:73], v[74:75]
    v_pk_add_f32 v[164:165], v[92:93], v[94:95]
    buffer_store_dwordx4 v[184:187], v8, s[8:11], s36 offen offset:1792 sc1
    v_pk_add_f32 v[162:163], v[162:163], v[76:77]
    v_pk_add_f32 v[164:165], v[164:165], v[96:97]
    v_pk_add_f32 v[162:163], v[162:163], v[78:79]
    v_pk_add_f32 v[164:165], v[164:165], v[98:99]
    v_pk_add_f32 v[162:163], v[162:163], v[80:81]
    v_pk_add_f32 v[164:165], v[164:165], v[100:101]
    v_pk_add_f32 v[162:163], v[162:163], v[82:83]
    v_pk_add_f32 v[164:165], v[164:165], v[102:103]
    v_pk_add_f32 v[162:163], v[162:163], v[84:85]
    v_pk_add_f32 v[164:165], v[164:165], v[104:105]
    v_pk_add_f32 v[162:163], v[162:163], v[86:87]
    v_pk_add_f32 v[164:165], v[164:165], v[106:107]
    v_pk_add_f32 v[162:163], v[162:163], v[88:89]
    v_pk_add_f32 v[164:165], v[164:165], v[108:109]
    v_pk_add_f32 v[162:163], v[162:163], v[90:91]
    buffer_store_dwordx4 v[188:191], v9, s[8:11], s36 offen offset:256 sc1
    v_pk_add_f32 v[164:165], v[164:165], v[110:111]
    v_add_f32 v162, v162, v163
    v_add_f32 v164, v164, v165
    v_rcp_f32 v162, v162
    v_rcp_f32 v164, v164
    v_pk_mul_f32 v[72:73], v[72:73], v[162:163] op_sel_hi:[1,0]
    v_pk_mul_f32 v[74:75], v[74:75], v[162:163] op_sel_hi:[1,0]
    v_pk_mul_f32 v[76:77], v[76:77], v[162:163] op_sel_hi:[1,0]
    v_pk_mul_f32 v[78:79], v[78:79], v[162:163] op_sel_hi:[1,0]
    v_pk_mul_f32 v[80:81], v[80:81], v[162:163] op_sel_hi:[1,0]
    v_pk_mul_f32 v[82:83], v[82:83], v[162:163] op_sel_hi:[1,0]
    v_pk_mul_f32 v[84:85], v[84:85], v[162:163] op_sel_hi:[1,0]
    v_pk_mul_f32 v[86:87], v[86:87], v[162:163] op_sel_hi:[1,0]
    v_pk_mul_f32 v[88:89], v[88:89], v[162:163] op_sel_hi:[1,0]
    v_pk_mul_f32 v[90:91], v[90:91], v[162:163] op_sel_hi:[1,0]
    v_pk_mul_f32 v[92:93], v[92:93], v[164:165] op_sel_hi:[1,0]
    v_pk_mul_f32 v[94:95], v[94:95], v[164:165] op_sel_hi:[1,0]
    v_pk_mul_f32 v[96:97], v[96:97], v[164:165] op_sel_hi:[1,0]
    v_pk_mul_f32 v[98:99], v[98:99], v[164:165] op_sel_hi:[1,0]
    v_pk_mul_f32 v[100:101], v[100:101], v[164:165] op_sel_hi:[1,0]
    v_pk_mul_f32 v[102:103], v[102:103], v[164:165] op_sel_hi:[1,0]
    v_pk_mul_f32 v[104:105], v[104:105], v[164:165] op_sel_hi:[1,0]
    v_pk_mul_f32 v[106:107], v[106:107], v[164:165] op_sel_hi:[1,0]
    v_pk_mul_f32 v[108:109], v[108:109], v[164:165] op_sel_hi:[1,0]
    v_pk_mul_f32 v[110:111], v[110:111], v[164:165] op_sel_hi:[1,0]
    v_cvt_pk_bf16_f32 v136, v72, v73
    v_cvt_pk_bf16_f32 v137, v74, v75
    v_cvt_pk_bf16_f32 v138, v76, v77
    v_cvt_pk_bf16_f32 v139, v78, v79
    v_cvt_pk_bf16_f32 v140, v80, v81
    v_cvt_pk_bf16_f32 v141, v82, v83
    v_cvt_pk_bf16_f32 v142, v84, v85
    v_cvt_pk_bf16_f32 v143, v86, v87
    v_cvt_pk_bf16_f32 v144, v88, v89
    v_cvt_pk_bf16_f32 v145, v90, v91
    v_cvt_pk_bf16_f32 v146, v92, v93
    v_cvt_pk_bf16_f32 v147, v94, v95
    v_cvt_pk_bf16_f32 v148, v96, v97
    v_cvt_pk_bf16_f32 v149, v98, v99
    v_cvt_pk_bf16_f32 v150, v100, v101
    v_cvt_pk_bf16_f32 v151, v102, v103
    v_cvt_pk_bf16_f32 v152, v104, v105
    v_cvt_pk_bf16_f32 v153, v106, v107
    v_cvt_pk_bf16_f32 v154, v108, v109
    v_cvt_pk_bf16_f32 v155, v110, v111
    v_max3_f32 v158, v12, v13, v14
    v_min3_f32 v160, v12, v13, v14
    v_max3_f32 v158, v158, v15, v16
    v_min3_f32 v160, v160, v15, v16
    v_max3_f32 v158, v158, v17, v18
    v_min3_f32 v160, v160, v17, v18
    v_max3_f32 v158, v158, v19, v20
    v_min3_f32 v160, v160, v19, v20
    v_max3_f32 v158, v158, v21, v22
    v_min3_f32 v160, v160, v21, v22
    v_max3_f32 v158, v158, v23, v24
    buffer_load_dwordx4 a[108:111], v1, s[8:11], s54 offen offset:3072 sc1
    v_min3_f32 v160, v160, v23, v24
    v_max3_f32 v158, v158, v25, v26
    v_min3_f32 v160, v160, v25, v26
    v_max3_f32 v158, v158, v27, v28
    v_min3_f32 v160, v160, v27, v28
    v_max3_f32 v158, v158, v29, v30
    v_min3_f32 v160, v160, v29, v30
    v_max_f32 v158, v158, v31
    v_min_f32 v160, v160, v31
    v_mul_f32 v156, 0x3fb8aa3b, v195
    v_mul_f32_e64 v158, v158, v156
    s_add_u32 s54, s54, 4096
    buffer_load_dwordx4 a[112:115], v1, s[8:11], s54 offen sc1
    v_mul_f32_e64 v160, v160, v156
    v_pk_fma_f32 v[72:73], v[12:13], v[156:157], v[158:159] op_sel_hi:[1,0,0] neg_lo:[0,0,1] neg_hi:[0,0,1]
    v_pk_fma_f32 v[74:75], v[14:15], v[156:157], v[158:159] op_sel_hi:[1,0,0] neg_lo:[0,0,1] neg_hi:[0,0,1]
    v_pk_fma_f32 v[76:77], v[16:17], v[156:157], v[158:159] op_sel_hi:[1,0,0] neg_lo:[0,0,1] neg_hi:[0,0,1]
    v_pk_fma_f32 v[78:79], v[18:19], v[156:157], v[158:159] op_sel_hi:[1,0,0] neg_lo:[0,0,1] neg_hi:[0,0,1]
    v_pk_fma_f32 v[80:81], v[20:21], v[156:157], v[158:159] op_sel_hi:[1,0,0] neg_lo:[0,0,1] neg_hi:[0,0,1]
    v_pk_fma_f32 v[82:83], v[22:23], v[156:157], v[158:159] op_sel_hi:[1,0,0] neg_lo:[0,0,1] neg_hi:[0,0,1]
    v_pk_fma_f32 v[84:85], v[24:25], v[156:157], v[158:159] op_sel_hi:[1,0,0] neg_lo:[0,0,1] neg_hi:[0,0,1]
    v_pk_fma_f32 v[86:87], v[26:27], v[156:157], v[158:159] op_sel_hi:[1,0,0] neg_lo:[0,0,1] neg_hi:[0,0,1]
    v_pk_fma_f32 v[88:89], v[28:29], v[156:157], v[158:159] op_sel_hi:[1,0,0] neg_lo:[0,0,1] neg_hi:[0,0,1]
    v_pk_fma_f32 v[90:91], v[30:31], v[156:157], v[158:159] op_sel_hi:[1,0,0] neg_lo:[0,0,1] neg_hi:[0,0,1]
    buffer_store_dwordx4 v[136:139], v8, s[8:11], s37 offen offset:0 sc1
    v_pk_fma_f32 v[92:93], v[12:13], v[156:157], v[160:161] op_sel_hi:[1,0,0] neg_lo:[1,0,0] neg_hi:[1,0,0]
    v_pk_fma_f32 v[94:95], v[14:15], v[156:157], v[160:161] op_sel_hi:[1,0,0] neg_lo:[1,0,0] neg_hi:[1,0,0]
    v_pk_fma_f32 v[96:97], v[16:17], v[156:157], v[160:161] op_sel_hi:[1,0,0] neg_lo:[1,0,0] neg_hi:[1,0,0]
    v_pk_fma_f32 v[98:99], v[18:19], v[156:157], v[160:161] op_sel_hi:[1,0,0] neg_lo:[1,0,0] neg_hi:[1,0,0]
    v_pk_fma_f32 v[100:101], v[20:21], v[156:157], v[160:161] op_sel_hi:[1,0,0] neg_lo:[1,0,0] neg_hi:[1,0,0]
    v_pk_fma_f32 v[102:103], v[22:23], v[156:157], v[160:161] op_sel_hi:[1,0,0] neg_lo:[1,0,0] neg_hi:[1,0,0]
    v_pk_fma_f32 v[104:105], v[24:25], v[156:157], v[160:161] op_sel_hi:[1,0,0] neg_lo:[1,0,0] neg_hi:[1,0,0]
    v_pk_fma_f32 v[106:107], v[26:27], v[156:157], v[160:161] op_sel_hi:[1,0,0] neg_lo:[1,0,0] neg_hi:[1,0,0]
    v_pk_fma_f32 v[108:109], v[28:29], v[156:157], v[160:161] op_sel_hi:[1,0,0] neg_lo:[1,0,0] neg_hi:[1,0,0]
    v_pk_fma_f32 v[110:111], v[30:31], v[156:157], v[160:161] op_sel_hi:[1,0,0] neg_lo:[1,0,0] neg_hi:[1,0,0]
    v_exp_f32_e64 v72, v72
    buffer_load_dwordx4 a[116:119], v1, s[8:11], s54 offen offset:1024 sc1
    v_exp_f32 v73, v73
    v_exp_f32 v74, v74
    v_exp_f32 v75, v75
    v_exp_f32 v76, v76
    v_exp_f32 v77, v77
    v_exp_f32 v78, v78
    v_exp_f32 v79, v79
    v_exp_f32 v80, v80
    v_exp_f32 v81, v81
    v_exp_f32 v82, v82
    v_exp_f32_e64 v83, v83
    buffer_load_dwordx4 a[120:123], v1, s[8:11], s54 offen offset:2048 sc1
    v_exp_f32 v84, v84
    v_exp_f32 v85, v85
    v_exp_f32 v86, v86
    v_exp_f32 v87, v87
    v_exp_f32 v88, v88
    v_exp_f32 v89, v89
    v_exp_f32 v90, v90
    v_exp_f32 v91, v91
    v_exp_f32 v92, v92
    v_exp_f32 v93, v93
    v_exp_f32_e64 v94, v94
    buffer_store_dwordx4 v[140:143], v8, s[8:11], s37 offen offset:512 sc1
    v_exp_f32 v95, v95
    v_exp_f32 v96, v96
    v_exp_f32 v97, v97
    v_exp_f32 v98, v98
    v_exp_f32 v99, v99
    v_exp_f32 v100, v100
    v_exp_f32 v101, v101
    v_exp_f32 v102, v102
    v_exp_f32 v103, v103
    v_exp_f32 v104, v104
    v_exp_f32_e64 v105, v105
    buffer_load_dwordx4 a[124:127], v1, s[8:11], s54 offen offset:3072 sc1
    v_exp_f32 v106, v106
    v_exp_f32 v107, v107
    v_exp_f32 v108, v108
    v_exp_f32 v109, v109
    v_exp_f32 v110, v110
    v_exp_f32 v111, v111
    v_pk_add_f32 v[162:163], v[72:73], v[74:75]
    v_pk_add_f32 v[164:165], v[92:93], v[94:95]
    v_pk_add_f32 v[162:163], v[162:163], v[76:77]
    v_pk_add_f32 v[164:165], v[164:165], v[96:97]
    v_pk_add_f32 v[162:163], v[162:163], v[78:79]
    buffer_store_dwordx4 v[144:147], v8, s[8:11], s37 offen offset:1024 sc1
    v_pk_add_f32 v[164:165], v[164:165], v[98:99]
    v_pk_add_f32 v[162:163], v[162:163], v[80:81]
    v_pk_add_f32 v[164:165], v[164:165], v[100:101]
    v_pk_add_f32 v[162:163], v[162:163], v[82:83]
    v_pk_add_f32 v[164:165], v[164:165], v[102:103]
    v_pk_add_f32 v[162:163], v[162:163], v[84:85]
    v_pk_add_f32 v[164:165], v[164:165], v[104:105]
    v_pk_add_f32 v[162:163], v[162:163], v[86:87]
    v_pk_add_f32 v[164:165], v[164:165], v[106:107]
    v_pk_add_f32 v[162:163], v[162:163], v[88:89]
    v_pk_add_f32 v[164:165], v[164:165], v[108:109]
    buffer_store_dwordx4 v[148:151], v8, s[8:11], s37 offen offset:1536 sc1
    v_pk_add_f32 v[162:163], v[162:163], v[90:91]
    v_pk_add_f32 v[164:165], v[164:165], v[110:111]
    v_add_f32 v162, v162, v163
    v_add_f32 v164, v164, v165
    v_rcp_f32 v162, v162
    v_rcp_f32 v164, v164
    v_pk_mul_f32 v[72:73], v[72:73], v[162:163] op_sel_hi:[1,0]
    v_pk_mul_f32 v[74:75], v[74:75], v[162:163] op_sel_hi:[1,0]
    v_pk_mul_f32 v[76:77], v[76:77], v[162:163] op_sel_hi:[1,0]
    v_pk_mul_f32 v[78:79], v[78:79], v[162:163] op_sel_hi:[1,0]
    v_pk_mul_f32 v[80:81], v[80:81], v[162:163] op_sel_hi:[1,0]
    buffer_store_dwordx4 v[152:155], v9, s[8:11], s37 offen offset:0 sc1
    v_pk_mul_f32 v[82:83], v[82:83], v[162:163] op_sel_hi:[1,0]
    v_pk_mul_f32 v[84:85], v[84:85], v[162:163] op_sel_hi:[1,0]
    v_pk_mul_f32 v[86:87], v[86:87], v[162:163] op_sel_hi:[1,0]
    v_pk_mul_f32 v[88:89], v[88:89], v[162:163] op_sel_hi:[1,0]
    v_pk_mul_f32 v[90:91], v[90:91], v[162:163] op_sel_hi:[1,0]
    v_pk_mul_f32 v[92:93], v[92:93], v[164:165] op_sel_hi:[1,0]
    v_pk_mul_f32 v[94:95], v[94:95], v[164:165] op_sel_hi:[1,0]
    v_pk_mul_f32 v[96:97], v[96:97], v[164:165] op_sel_hi:[1,0]
    v_pk_mul_f32 v[98:99], v[98:99], v[164:165] op_sel_hi:[1,0]
    v_pk_mul_f32 v[100:101], v[100:101], v[164:165] op_sel_hi:[1,0]
    v_pk_mul_f32 v[102:103], v[102:103], v[164:165] op_sel_hi:[1,0]
    v_pk_mul_f32 v[104:105], v[104:105], v[164:165] op_sel_hi:[1,0]
    v_pk_mul_f32 v[106:107], v[106:107], v[164:165] op_sel_hi:[1,0]
    v_pk_mul_f32 v[108:109], v[108:109], v[164:165] op_sel_hi:[1,0]
    v_pk_mul_f32 v[110:111], v[110:111], v[164:165] op_sel_hi:[1,0]
    v_cvt_pk_bf16_f32 v172, v72, v73
    v_cvt_pk_bf16_f32 v173, v74, v75
    v_cvt_pk_bf16_f32 v174, v76, v77
    v_cvt_pk_bf16_f32 v175, v78, v79
    v_cvt_pk_bf16_f32 v176, v80, v81
    v_cvt_pk_bf16_f32 v177, v82, v83
    v_cvt_pk_bf16_f32 v178, v84, v85
    v_cvt_pk_bf16_f32 v179, v86, v87
    v_cvt_pk_bf16_f32 v180, v88, v89
    v_cvt_pk_bf16_f32 v181, v90, v91
    v_cvt_pk_bf16_f32 v182, v92, v93
    v_cvt_pk_bf16_f32 v183, v94, v95
    v_cvt_pk_bf16_f32 v184, v96, v97
    v_cvt_pk_bf16_f32 v185, v98, v99
    v_cvt_pk_bf16_f32 v186, v100, v101
    v_cvt_pk_bf16_f32 v187, v102, v103
    v_cvt_pk_bf16_f32 v188, v104, v105
    v_cvt_pk_bf16_f32 v189, v106, v107
    v_cvt_pk_bf16_f32 v190, v108, v109
    v_cvt_pk_bf16_f32 v191, v110, v111
    buffer_store_dwordx4 v[172:175], v8, s[8:11], s37 offen offset:256 sc1
    buffer_store_dwordx4 v[176:179], v8, s[8:11], s37 offen offset:768 sc1
    buffer_store_dwordx4 v[180:183], v8, s[8:11], s37 offen offset:1280 sc1
    buffer_store_dwordx4 v[184:187], v8, s[8:11], s37 offen offset:1792 sc1
    buffer_store_dwordx4 v[188:191], v9, s[8:11], s37 offen offset:256 sc1
    s_lshl_b32 s30, s40, 11
    s_lshl_b32 s31, s41, 2
    s_add_u32 s30, s30, s31
    s_add_u32 s30, s30, 22544384
    v_lshrrev_b32 v4, 4, v2
    v_lshlrev_b32_e64 v3, 7, v2
    v_lshl_add_u32 v3, v4, 28, v3
    v_mov_b32 v4, 0x01010101
    s_waitcnt vmcnt(0)
    s_barrier
    s_cmp_lg_u32 s24, 0
    s_cbranch_scc1 sig_14
    buffer_store_dword v4, v3, s[8:11], s30 offen sc1
sig_14:
    s_add_u32 s54, s54, 4096
    buffer_load_dwordx4 a[128:131], v1, s[8:11], s54 offen sc1
    buffer_load_dwordx4 a[132:135], v1, s[8:11], s54 offen offset:1024 sc1
    buffer_load_dwordx4 a[136:139], v1, s[8:11], s54 offen offset:2048 sc1
    buffer_load_dwordx4 a[140:143], v1, s[8:11], s54 offen offset:3072 sc1
    s_add_u32 s54, s54, 4096
    buffer_load_dwordx4 a[144:147], v1, s[8:11], s54 offen sc1
    buffer_load_dwordx4 a[148:151], v1, s[8:11], s54 offen offset:1024 sc1
    buffer_load_dwordx4 a[152:155], v1, s[8:11], s54 offen offset:2048 sc1
    buffer_load_dwordx4 a[156:159], v1, s[8:11], s54 offen offset:3072 sc1
    s_add_u32 s54, s54, 4096
    buffer_load_dwordx4 a[160:163], v1, s[8:11], s54 offen sc1
    buffer_load_dwordx4 a[164:167], v1, s[8:11], s54 offen offset:1024 sc1
    buffer_load_dwordx4 a[168:171], v1, s[8:11], s54 offen offset:2048 sc1
    buffer_load_dwordx4 a[172:175], v1, s[8:11], s54 offen offset:3072 sc1
    s_add_u32 s54, s54, 4096
    buffer_load_dwordx4 a[176:179], v1, s[8:11], s54 offen sc1
    buffer_load_dwordx4 a[180:183], v1, s[8:11], s54 offen offset:1024 sc1
    buffer_load_dwordx4 a[184:187], v1, s[8:11], s54 offen offset:2048 sc1
    buffer_load_dwordx4 a[188:191], v1, s[8:11], s54 offen offset:3072 sc1
    s_add_u32 s54, s54, 4096
    buffer_load_dwordx4 a[192:195], v1, s[8:11], s54 offen sc1
    buffer_load_dwordx4 a[196:199], v1, s[8:11], s54 offen offset:1024 sc1
    s_mov_b32 s12, s80
    s_mov_b32 s13, s81
    s_mov_b32 s14, 2621440
    s_mov_b32 s15, 0x20000
    s_lshl_b32 s30, s25, 5
    s_add_u32 s30, s30, s26
    s_lshl_b32 s30, s30, 7
    s_add_u32 s30, s30, 22544384
    s_lshl_b32 s31, s25, 2
    s_lshr_b32 s28, s26, 3
    s_add_u32 s31, s31, s28
    s_lshl_b32 s31, s31, 11
    s_add_u32 s31, s31, 22676480
    s_cmp_lg_u32 s24, 1
    s_cbranch_scc1 sp_15_d
    s_nop 0
    s_mov_b32 s29, 262144
sp_15:
    s_load_dwordx4 s[64:67], s[84:85], s31 offset:0 glc
    s_load_dwordx4 s[68:71], s[84:85], s31 offset:128 glc
    s_load_dwordx4 s[72:75], s[84:85], s31 offset:256 glc
    s_load_dwordx4 s[76:79], s[84:85], s31 offset:384 glc
    s_waitcnt lgkmcnt(0)
    s_and_b32 s64, s64, s65
    s_and_b32 s64, s64, s66
    s_and_b32 s64, s64, s67
    s_and_b32 s64, s64, s68
    s_and_b32 s64, s64, s69
    s_and_b32 s64, s64, s70
    s_and_b32 s64, s64, s71
    s_and_b32 s64, s64, s72
    s_and_b32 s64, s64, s73
    s_and_b32 s64, s64, s74
    s_and_b32 s64, s64, s75
    s_and_b32 s64, s64, s76
    s_and_b32 s64, s64, s77
    s_and_b32 s64, s64, s78
    s_and_b32 s64, s64, s79
    s_cmp_eq_u32 s64, 0x01010101
    s_cbranch_scc1 sp_15_d
    s_sleep 2
    s_sub_u32 s29, s29, 1
    s_cbranch_scc0 sp_15
sp_15_d:
    s_cmp_lg_u32 s24, 0
    s_cbranch_scc1 sp_16_d
    s_mov_b32 s29, 262144
sp_16:
    s_load_dwordx4 s[64:67], s[84:85], s30 offset:0 glc
    s_waitcnt lgkmcnt(0)
    s_and_b32 s64, s64, s65
    s_and_b32 s64, s64, s66
    s_and_b32 s64, s64, s67
    s_cmp_eq_u32 s64, 0x01010101
    s_cbranch_scc1 sp_16_d
    s_sleep 2
    s_sub_u32 s29, s29, 1
    s_cbranch_scc0 sp_16
sp_16_d:
    s_barrier
    s_branch L_join
L_side:
    s_sub_u32 s30, s26, 24
    s_lshl_b32 s31, s30, 3
    s_add_u32 s40, s31, s25
    v_lshrrev_b32 v12, 3, v2
    v_and_b32_e64 v13, 7, v2
    v_mul_u32_u24 v8, 1280, v12
    v_lshl_add_u32 v8, v13, 4, v8
    v_mul_u32_u24 v9, 3840, v12
    v_lshl_add_u32 v9, v13, 4, v9
    s_lshl_b32 s31, s25, 3
    s_add_u32 s31, s31, s30
    s_lshl_b32 s31, s31, 2
    s_add_u32 s53, s31, s24
    s_mul_i32 s34, s53, 10240
    s_lshr_b32 s31, s30, 1
    s_lshl_b32 s31, s31, 2
    s_lshr_b32 s32, s25, 1
    s_add_u32 s32, s32, s31
    s_mul_i32 s31, s32, 52
    s_lshr_b32 s31, s31, 8
    s_mul_i32 s31, s31, 5
    s_add_u32 s31, s31, s32
    s_and_b32 s33, s25, 1
    s_mul_i32 s33, s33, 5
    s_add_u32 s38, s31, s33
    s_lshl_b32 s36, s38, 7
    s_and_b32 s39, s30, 1
    s_lshl_b32 s31, s39, 2
    s_add_u32 s31, s31, s24
    s_mul_i32 s31, s31, 30720
    s_add_u32 s36, s36, s31
    s_cmp_eq_u32 s32, 15
    s_cselect_b32 s36, 1073741824, s36
    buffer_load_dwordx4 v[16:19], v8, s[16:19], s34 offen offset:0
    buffer_load_dwordx4 v[20:23], v9, s[20:23], s36 offen
    s_add_u32 s36, s36, 245760
    buffer_load_dwordx4 v[24:27], v8, s[16:19], s34 offen offset:128
    buffer_load_dwordx4 v[28:31], v9, s[20:23], s36 offen
    s_add_u32 s36, s36, 245760
    buffer_load_dwordx4 v[32:35], v8, s[16:19], s34 offen offset:256
    buffer_load_dwordx4 v[36:39], v9, s[20:23], s36 offen
    s_add_u32 s36, s36, 245760
    buffer_load_dwordx4 v[40:43], v8, s[16:19], s34 offen offset:384
    buffer_load_dwordx4 v[44:47], v9, s[20:23], s36 offen
    s_add_u32 s36, s36, 245760
    s_mov_b32 s12, s70
    s_mov_b32 s13, s71
    s_mov_b32 s14, 819200
    s_mov_b32 s15, 0x20000
    s_and_b32 s41, s40, 3
    s_bfe_u32 s42, s40, 0x20002
    s_bfe_u32 s43, s40, 0x10004
    s_lshr_b32 s44, s40, 5
    s_and_b32 s57, s40, 15
    s_lshr_b32 s58, s40, 4
    s_lshr_b32 s59, s40, 2
    s_and_b32 s37, s40, 3
    s_lshl_b32 s30, s42, 1
    s_add_u32 s30, s30, s43
    s_mul_i32 s30, s30, 102400
    s_mul_i32 s31, s41, 320
    s_add_u32 s30, s30, s31
    s_min_u32 s31, s42, 2
    s_lshl_b32 s32, s42, 1
    s_add_u32 s32, s32, s31
    s_mul_i32 s31, s44, 6
    s_add_u32 s32, s32, s31
    s_lshl_b32 s31, s24, 8
    v_add_u32_e64 v10, s31, v2
    s_lshl_b32 s31, s24, 12
    v_mul_u32_u24 v14, 5462, v10
    v_lshrrev_b32 v14, 16, v14
    v_mul_u32_u24 v15, 12, v14
    v_sub_u32 v15, v10, v15
    v_lshrrev_b32 v11, 1, v15
    v_add_u32 v11, s32, v11
    v_subrev_u32 v208, 10, v11
    v_min_u32 v11, v11, v208
    v_and_b32 v15, 1, v15
    v_lshl_add_u32 v11, v11, 1, v15
    v_mul_u32_u24 v14, 1280, v14
    v_lshl_add_u32 v11, v11, 4, v14
    s_add_u32 m0, s31, 0
    v_add_u32 v10, 64, v10
    buffer_load_dwordx4 v11, s[12:15], s30 offen lds
    v_mul_u32_u24 v14, 5462, v10
    v_lshrrev_b32 v14, 16, v14
    v_mul_u32_u24 v15, 12, v14
    v_sub_u32 v15, v10, v15
    v_lshrrev_b32 v11, 1, v15
    v_add_u32 v11, s32, v11
    v_subrev_u32 v208, 10, v11
    v_min_u32 v11, v11, v208
    v_and_b32 v15, 1, v15
    v_lshl_add_u32 v11, v11, 1, v15
    v_mul_u32_u24 v14, 1280, v14
    v_lshl_add_u32 v11, v11, 4, v14
    s_add_u32 m0, s31, 1024
    v_add_u32_e64 v10, 64, v10
    buffer_load_dwordx4 v11, s[12:15], s30 offen lds
    v_mul_u32_u24 v14, 5462, v10
    v_lshrrev_b32 v14, 16, v14
    v_mul_u32_u24 v15, 12, v14
    v_sub_u32 v15, v10, v15
    v_lshrrev_b32 v11, 1, v15
    v_add_u32 v11, s32, v11
    v_subrev_u32 v208, 10, v11
    v_min_u32 v11, v11, v208
    v_and_b32 v15, 1, v15
    v_lshl_add_u32 v11, v11, 1, v15
    v_mul_u32_u24 v14, 1280, v14
    v_lshl_add_u32 v11, v11, 4, v14
    s_add_u32 m0, s31, 2048
    v_add_u32_e64 v10, 64, v10
    buffer_load_dwordx4 v11, s[12:15], s30 offen lds
    v_mul_u32_u24 v14, 5462, v10
    v_lshrrev_b32 v14, 16, v14
    v_mul_u32_u24 v15, 12, v14
    v_sub_u32 v15, v10, v15
    v_lshrrev_b32 v11, 1, v15
    v_add_u32 v11, s32, v11
    v_subrev_u32 v208, 10, v11
    v_min_u32 v11, v11, v208
    v_and_b32 v15, 1, v15
    v_lshl_add_u32 v11, v11, 1, v15
    v_mul_u32_u24 v14, 1280, v14
    v_lshl_add_u32 v11, v11, 4, v14
    s_add_u32 m0, s31, 3072
    v_add_u32_e64 v10, 64, v10
    buffer_load_dwordx4 v11, s[12:15], s30 offen lds
    buffer_load_dwordx4 v[48:51], v8, s[16:19], s34 offen offset:512
    buffer_load_dwordx4 v[52:55], v9, s[20:23], s36 offen
    s_add_u32 s36, s36, 245760
    buffer_load_dwordx4 v[56:59], v8, s[16:19], s34 offen offset:640
    buffer_load_dwordx4 v[60:63], v9, s[20:23], s36 offen
    s_add_u32 s36, s36, 245760
    buffer_load_dwordx4 v[64:67], v8, s[16:19], s34 offen offset:768
    buffer_load_dwordx4 v[68:71], v9, s[20:23], s36 offen
    s_add_u32 s36, s36, 245760
    buffer_load_dwordx4 v[72:75], v8, s[16:19], s34 offen offset:896
    buffer_load_dwordx4 v[76:79], v9, s[20:23], s36 offen
    s_add_u32 s36, s36, 245760
    buffer_load_dwordx4 v[80:83], v8, s[16:19], s34 offen offset:1024
    buffer_load_dwordx4 v[84:87], v9, s[20:23], s36 offen
    s_add_u32 s36, s36, 245760
    buffer_load_dwordx4 v[88:91], v8, s[16:19], s34 offen offset:1152
    buffer_load_dwordx4 v[92:95], v9, s[20:23], s36 offen
    s_add_u32 s36, s36, 245760
    v_mov_b32 v208, 0
    v_mov_b32 v209, 0
    v_mov_b32 v210, 0
    v_mov_b32_e64 v211, 0
    s_lshl_b32 s30, s40, 11
    s_add_u32 s33, s30, 22544384
    s_add_u32 s30, s30, 22020096
    s_mul_i32 s31, s40, 3072
    s_add_u32 s31, s31, 22294528
    s_cmp_ge_u32 s40, 60
    s_cselect_b32 s30, s31, s30
    s_cselect_b32 s31, s31, 1073741824
    s_sub_u32 s32, s40, 32
    s_cmp_lt_u32 s32, 28
    s_cselect_b32 s30, 1073741824, s30
    s_cmp_eq_u32 s24, 0
    s_cselect_b32 s30, s30, 1073741824
    s_cselect_b32 s31, s31, 1073741824
    s_cmp_eq_u32 s24, 1
    s_cselect_b32 s33, s33, 1073741824
    buffer_store_dwordx4 v[208:211], v1, s[8:11], s30 offen sc1
    buffer_store_dwordx4 v[208:211], v1, s[8:11], s30 offen offset:1024 sc1
    buffer_store_dwordx4 v[208:211], v1, s[8:11], s31 offen offset:2048 sc1
    v_lshrrev_b32 v10, 2, v2
    v_and_b32 v11, 3, v2
    v_lshlrev_b32 v11, 4, v11
    v_lshl_add_u32 v10, v10, 7, v11
    buffer_store_dwordx4 v[208:211], v10, s[8:11], s33 offen sc1
    s_lshl_b32 s33, s40, 10
    s_add_u32 s33, s33, 22675456
    s_cmp_eq_u32 s24, 2
    s_cselect_b32 s33, s33, 1073741824
    v_lshrrev_b32 v11, 3, v2
    v_lshlrev_b32_e64 v10, 7, v2
    v_lshl_add_u32 v10, v11, 27, v10
    buffer_store_dwordx4 v[208:211], v10, s[8:11], s33 offen sc1
    s_waitcnt vmcnt(17)
    s_barrier
    v_bfe_u32 v240, v2, 2, 2
    v_lshrrev_b32 v241, 5, v2
    v_mul_u32_u24 v241, 10, v241
    v_bfe_u32 v242, v2, 4, 1
    v_lshlrev_b32 v242, 5, v242
    v_and_b32 v243, 1, v2
    v_lshl_add_u32 v242, v243, 4, v242
    v_bfe_u32 v243, v2, 1, 1
    v_lshl_add_u32 v242, v243, 3, v242
    s_lshl_b32 s33, s41, 2
    s_add_u32 s33, s33, s42
    s_mul_i32 s33, s33, 50
    s_mul_i32 s30, s43, 25
    s_add_u32 s33, s33, s30
    s_mul_i32 s30, s44, 3
    s_add_u32 s33, s33, s30
    s_lshl_b32 s30, s24, 2
    s_add_u32 s30, s30, 0
    s_mul_i32 s31, s30, 86
    s_lshr_b32 s31, s31, 8
    s_mul_i32 s32, s31, 3
    s_sub_u32 s32, s30, s32
    s_mul_i32 s34, s31, 5
    s_add_u32 s34, s34, s32
    s_add_u32 s34, s34, s33
    s_lshl_b32 s34, s34, 10
    s_cmp_eq_u32 s30, 15
    s_cselect_b32 s34, 1073741824, s34
    s_add_u32 s35, s32, s44
    s_cmp_eq_u32 s35, 3
    s_cselect_b32 s45, 1073741824, s34
    s_lshl_b32 s31, s31, 3
    s_lshl_b32 s32, s32, 6
    v_add_u32 v243, s31, v240
    v_mul_u32_u24 v244, 26, v243
    v_lshrrev_b32 v244, 8, v244
    v_mul_u32_u24_e64 v244, 10, v244
    v_add3_u32 v243, v243, v244, v241
    v_mul_u32_u24 v243, 192, v243
    v_add3_u32 v243, v243, v242, s32
    ds_read_b64_tr_b16 v[176:177], v243
    v_add_u32 v243, s31, v240
    v_add_u32 v243, 4, v243
    v_mul_u32_u24 v244, 26, v243
    v_lshrrev_b32 v244, 8, v244
    v_mul_u32_u24_e64 v244, 10, v244
    v_add3_u32 v243, v243, v244, v241
    v_mul_u32_u24 v243, 192, v243
    v_add3_u32 v243, v243, v242, s32
    ds_read_b64_tr_b16 v[178:179], v243
    s_lshl_b32 s30, s24, 2
    s_add_u32 s30, s30, 1
    s_mul_i32 s31, s30, 86
    s_lshr_b32 s31, s31, 8
    s_mul_i32 s32, s31, 3
    s_sub_u32 s32, s30, s32
    s_mul_i32 s34, s31, 5
    s_add_u32 s34, s34, s32
    s_add_u32 s34, s34, s33
    s_lshl_b32 s34, s34, 10
    s_cmp_eq_u32 s30, 15
    s_cselect_b32 s34, 1073741824, s34
    s_add_u32 s35, s32, s44
    s_cmp_eq_u32 s35, 3
    s_cselect_b32 s46, 1073741824, s34
    s_lshl_b32 s31, s31, 3
    s_lshl_b32 s32, s32, 6
    v_add_u32 v243, s31, v240
    v_mul_u32_u24 v244, 26, v243
    v_lshrrev_b32 v244, 8, v244
    v_mul_u32_u24 v244, 10, v244
    v_add3_u32 v243, v243, v244, v241
    v_mul_u32_u24 v243, 192, v243
    v_add3_u32 v243, v243, v242, s32
    ds_read_b64_tr_b16 v[180:181], v243
    v_add_u32 v243, s31, v240
    v_add_u32 v243, 4, v243
    v_mul_u32_u24 v244, 26, v243
    v_lshrrev_b32 v244, 8, v244
    v_mul_u32_u24_e64 v244, 10, v244
    v_add3_u32 v243, v243, v244, v241
    v_mul_u32_u24 v243, 192, v243
    v_add3_u32 v243, v243, v242, s32
    ds_read_b64_tr_b16 v[182:183], v243
    s_lshl_b32 s30, s24, 2
    s_add_u32 s30, s30, 2
    s_mul_i32 s31, s30, 86
    s_lshr_b32 s31, s31, 8
    s_mul_i32 s32, s31, 3
    s_sub_u32 s32, s30, s32
    s_mul_i32 s34, s31, 5
    s_add_u32 s34, s34, s32
    s_add_u32 s34, s34, s33
    s_lshl_b32 s34, s34, 10
    s_cmp_eq_u32 s30, 15
    s_cselect_b32 s34, 1073741824, s34
    s_add_u32 s35, s32, s44
    s_cmp_eq_u32 s35, 3
    s_cselect_b32 s47, 1073741824, s34
    s_lshl_b32 s31, s31, 3
    s_lshl_b32 s32, s32, 6
    v_add_u32 v243, s31, v240
    v_mul_u32_u24 v244, 26, v243
    v_lshrrev_b32 v244, 8, v244
    v_mul_u32_u24 v244, 10, v244
    v_add3_u32 v243, v243, v244, v241
    v_mul_u32_u24 v243, 192, v243
    v_add3_u32 v243, v243, v242, s32
    ds_read_b64_tr_b16 v[184:185], v243
    v_add_u32 v243, s31, v240
    v_add_u32 v243, 4, v243
    v_mul_u32_u24 v244, 26, v243
    v_lshrrev_b32 v244, 8, v244
    v_mul_u32_u24_e64 v244, 10, v244
    v_add3_u32 v243, v243, v244, v241
    v_mul_u32_u24 v243, 192, v243
    v_add3_u32 v243, v243, v242, s32
    ds_read_b64_tr_b16 v[186:187], v243
    s_lshl_b32 s30, s24, 2
    s_add_u32 s30, s30, 3
    s_mul_i32 s31, s30, 86
    s_lshr_b32 s31, s31, 8
    s_mul_i32 s32, s31, 3
    s_sub_u32 s32, s30, s32
    s_mul_i32 s34, s31, 5
    s_add_u32 s34, s34, s32
    s_add_u32 s34, s34, s33
    s_lshl_b32 s34, s34, 10
    s_cmp_eq_u32 s30, 15
    s_cselect_b32 s34, 1073741824, s34
    s_add_u32 s35, s32, s44
    s_cmp_eq_u32 s35, 3
    s_cselect_b32 s48, 1073741824, s34
    s_lshl_b32 s31, s31, 3
    s_lshl_b32 s32, s32, 6
    v_add_u32 v243, s31, v240
    v_mul_u32_u24 v244, 26, v243
    v_lshrrev_b32 v244, 8, v244
    v_mul_u32_u24 v244, 10, v244
    v_add3_u32 v243, v243, v244, v241
    v_mul_u32_u24 v243, 192, v243
    v_add3_u32 v243, v243, v242, s32
    ds_read_b64_tr_b16 v[188:189], v243
    v_add_u32 v243, s31, v240
    v_add_u32 v243, 4, v243
    v_mul_u32_u24 v244, 26, v243
    v_lshrrev_b32 v244, 8, v244
    v_mul_u32_u24_e64 v244, 10, v244
    v_add3_u32 v243, v243, v244, v241
    v_mul_u32_u24 v243, 192, v243
    v_add3_u32 v243, v243, v242, s32
    ds_read_b64_tr_b16 v[190:191], v243
    s_waitcnt lgkmcnt(6)
    buffer_store_dwordx4 v[176:179], v1, s[8:11], s45 offen sc1
    s_waitcnt lgkmcnt(4)
    buffer_store_dwordx4 v[180:183], v1, s[8:11], s46 offen sc1
    s_waitcnt lgkmcnt(2)
    buffer_store_dwordx4 v[184:187], v1, s[8:11], s47 offen sc1
    s_waitcnt lgkmcnt(0)
    buffer_store_dwordx4 v[188:191], v1, s[8:11], s48 offen sc1
    v_mov_b32 v3, 0x3f803f80
    v_mov_b32 v4, 0x00003f80
    v_mov_b32 v6, 0x3f800000
    v_mov_b32 v208, 0
    v_mov_b32 v209, 0
    v_mov_b32 v210, 0
    v_mov_b32 v211, 0
    v_mov_b32 v212, 0
    v_mov_b32 v213, 0
    v_mov_b32 v214, 0
    v_mov_b32 v215, 0
    v_mov_b32 v216, 0
    v_mov_b32_e64 v217, 0
    v_dot2_f32_bf16 v216, v16, v3, v216
    v_dot2_f32_bf16 v217, v16, v16, v217
    v_dot2_f32_bf16 v216, v17, v3, v216
    v_dot2_f32_bf16 v217, v17, v17, v217
    v_dot2_f32_bf16 v216, v18, v3, v216
    v_dot2_f32_bf16 v217, v18, v18, v217
    v_dot2_f32_bf16 v216, v19, v3, v216
    v_dot2_f32_bf16 v217, v19, v19, v217
    v_dot2_f32_bf16 v208, v20, v4, v208
    v_dot2_f32_bf16 v209, v20, v6, v209
    v_dot2_f32_bf16 v210, v21, v4, v210
    v_dot2_f32_bf16 v211, v21, v6, v211
    v_dot2_f32_bf16 v212, v22, v4, v212
    v_dot2_f32_bf16 v213, v22, v6, v213
    v_dot2_f32_bf16 v214, v23, v4, v214
    v_dot2_f32_bf16 v215, v23, v6, v215
    v_dot2_f32_bf16 v216, v24, v3, v216
    v_dot2_f32_bf16 v217, v24, v24, v217
    v_dot2_f32_bf16 v216, v25, v3, v216
    v_dot2_f32_bf16 v217, v25, v25, v217
    v_dot2_f32_bf16 v216, v26, v3, v216
    v_dot2_f32_bf16 v217, v26, v26, v217
    v_dot2_f32_bf16 v216, v27, v3, v216
    v_dot2_f32_bf16 v217, v27, v27, v217
    v_dot2_f32_bf16 v208, v28, v4, v208
    v_dot2_f32_bf16 v209, v28, v6, v209
    v_dot2_f32_bf16 v210, v29, v4, v210
    v_dot2_f32_bf16 v211, v29, v6, v211
    v_dot2_f32_bf16 v212, v30, v4, v212
    v_dot2_f32_bf16 v213, v30, v6, v213
    v_dot2_f32_bf16 v214, v31, v4, v214
    v_dot2_f32_bf16 v215, v31, v6, v215
    v_dot2_f32_bf16 v216, v32, v3, v216
    v_dot2_f32_bf16 v217, v32, v32, v217
    v_dot2_f32_bf16 v216, v33, v3, v216
    v_dot2_f32_bf16 v217, v33, v33, v217
    v_dot2_f32_bf16 v216, v34, v3, v216
    v_dot2_f32_bf16 v217, v34, v34, v217
    v_dot2_f32_bf16 v216, v35, v3, v216
    v_dot2_f32_bf16 v217, v35, v35, v217
    v_dot2_f32_bf16 v208, v36, v4, v208
    v_dot2_f32_bf16 v209, v36, v6, v209
    v_dot2_f32_bf16 v210, v37, v4, v210
    v_dot2_f32_bf16 v211, v37, v6, v211
    v_dot2_f32_bf16 v212, v38, v4, v212
    v_dot2_f32_bf16 v213, v38, v6, v213
    v_dot2_f32_bf16 v214, v39, v4, v214
    v_dot2_f32_bf16 v215, v39, v6, v215
    v_dot2_f32_bf16 v216, v40, v3, v216
    v_dot2_f32_bf16 v217, v40, v40, v217
    v_dot2_f32_bf16 v216, v41, v3, v216
    v_dot2_f32_bf16 v217, v41, v41, v217
    v_dot2_f32_bf16 v216, v42, v3, v216
    v_dot2_f32_bf16 v217, v42, v42, v217
    v_dot2_f32_bf16 v216, v43, v3, v216
    v_dot2_f32_bf16 v217, v43, v43, v217
    v_dot2_f32_bf16 v208, v44, v4, v208
    v_dot2_f32_bf16 v209, v44, v6, v209
    v_dot2_f32_bf16 v210, v45, v4, v210
    v_dot2_f32_bf16 v211, v45, v6, v211
    v_dot2_f32_bf16 v212, v46, v4, v212
    v_dot2_f32_bf16 v213, v46, v6, v213
    v_dot2_f32_bf16 v214, v47, v4, v214
    v_dot2_f32_bf16 v215, v47, v6, v215
    s_waitcnt vmcnt(20)
    s_nop 0
    v_dot2_f32_bf16 v216, v48, v3, v216
    v_dot2_f32_bf16 v217, v48, v48, v217
    v_dot2_f32_bf16 v216, v49, v3, v216
    v_dot2_f32_bf16 v217, v49, v49, v217
    v_dot2_f32_bf16 v216, v50, v3, v216
    v_dot2_f32_bf16 v217, v50, v50, v217
    v_dot2_f32_bf16 v216, v51, v3, v216
    v_dot2_f32_bf16 v217, v51, v51, v217
    s_waitcnt vmcnt(19)
    s_nop 0
    v_dot2_f32_bf16 v208, v52, v4, v208
    v_dot2_f32_bf16 v209, v52, v6, v209
    v_dot2_f32_bf16 v210, v53, v4, v210
    v_dot2_f32_bf16 v211, v53, v6, v211
    v_dot2_f32_bf16 v212, v54, v4, v212
    v_dot2_f32_bf16 v213, v54, v6, v213
    v_dot2_f32_bf16 v214, v55, v4, v214
    v_dot2_f32_bf16 v215, v55, v6, v215
    s_waitcnt vmcnt(18)
    s_nop 0
    v_dot2_f32_bf16 v216, v56, v3, v216
    v_dot2_f32_bf16 v217, v56, v56, v217
    v_dot2_f32_bf16 v216, v57, v3, v216
    v_dot2_f32_bf16 v217, v57, v57, v217
    v_dot2_f32_bf16 v216, v58, v3, v216
    v_dot2_f32_bf16 v217, v58, v58, v217
    v_dot2_f32_bf16 v216, v59, v3, v216
    v_dot2_f32_bf16 v217, v59, v59, v217
    s_waitcnt vmcnt(17)
    s_nop 0
    v_dot2_f32_bf16 v208, v60, v4, v208
    v_dot2_f32_bf16 v209, v60, v6, v209
    v_dot2_f32_bf16 v210, v61, v4, v210
    v_dot2_f32_bf16 v211, v61, v6, v211
    v_dot2_f32_bf16 v212, v62, v4, v212
    v_dot2_f32_bf16 v213, v62, v6, v213
    v_dot2_f32_bf16 v214, v63, v4, v214
    v_dot2_f32_bf16 v215, v63, v6, v215
    s_waitcnt vmcnt(16)
    s_nop 0
    v_dot2_f32_bf16 v216, v64, v3, v216
    v_dot2_f32_bf16 v217, v64, v64, v217
    v_dot2_f32_bf16 v216, v65, v3, v216
    v_dot2_f32_bf16 v217, v65, v65, v217
    v_dot2_f32_bf16 v216, v66, v3, v216
    v_dot2_f32_bf16 v217, v66, v66, v217
    v_dot2_f32_bf16 v216, v67, v3, v216
    v_dot2_f32_bf16 v217, v67, v67, v217
    s_waitcnt vmcnt(15)
    s_nop 0
    v_dot2_f32_bf16 v208, v68, v4, v208
    v_dot2_f32_bf16 v209, v68, v6, v209
    v_dot2_f32_bf16 v210, v69, v4, v210
    v_dot2_f32_bf16 v211, v69, v6, v211
    v_dot2_f32_bf16 v212, v70, v4, v212
    v_dot2_f32_bf16 v213, v70, v6, v213
    v_dot2_f32_bf16 v214, v71, v4, v214
    v_dot2_f32_bf16 v215, v71, v6, v215
    s_waitcnt vmcnt(14)
    s_nop 0
    v_dot2_f32_bf16 v216, v72, v3, v216
    v_dot2_f32_bf16 v217, v72, v72, v217
    v_dot2_f32_bf16 v216, v73, v3, v216
    v_dot2_f32_bf16 v217, v73, v73, v217
    v_dot2_f32_bf16 v216, v74, v3, v216
    v_dot2_f32_bf16 v217, v74, v74, v217
    v_dot2_f32_bf16 v216, v75, v3, v216
    v_dot2_f32_bf16 v217, v75, v75, v217
    s_waitcnt vmcnt(13)
    s_nop 0
    v_dot2_f32_bf16 v208, v76, v4, v208
    v_dot2_f32_bf16 v209, v76, v6, v209
    v_dot2_f32_bf16 v210, v77, v4, v210
    v_dot2_f32_bf16 v211, v77, v6, v211
    v_dot2_f32_bf16 v212, v78, v4, v212
    v_dot2_f32_bf16 v213, v78, v6, v213
    v_dot2_f32_bf16 v214, v79, v4, v214
    v_dot2_f32_bf16 v215, v79, v6, v215
    s_waitcnt vmcnt(12)
    s_nop 0
    v_dot2_f32_bf16 v216, v80, v3, v216
    v_dot2_f32_bf16 v217, v80, v80, v217
    v_dot2_f32_bf16 v216, v81, v3, v216
    v_dot2_f32_bf16 v217, v81, v81, v217
    v_dot2_f32_bf16 v216, v82, v3, v216
    v_dot2_f32_bf16 v217, v82, v82, v217
    v_dot2_f32_bf16 v216, v83, v3, v216
    v_dot2_f32_bf16 v217, v83, v83, v217
    s_waitcnt vmcnt(11)
    s_nop 0
    v_dot2_f32_bf16 v208, v84, v4, v208
    v_dot2_f32_bf16 v209, v84, v6, v209
    v_dot2_f32_bf16 v210, v85, v4, v210
    v_dot2_f32_bf16 v211, v85, v6, v211
    v_dot2_f32_bf16 v212, v86, v4, v212
    v_dot2_f32_bf16 v213, v86, v6, v213
    v_dot2_f32_bf16 v214, v87, v4, v214
    v_dot2_f32_bf16 v215, v87, v6, v215
    s_waitcnt vmcnt(10)
    s_nop 0
    v_dot2_f32_bf16 v216, v88, v3, v216
    v_dot2_f32_bf16 v217, v88, v88, v217
    v_dot2_f32_bf16 v216, v89, v3, v216
    v_dot2_f32_bf16 v217, v89, v89, v217
    v_dot2_f32_bf16 v216, v90, v3, v216
    v_dot2_f32_bf16 v217, v90, v90, v217
    v_dot2_f32_bf16 v216, v91, v3, v216
    v_dot2_f32_bf16 v217, v91, v91, v217
    s_waitcnt vmcnt(9)
    s_nop 0
    v_dot2_f32_bf16 v208, v92, v4, v208
    v_dot2_f32_bf16 v209, v92, v6, v209
    v_dot2_f32_bf16 v210, v93, v4, v210
    v_dot2_f32_bf16 v211, v93, v6, v211
    v_dot2_f32_bf16 v212, v94, v4, v212
    v_dot2_f32_bf16 v213, v94, v6, v213
    v_dot2_f32_bf16 v214, v95, v4, v214
    v_dot2_f32_bf16 v215, v95, v6, v215
    s_nop 2
    s_nop 0
    v_add_f32_dpp v208, v208, v208 row_ror:8 row_mask:0xf bank_mask:0xf
    v_add_f32_dpp v209, v209, v209 row_ror:8 row_mask:0xf bank_mask:0xf
    v_add_f32_dpp v210, v210, v210 row_ror:8 row_mask:0xf bank_mask:0xf
    v_add_f32_dpp v211, v211, v211 row_ror:8 row_mask:0xf bank_mask:0xf
    v_add_f32_dpp v212, v212, v212 row_ror:8 row_mask:0xf bank_mask:0xf
    v_add_f32_dpp v213, v213, v213 row_ror:8 row_mask:0xf bank_mask:0xf
    v_add_f32_dpp v214, v214, v214 row_ror:8 row_mask:0xf bank_mask:0xf
    v_add_f32_dpp v215, v215, v215 row_ror:8 row_mask:0xf bank_mask:0xf
    v_mov_b32 v16, v208
    v_mov_b32 v17, v209
    v_mov_b32 v18, v210
    v_mov_b32 v19, v211
    v_mov_b32 v20, v212
    v_mov_b32 v21, v213
    v_mov_b32 v22, v214
    v_mov_b32 v23, v215
    v_permlane16_swap_b32 v208, v16
    v_permlane16_swap_b32 v209, v17
    v_permlane16_swap_b32 v210, v18
    v_permlane16_swap_b32 v211, v19
    v_permlane16_swap_b32 v212, v20
    v_permlane16_swap_b32 v213, v21
    v_permlane16_swap_b32 v214, v22
    v_permlane16_swap_b32 v215, v23
    v_add_f32 v208, v208, v16
    v_add_f32 v209, v209, v17
    v_add_f32 v210, v210, v18
    v_add_f32 v211, v211, v19
    v_add_f32 v212, v212, v20
    v_add_f32 v213, v213, v21
    v_add_f32 v214, v214, v22
    v_add_f32 v215, v215, v23
    v_mov_b32 v16, v208
    v_mov_b32 v17, v209
    v_mov_b32 v18, v210
    v_mov_b32 v19, v211
    v_mov_b32 v20, v212
    v_mov_b32 v21, v213
    v_mov_b32 v22, v214
    v_mov_b32 v23, v215
    v_permlane32_swap_b32 v208, v16
    v_permlane32_swap_b32 v209, v17
    v_permlane32_swap_b32 v210, v18
    v_permlane32_swap_b32 v211, v19
    v_permlane32_swap_b32 v212, v20
    v_permlane32_swap_b32 v213, v21
    v_permlane32_swap_b32 v214, v22
    v_permlane32_swap_b32 v215, v23
    v_add_f32 v208, v208, v16
    v_add_f32 v209, v209, v17
    v_add_f32 v210, v210, v18
    v_add_f32 v211, v211, v19
    v_add_f32 v212, v212, v20
    v_add_f32 v213, v213, v21
    v_add_f32 v214, v214, v22
    v_add_f32_e64 v215, v215, v23
    s_lshl_b32 s31, s24, 8
    s_add_u32 s31, s31, 110592
    v_lshl_add_u32 v8, v13, 5, s31
    ds_write_b128 v8, v[208:211]
    ds_write_b128 v8, v[212:215] offset:16
    v_add_f32_dpp v216, v216, v216 quad_perm:[1,0,3,2] row_mask:0xf bank_mask:0xf
    v_add_f32_dpp v217, v217, v217 quad_perm:[1,0,3,2] row_mask:0xf bank_mask:0xf
    s_nop 0
    v_add_f32_dpp v216, v216, v216 quad_perm:[2,3,0,1] row_mask:0xf bank_mask:0xf
    v_add_f32_dpp v217, v217, v217 quad_perm:[2,3,0,1] row_mask:0xf bank_mask:0xf
    s_nop 0
    v_add_f32_dpp v216, v216, v216 row_half_mirror row_mask:0xf bank_mask:0xf
    v_add_f32_dpp v217, v217, v217 row_half_mirror row_mask:0xf bank_mask:0xf
    v_mul_f32 v216, 0x3acccccd, v216
    v_mul_f32 v217, 0x3acccccd, v217
    v_fma_f32 v217, -v216, v216, v217
    v_max_f32_e64 v217, 0, v217
    v_add_f32 v217, 0x3727c5ac, v217
    v_rsq_f32 v217, v217
    v_lshlrev_b32 v8, 2, v12
    v_lshl_add_u32 v8, v13, 27, v8
    s_lshl_b32 s30, s53, 5
    s_add_u32 s30, s30, 22151168
    s_add_u32 s31, s30, 8192
    buffer_store_dword v216, v8, s[8:11], s30 offen sc1
    buffer_store_dword v217, v8, s[8:11], s31 offen sc1
    v_lshlrev_b32 v9, 2, v2
    v_add_u32 v10, 110592, v9
    s_lshl_b32 s30, s38, 8
    s_mul_i32 s31, s39, 7680
    s_add_u32 s30, s30, s31
    s_add_u32 s30, s30, 22183936
    s_cmp_ge_u32 s38, 30
    s_cselect_b32 s30, 1073741824, s30
    s_cmp_eq_u32 s24, 0
    s_cselect_b32 s30, s30, 1073741824
    s_waitcnt lgkmcnt(0)
    s_barrier
    ds_read_b32 v208, v10 offset:0
    ds_read_b32 v209, v10 offset:256
    ds_read_b32 v210, v10 offset:512
    ds_read_b32 v211, v10 offset:768
    s_waitcnt lgkmcnt(2)
    v_add_f32 v208, v208, v209
    s_waitcnt lgkmcnt(0)
    v_add_f32 v210, v210, v211
    v_add_f32_e64 v208, v208, v210
    buffer_store_dword v208, v9, s[8:11], s30 offen sc1
    v_mov_b32 v14, 0
    v_mov_b32_e64 v15, 1
    s_waitcnt vmcnt(0)
    s_barrier
    s_cmp_lg_u32 s24, 0
    s_cbranch_scc1 s0sig_18
    s_mov_b64 exec, 1
    global_atomic_add v11, v14, v15, s[82:83] sc0 sc1
    s_waitcnt vmcnt(0)
    v_readfirstlane_b32 s33, v11
    s_nop 1
    s_cmp_lg_u32 s33, 63
    s_cbranch_scc1 s0sig_18_x
    global_store_dword v14, v15, s[82:83] offset:128 sc1
s0sig_18_x:
    s_mov_b64 exec, -1
s0sig_18:
    s_and_b32 s30, s26, 3
    s_lshl_b32 s31, s30, 2
    s_add_u32 s31, s31, s24
    s_mul_i32 s54, s31, 51200
    s_lshr_b32 s32, s25, 1
    s_lshl_b32 s32, s32, 4
    s_add_u32 s32, s32, s31
    s_mul_i32 s27, s32, 61440
    s_lshr_b32 s32, s32, 2
    s_mul_i32 s55, s32, 192
    s_lshr_b32 s32, s24, 1
    s_mul_i32 s32, s32, 983040
    s_add_u32 s55, s55, s32
    s_add_u32 s55, s27, 1048576
    s_and_b32 s32, s25, 1
    s_lshl_b32 s32, s32, 4
    s_add_u32 s32, s32, s31
    s_mul_i32 s56, s32, 61440
    s_add_u32 s56, s56, 5242880
    s_cmp_lt_u32 s24, 2
    s_cselect_b32 s20, s74, s76
    s_cselect_b32 s21, s75, s77
    s_mov_b32 s22, 1966080
    s_mul_i32 s30, s58, 491520
    s_mul_i32 s31, s57, 192
    s_add_u32 s30, s30, s31
    s_and_b32 s31, s24, 1
    s_mul_i32 s31, s31, 960
    v_add_u32 v10, s31, v2
    s_mul_i32 s31, s24, 15360
    v_mul_u32_u24 v8, 5462, v10
    v_lshrrev_b32 v8, 16, v8
    v_mul_u32_u24 v9, 12, v8
    v_sub_u32_e64 v9, v10, v9
    v_mul_u32_u24 v8, 3072, v8
    v_lshl_add_u32 v11, v9, 4, v8
    s_add_u32 m0, s31, 16384
    v_add_u32_e64 v10, 64, v10
    buffer_load_dwordx4 v11, s[20:23], s30 offen lds
    v_mul_u32_u24 v8, 5462, v10
    v_lshrrev_b32 v8, 16, v8
    v_mul_u32_u24 v9, 12, v8
    v_sub_u32_e64 v9, v10, v9
    v_mul_u32_u24 v8, 3072, v8
    v_lshl_add_u32 v11, v9, 4, v8
    s_add_u32 m0, s31, 17408
    v_add_u32_e64 v10, 64, v10
    buffer_load_dwordx4 v11, s[20:23], s30 offen lds
    v_mul_u32_u24 v8, 5462, v10
    v_lshrrev_b32 v8, 16, v8
    v_mul_u32_u24 v9, 12, v8
    v_sub_u32_e64 v9, v10, v9
    v_mul_u32_u24 v8, 3072, v8
    v_lshl_add_u32 v11, v9, 4, v8
    s_add_u32 m0, s31, 18432
    v_add_u32_e64 v10, 64, v10
    buffer_load_dwordx4 v11, s[20:23], s30 offen lds
    v_mul_u32_u24 v8, 5462, v10
    v_lshrrev_b32 v8, 16, v8
    v_mul_u32_u24 v9, 12, v8
    v_sub_u32_e64 v9, v10, v9
    v_mul_u32_u24 v8, 3072, v8
    v_lshl_add_u32 v11, v9, 4, v8
    s_add_u32 m0, s31, 19456
    v_add_u32_e64 v10, 64, v10
    buffer_load_dwordx4 v11, s[20:23], s30 offen lds
    v_mul_u32_u24 v8, 5462, v10
    v_lshrrev_b32 v8, 16, v8
    v_mul_u32_u24 v9, 12, v8
    v_sub_u32_e64 v9, v10, v9
    v_mul_u32_u24 v8, 3072, v8
    v_lshl_add_u32 v11, v9, 4, v8
    s_add_u32 m0, s31, 20480
    v_add_u32_e64 v10, 64, v10
    buffer_load_dwordx4 v11, s[20:23], s30 offen lds
    v_mul_u32_u24 v8, 5462, v10
    v_lshrrev_b32 v8, 16, v8
    v_mul_u32_u24 v9, 12, v8
    v_sub_u32_e64 v9, v10, v9
    v_mul_u32_u24 v8, 3072, v8
    v_lshl_add_u32 v11, v9, 4, v8
    s_add_u32 m0, s31, 21504
    v_add_u32_e64 v10, 64, v10
    buffer_load_dwordx4 v11, s[20:23], s30 offen lds
    v_mul_u32_u24 v8, 5462, v10
    v_lshrrev_b32 v8, 16, v8
    v_mul_u32_u24 v9, 12, v8
    v_sub_u32_e64 v9, v10, v9
    v_mul_u32_u24 v8, 3072, v8
    v_lshl_add_u32 v11, v9, 4, v8
    s_add_u32 m0, s31, 22528
    v_add_u32_e64 v10, 64, v10
    buffer_load_dwordx4 v11, s[20:23], s30 offen lds
    v_mul_u32_u24 v8, 5462, v10
    v_lshrrev_b32 v8, 16, v8
    v_mul_u32_u24 v9, 12, v8
    v_sub_u32_e64 v9, v10, v9
    v_mul_u32_u24 v8, 3072, v8
    v_lshl_add_u32 v11, v9, 4, v8
    s_add_u32 m0, s31, 23552
    v_add_u32_e64 v10, 64, v10
    buffer_load_dwordx4 v11, s[20:23], s30 offen lds
    v_mul_u32_u24 v8, 5462, v10
    v_lshrrev_b32 v8, 16, v8
    v_mul_u32_u24 v9, 12, v8
    v_sub_u32_e64 v9, v10, v9
    v_mul_u32_u24 v8, 3072, v8
    v_lshl_add_u32 v11, v9, 4, v8
    s_add_u32 m0, s31, 24576
    v_add_u32_e64 v10, 64, v10
    buffer_load_dwordx4 v11, s[20:23], s30 offen lds
    v_mul_u32_u24 v8, 5462, v10
    v_lshrrev_b32 v8, 16, v8
    v_mul_u32_u24 v9, 12, v8
    v_sub_u32_e64 v9, v10, v9
    v_mul_u32_u24 v8, 3072, v8
    v_lshl_add_u32 v11, v9, 4, v8
    s_add_u32 m0, s31, 25600
    v_add_u32_e64 v10, 64, v10
    buffer_load_dwordx4 v11, s[20:23], s30 offen lds
    v_mul_u32_u24 v8, 5462, v10
    v_lshrrev_b32 v8, 16, v8
    v_mul_u32_u24 v9, 12, v8
    v_sub_u32_e64 v9, v10, v9
    v_mul_u32_u24 v8, 3072, v8
    v_lshl_add_u32 v11, v9, 4, v8
    s_add_u32 m0, s31, 26624
    v_add_u32_e64 v10, 64, v10
    buffer_load_dwordx4 v11, s[20:23], s30 offen lds
    v_mul_u32_u24 v8, 5462, v10
    v_lshrrev_b32 v8, 16, v8
    v_mul_u32_u24 v9, 12, v8
    v_sub_u32_e64 v9, v10, v9
    v_mul_u32_u24 v8, 3072, v8
    v_lshl_add_u32 v11, v9, 4, v8
    s_add_u32 m0, s31, 27648
    v_add_u32_e64 v10, 64, v10
    buffer_load_dwordx4 v11, s[20:23], s30 offen lds
    v_mul_u32_u24 v8, 5462, v10
    v_lshrrev_b32 v8, 16, v8
    v_mul_u32_u24 v9, 12, v8
    v_sub_u32_e64 v9, v10, v9
    v_mul_u32_u24 v8, 3072, v8
    v_lshl_add_u32 v11, v9, 4, v8
    s_add_u32 m0, s31, 28672
    v_add_u32_e64 v10, 64, v10
    buffer_load_dwordx4 v11, s[20:23], s30 offen lds
    v_mul_u32_u24 v8, 5462, v10
    v_lshrrev_b32 v8, 16, v8
    v_mul_u32_u24 v9, 12, v8
    v_sub_u32_e64 v9, v10, v9
    v_mul_u32_u24 v8, 3072, v8
    v_lshl_add_u32 v11, v9, 4, v8
    s_add_u32 m0, s31, 29696
    v_add_u32_e64 v10, 64, v10
    buffer_load_dwordx4 v11, s[20:23], s30 offen lds
    v_mul_u32_u24 v8, 5462, v10
    v_lshrrev_b32 v8, 16, v8
    v_mul_u32_u24 v9, 12, v8
    v_sub_u32_e64 v9, v10, v9
    v_mul_u32_u24 v8, 3072, v8
    v_lshl_add_u32 v11, v9, 4, v8
    s_add_u32 m0, s31, 30720
    v_add_u32_e64 v10, 64, v10
    buffer_load_dwordx4 v11, s[20:23], s30 offen lds
    s_mov_b32 s12, s78
    s_mov_b32 s13, s79
    s_mov_b32 s14, 1966080
    s_mov_b32 s15, 0x20000
    s_mul_i32 s30, s59, 122880
    s_mul_i32 s31, s37, 320
    s_add_u32 s30, s30, s31
    s_lshl_b32 s31, s24, 9
    v_add_u32 v10, s31, v2
    s_lshl_b32 s31, s24, 13
    v_mul_u32_u24 v8, 3277, v10
    v_lshrrev_b32 v8, 16, v8
    v_mul_u32_u24 v9, 20, v8
    v_sub_u32_e64 v9, v10, v9
    v_mul_u32_u24 v8, 1280, v8
    v_lshl_add_u32 v11, v9, 4, v8
    s_add_u32 m0, s31, 77824
    v_add_u32_e64 v10, 64, v10
    buffer_load_dwordx4 v11, s[12:15], s30 offen lds
    v_mul_u32_u24 v8, 3277, v10
    v_lshrrev_b32 v8, 16, v8
    v_mul_u32_u24 v9, 20, v8
    v_sub_u32_e64 v9, v10, v9
    v_mul_u32_u24 v8, 1280, v8
    v_lshl_add_u32 v11, v9, 4, v8
    s_add_u32 m0, s31, 78848
    v_add_u32_e64 v10, 64, v10
    buffer_load_dwordx4 v11, s[12:15], s30 offen lds
    v_mul_u32_u24 v8, 3277, v10
    v_lshrrev_b32 v8, 16, v8
    v_mul_u32_u24 v9, 20, v8
    v_sub_u32_e64 v9, v10, v9
    v_mul_u32_u24 v8, 1280, v8
    v_lshl_add_u32 v11, v9, 4, v8
    s_add_u32 m0, s31, 79872
    v_add_u32_e64 v10, 64, v10
    buffer_load_dwordx4 v11, s[12:15], s30 offen lds
    v_mul_u32_u24 v8, 3277, v10
    v_lshrrev_b32 v8, 16, v8
    v_mul_u32_u24 v9, 20, v8
    v_sub_u32_e64 v9, v10, v9
    v_mul_u32_u24 v8, 1280, v8
    v_lshl_add_u32 v11, v9, 4, v8
    s_add_u32 m0, s31, 80896
    v_add_u32_e64 v10, 64, v10
    buffer_load_dwordx4 v11, s[12:15], s30 offen lds
    v_mul_u32_u24 v8, 3277, v10
    v_lshrrev_b32 v8, 16, v8
    v_mul_u32_u24 v9, 20, v8
    v_sub_u32_e64 v9, v10, v9
    v_mul_u32_u24 v8, 1280, v8
    v_lshl_add_u32 v11, v9, 4, v8
    s_add_u32 m0, s31, 81920
    v_add_u32_e64 v10, 64, v10
    buffer_load_dwordx4 v11, s[12:15], s30 offen lds
    v_mul_u32_u24 v8, 3277, v10
    v_lshrrev_b32 v8, 16, v8
    v_mul_u32_u24 v9, 20, v8
    v_sub_u32_e64 v9, v10, v9
    v_mul_u32_u24 v8, 1280, v8
    v_lshl_add_u32 v11, v9, 4, v8
    s_add_u32 m0, s31, 82944
    v_add_u32_e64 v10, 64, v10
    buffer_load_dwordx4 v11, s[12:15], s30 offen lds
    v_mul_u32_u24 v8, 3277, v10
    v_lshrrev_b32 v8, 16, v8
    v_mul_u32_u24 v9, 20, v8
    v_sub_u32_e64 v9, v10, v9
    v_mul_u32_u24 v8, 1280, v8
    v_lshl_add_u32 v11, v9, 4, v8
    s_add_u32 m0, s31, 83968
    v_add_u32_e64 v10, 64, v10
    buffer_load_dwordx4 v11, s[12:15], s30 offen lds
    v_mul_u32_u24 v8, 3277, v10
    v_lshrrev_b32 v8, 16, v8
    v_mul_u32_u24 v9, 20, v8
    v_sub_u32_e64 v9, v10, v9
    v_mul_u32_u24 v8, 1280, v8
    v_lshl_add_u32 v11, v9, 4, v8
    s_add_u32 m0, s31, 84992
    v_add_u32_e64 v10, 64, v10
    buffer_load_dwordx4 v11, s[12:15], s30 offen lds
    v_lshrrev_b32 v8, 4, v2
    v_lshlrev_b32 v8, 3, v8
    v_bfe_u32 v9, v2, 2, 2
    v_add_u32_e64 v8, v8, v9
    v_mul_u32_u24 v14, 320, v8
    v_and_b32_e64 v10, 3, v2
    v_lshl_add_u32 v14, v10, 3, v14
    v_lshrrev_b32_e64 v8, 5, v2
    v_lshl_add_u32 v8, v8, 3, v9
    v_mul_u32_u24 v8, 192, v8
    v_bfe_u32 v9, v2, 4, 1
    v_mul_u32_u24 v9, 30720, v9
    s_lshr_b32 s32, s58, 1
    s_lshl_b32 s33, s32, 1
    v_xor_b32 v10, s33, v10
    v_lshlrev_b32 v10, 3, v10
    v_add3_u32 v8, v8, v9, v10
    s_and_b32 s30, s24, 1
    s_mul_i32 s33, s30, 96
    s_lshr_b32 s34, s24, 1
    s_mul_i32 s35, s34, 15360
    s_add_u32 s33, s33, s35
    s_add_u32 s33, s33, 16384
    v_add_u32 v10, s33, v8
    s_lshl_b32 s31, s57, 2
    s_add_u32 s31, s31, s30
    s_lshl_b32 s33, s32, 1
    s_add_u32 s31, s31, s33
    s_mul_i32 s31, s31, 20
    s_and_b32 s33, s58, 1
    s_mul_i32 s33, s33, 10
    s_add_u32 s31, s31, s33
    s_mul_i32 s33, s34, 5
    s_add_u32 s31, s31, s33
    s_mul_i32 s31, s31, 3072
    s_add_u32 s31, s31, 1048576
    v_bfe_u32 v8, v2, 3, 1
    v_xor_b32 v8, s32, v8
    v_and_b32 v9, 7, v2
    v_lshl_add_u32 v8, v8, 3, v9
    v_bfe_u32 v9, v2, 4, 1
    v_mul_u32_u24 v9, 1536, v9
    v_add_u32 v8, v8, v9
    v_lshrrev_b32 v9, 5, v2
    v_lshlrev_b32_e64 v9, 28, v9
    v_lshl_add_u32 v212, v8, 2, v9
    s_mul_i32 s53, s57, 384
    s_mul_i32 s30, s30, 192
    s_add_u32 s53, s53, s30
    s_add_u32 s53, s53, 22478848
    v_mov_b32 v12, 0x3f803f80
    v_mov_b32 v208, 0
    v_mov_b32 v209, 0
    v_mov_b32 v210, 0
    v_mov_b32 v6, 128
    s_cmp_lg_u32 s24, 0
    s_cbranch_scc1 s0w_19
    s_mov_b32 s29, 262144
go_20:
    global_load_dword v7, v6, s[82:83] sc1
    s_waitcnt vmcnt(0)
    v_cmp_eq_u32 vcc, 0, v7
    s_nop 1
    s_cbranch_vccz s0w_19
    s_sleep 12
    s_sub_u32 s29, s29, 1
    s_cbranch_scc0 go_20
s0w_19:
    s_waitcnt vmcnt(8)
    s_barrier
    s_nop 0
    ds_read_b64_tr_b16 v[16:17], v10 offset:0
    ds_read_b64_tr_b16 v[18:19], v10 offset:768
    ds_read_b64_tr_b16 v[20:21], v10 offset:32
    ds_read_b64_tr_b16 v[22:23], v10 offset:800
    ds_read_b64_tr_b16 v[24:25], v10 offset:64
    ds_read_b64_tr_b16 v[26:27], v10 offset:832
    ds_read_b64_tr_b16 v[28:29], v10 offset:3072
    ds_read_b64_tr_b16 v[30:31], v10 offset:3840
    ds_read_b64_tr_b16 v[32:33], v10 offset:3104
    ds_read_b64_tr_b16 v[34:35], v10 offset:3872
    ds_read_b64_tr_b16 v[36:37], v10 offset:3136
    ds_read_b64_tr_b16 v[38:39], v10 offset:3904
    ds_read_b64_tr_b16 v[40:41], v10 offset:6144
    ds_read_b64_tr_b16 v[42:43], v10 offset:6912
    ds_read_b64_tr_b16 v[44:45], v10 offset:6176
    ds_read_b64_tr_b16 v[46:47], v10 offset:6944
    ds_read_b64_tr_b16 v[48:49], v10 offset:6208
    ds_read_b64_tr_b16 v[50:51], v10 offset:6976
    ds_read_b64_tr_b16 v[52:53], v10 offset:9216
    ds_read_b64_tr_b16 v[54:55], v10 offset:9984
    ds_read_b64_tr_b16 v[56:57], v10 offset:9248
    ds_read_b64_tr_b16 v[58:59], v10 offset:10016
    ds_read_b64_tr_b16 v[60:61], v10 offset:9280
    ds_read_b64_tr_b16 v[62:63], v10 offset:10048
    ds_read_b64_tr_b16 v[64:65], v10 offset:12288
    ds_read_b64_tr_b16 v[66:67], v10 offset:13056
    ds_read_b64_tr_b16 v[68:69], v10 offset:12320
    ds_read_b64_tr_b16 v[70:71], v10 offset:13088
    ds_read_b64_tr_b16 v[72:73], v10 offset:12352
    ds_read_b64_tr_b16 v[74:75], v10 offset:13120
    s_waitcnt lgkmcnt(15)
    s_nop 0
    buffer_store_dwordx4 v[16:19], v1, s[8:11], s31 offen offset:0 sc1
    v_dot2_f32_bf16 v208, v16, v12, v208
    v_dot2_f32_bf16 v208, v17, v12, v208
    v_dot2_f32_bf16 v208, v18, v12, v208
    v_dot2_f32_bf16 v208, v19, v12, v208
    buffer_store_dwordx4 v[20:23], v1, s[8:11], s31 offen offset:1024 sc1
    v_dot2_f32_bf16 v209, v20, v12, v209
    v_dot2_f32_bf16 v209, v21, v12, v209
    v_dot2_f32_bf16 v209, v22, v12, v209
    v_dot2_f32_bf16 v209, v23, v12, v209
    buffer_store_dwordx4 v[24:27], v1, s[8:11], s31 offen offset:2048 sc1
    v_dot2_f32_bf16 v210, v24, v12, v210
    v_dot2_f32_bf16 v210, v25, v12, v210
    v_dot2_f32_bf16 v210, v26, v12, v210
    v_dot2_f32_bf16 v210, v27, v12, v210
    buffer_store_dwordx4 v[28:31], v1, s[8:11], s31 offen offset:3072 sc1
    v_dot2_f32_bf16 v208, v28, v12, v208
    v_dot2_f32_bf16 v208, v29, v12, v208
    v_dot2_f32_bf16 v208, v30, v12, v208
    v_dot2_f32_bf16 v208, v31, v12, v208
    s_add_u32 s31, s31, 4096
    buffer_store_dwordx4 v[32:35], v1, s[8:11], s31 offen offset:0 sc1
    v_dot2_f32_bf16 v209, v32, v12, v209
    v_dot2_f32_bf16 v209, v33, v12, v209
    v_dot2_f32_bf16 v209, v34, v12, v209
    v_dot2_f32_bf16 v209, v35, v12, v209
    buffer_store_dwordx4 v[36:39], v1, s[8:11], s31 offen offset:1024 sc1
    v_dot2_f32_bf16 v210, v36, v12, v210
    v_dot2_f32_bf16 v210, v37, v12, v210
    v_dot2_f32_bf16 v210, v38, v12, v210
    v_dot2_f32_bf16 v210, v39, v12, v210
    buffer_store_dwordx4 v[40:43], v1, s[8:11], s31 offen offset:2048 sc1
    v_dot2_f32_bf16 v208, v40, v12, v208
    v_dot2_f32_bf16 v208, v41, v12, v208
    v_dot2_f32_bf16 v208, v42, v12, v208
    v_dot2_f32_bf16 v208, v43, v12, v208
    s_waitcnt lgkmcnt(14)
    s_nop 0
    buffer_store_dwordx4 v[44:47], v1, s[8:11], s31 offen offset:3072 sc1
    v_dot2_f32_bf16 v209, v44, v12, v209
    v_dot2_f32_bf16 v209, v45, v12, v209
    v_dot2_f32_bf16 v209, v46, v12, v209
    v_dot2_f32_bf16 v209, v47, v12, v209
    s_add_u32 s31, s31, 4096
    s_waitcnt lgkmcnt(12)
    s_nop 0
    buffer_store_dwordx4 v[48:51], v1, s[8:11], s31 offen offset:0 sc1
    v_dot2_f32_bf16 v210, v48, v12, v210
    v_dot2_f32_bf16 v210, v49, v12, v210
    v_dot2_f32_bf16 v210, v50, v12, v210
    v_dot2_f32_bf16 v210, v51, v12, v210
    s_waitcnt lgkmcnt(10)
    s_nop 0
    buffer_store_dwordx4 v[52:55], v1, s[8:11], s31 offen offset:1024 sc1
    v_dot2_f32_bf16 v208, v52, v12, v208
    v_dot2_f32_bf16 v208, v53, v12, v208
    v_dot2_f32_bf16 v208, v54, v12, v208
    v_dot2_f32_bf16 v208, v55, v12, v208
    s_waitcnt lgkmcnt(8)
    s_nop 0
    buffer_store_dwordx4 v[56:59], v1, s[8:11], s31 offen offset:2048 sc1
    v_dot2_f32_bf16 v209, v56, v12, v209
    v_dot2_f32_bf16 v209, v57, v12, v209
    v_dot2_f32_bf16 v209, v58, v12, v209
    v_dot2_f32_bf16 v209, v59, v12, v209
    s_waitcnt lgkmcnt(6)
    s_nop 0
    buffer_store_dwordx4 v[60:63], v1, s[8:11], s31 offen offset:3072 sc1
    v_dot2_f32_bf16 v210, v60, v12, v210
    v_dot2_f32_bf16 v210, v61, v12, v210
    v_dot2_f32_bf16 v210, v62, v12, v210
    v_dot2_f32_bf16 v210, v63, v12, v210
    s_add_u32 s31, s31, 4096
    s_waitcnt lgkmcnt(4)
    s_nop 0
    buffer_store_dwordx4 v[64:67], v1, s[8:11], s31 offen offset:0 sc1
    v_dot2_f32_bf16 v208, v64, v12, v208
    v_dot2_f32_bf16 v208, v65, v12, v208
    v_dot2_f32_bf16 v208, v66, v12, v208
    v_dot2_f32_bf16 v208, v67, v12, v208
    s_waitcnt lgkmcnt(2)
    s_nop 0
    buffer_store_dwordx4 v[68:71], v1, s[8:11], s31 offen offset:1024 sc1
    v_dot2_f32_bf16 v209, v68, v12, v209
    v_dot2_f32_bf16 v209, v69, v12, v209
    v_dot2_f32_bf16 v209, v70, v12, v209
    v_dot2_f32_bf16 v209, v71, v12, v209
    s_waitcnt lgkmcnt(0)
    s_nop 0
    buffer_store_dwordx4 v[72:75], v1, s[8:11], s31 offen offset:2048 sc1
    v_dot2_f32_bf16 v210, v72, v12, v210
    v_dot2_f32_bf16 v210, v73, v12, v210
    v_dot2_f32_bf16 v210, v74, v12, v210
    v_dot2_f32_bf16 v210, v75, v12, v210
    s_nop 2
    v_mov_b32 v216, v208
    v_mov_b32 v217, v209
    v_mov_b32 v218, v210
    v_permlane32_swap_b32 v208, v216
    v_permlane32_swap_b32 v209, v217
    v_permlane32_swap_b32 v210, v218
    v_add_f32 v208, v208, v216
    v_add_f32 v209, v209, v217
    v_add_f32 v210, v210, v218
    buffer_atomic_add_f32 v208, v212, s[8:11], s53 offen offset:0
    buffer_atomic_add_f32 v209, v212, s[8:11], s53 offen offset:64
    buffer_atomic_add_f32 v210, v212, s[8:11], s53 offen offset:128
    s_lshr_b32 s30, s40, 4
    s_lshl_b32 s30, s30, 7
    s_and_b32 s31, s40, 15
    s_add_u32 s30, s30, s31
    s_add_u32 s30, s30, 22676480
    s_mov_b32 s36, s30
    v_lshrrev_b32 v4, 5, v2
    v_lshlrev_b32_e64 v3, 11, v2
    v_lshl_add_u32 v3, v4, 28, v3
    v_mov_b32_e64 v4, 1
    s_waitcnt vmcnt(0)
    s_barrier
    s_cmp_lg_u32 s24, 0
    s_cbranch_scc1 sig_21
    buffer_store_byte v4, v3, s[8:11], s36 offen sc1
sig_21:
    s_barrier
    s_lshl_b32 s30, s24, 3
    s_add_u32 s30, s30, 0
    s_mul_i32 s31, s30, 26
    s_lshr_b32 s31, s31, 8
    s_mul_i32 s32, s31, 10
    s_sub_u32 s32, s30, s32
    s_mul_i32 s33, s31, 10240
    s_lshl_b32 s34, s32, 5
    s_add_u32 s33, s33, s34
    s_add_u32 s33, s33, 77824
    v_add_u32 v8, s33, v14
    ds_read_b64_tr_b16 v[80:81], v8
    ds_read_b64_tr_b16 v[82:83], v8 offset:1280
    s_cmp_ge_u32 s32, 5
    s_cselect_b32 s33, 235, 0
    s_add_u32 s33, s33, s32
    s_mul_i32 s34, s31, 5
    s_add_u32 s33, s33, s34
    s_mul_i32 s34, s59, 15
    s_add_u32 s33, s33, s34
    s_mul_i32 s34, s37, 480
    s_add_u32 s33, s33, s34
    s_lshl_b32 s33, s33, 10
    s_add_u32 s33, s33, 5242880
    s_cmp_ge_u32 s30, 30
    s_cselect_b32 s45, 1073741824, s33
    s_lshl_b32 s30, s24, 3
    s_add_u32 s30, s30, 1
    s_mul_i32 s31, s30, 26
    s_lshr_b32 s31, s31, 8
    s_mul_i32 s32, s31, 10
    s_sub_u32 s32, s30, s32
    s_mul_i32 s33, s31, 10240
    s_lshl_b32 s34, s32, 5
    s_add_u32 s33, s33, s34
    s_add_u32 s33, s33, 77824
    v_add_u32_e64 v8, s33, v14
    ds_read_b64_tr_b16 v[84:85], v8
    ds_read_b64_tr_b16 v[86:87], v8 offset:1280
    s_cmp_ge_u32 s32, 5
    s_cselect_b32 s33, 235, 0
    s_add_u32 s33, s33, s32
    s_mul_i32 s34, s31, 5
    s_add_u32 s33, s33, s34
    s_mul_i32 s34, s59, 15
    s_add_u32 s33, s33, s34
    s_mul_i32 s34, s37, 480
    s_add_u32 s33, s33, s34
    s_lshl_b32 s33, s33, 10
    s_add_u32 s33, s33, 5242880
    s_cmp_ge_u32 s30, 30
    s_cselect_b32 s46, 1073741824, s33
    s_lshl_b32 s30, s24, 3
    s_add_u32 s30, s30, 2
    s_mul_i32 s31, s30, 26
    s_lshr_b32 s31, s31, 8
    s_mul_i32 s32, s31, 10
    s_sub_u32 s32, s30, s32
    s_mul_i32 s33, s31, 10240
    s_lshl_b32 s34, s32, 5
    s_add_u32 s33, s33, s34
    s_add_u32 s33, s33, 77824
    v_add_u32_e64 v8, s33, v14
    ds_read_b64_tr_b16 v[88:89], v8
    ds_read_b64_tr_b16 v[90:91], v8 offset:1280
    s_cmp_ge_u32 s32, 5
    s_cselect_b32 s33, 235, 0
    s_add_u32 s33, s33, s32
    s_mul_i32 s34, s31, 5
    s_add_u32 s33, s33, s34
    s_mul_i32 s34, s59, 15
    s_add_u32 s33, s33, s34
    s_mul_i32 s34, s37, 480
    s_add_u32 s33, s33, s34
    s_lshl_b32 s33, s33, 10
    s_add_u32 s33, s33, 5242880
    s_cmp_ge_u32 s30, 30
    s_cselect_b32 s47, 1073741824, s33
    s_lshl_b32 s30, s24, 3
    s_add_u32 s30, s30, 3
    s_mul_i32 s31, s30, 26
    s_lshr_b32 s31, s31, 8
    s_mul_i32 s32, s31, 10
    s_sub_u32 s32, s30, s32
    s_mul_i32 s33, s31, 10240
    s_lshl_b32 s34, s32, 5
    s_add_u32 s33, s33, s34
    s_add_u32 s33, s33, 77824
    v_add_u32_e64 v8, s33, v14
    ds_read_b64_tr_b16 v[92:93], v8
    ds_read_b64_tr_b16 v[94:95], v8 offset:1280
    s_cmp_ge_u32 s32, 5
    s_cselect_b32 s33, 235, 0
    s_add_u32 s33, s33, s32
    s_mul_i32 s34, s31, 5
    s_add_u32 s33, s33, s34
    s_mul_i32 s34, s59, 15
    s_add_u32 s33, s33, s34
    s_mul_i32 s34, s37, 480
    s_add_u32 s33, s33, s34
    s_lshl_b32 s33, s33, 10
    s_add_u32 s33, s33, 5242880
    s_cmp_ge_u32 s30, 30
    s_cselect_b32 s48, 1073741824, s33
    s_lshl_b32 s30, s24, 3
    s_add_u32 s30, s30, 4
    s_mul_i32 s31, s30, 26
    s_lshr_b32 s31, s31, 8
    s_mul_i32 s32, s31, 10
    s_sub_u32 s32, s30, s32
    s_mul_i32 s33, s31, 10240
    s_lshl_b32 s34, s32, 5
    s_add_u32 s33, s33, s34
    s_add_u32 s33, s33, 77824
    v_add_u32_e64 v8, s33, v14
    ds_read_b64_tr_b16 v[96:97], v8
    ds_read_b64_tr_b16 v[98:99], v8 offset:1280
    s_cmp_ge_u32 s32, 5
    s_cselect_b32 s33, 235, 0
    s_add_u32 s33, s33, s32
    s_mul_i32 s34, s31, 5
    s_add_u32 s33, s33, s34
    s_mul_i32 s34, s59, 15
    s_add_u32 s33, s33, s34
    s_mul_i32 s34, s37, 480
    s_add_u32 s33, s33, s34
    s_lshl_b32 s33, s33, 10
    s_add_u32 s33, s33, 5242880
    s_cmp_ge_u32 s30, 30
    s_cselect_b32 s49, 1073741824, s33
    s_lshl_b32 s30, s24, 3
    s_add_u32 s30, s30, 5
    s_mul_i32 s31, s30, 26
    s_lshr_b32 s31, s31, 8
    s_mul_i32 s32, s31, 10
    s_sub_u32 s32, s30, s32
    s_mul_i32 s33, s31, 10240
    s_lshl_b32 s34, s32, 5
    s_add_u32 s33, s33, s34
    s_add_u32 s33, s33, 77824
    v_add_u32_e64 v8, s33, v14
    ds_read_b64_tr_b16 v[100:101], v8
    ds_read_b64_tr_b16 v[102:103], v8 offset:1280
    s_cmp_ge_u32 s32, 5
    s_cselect_b32 s33, 235, 0
    s_add_u32 s33, s33, s32
    s_mul_i32 s34, s31, 5
    s_add_u32 s33, s33, s34
    s_mul_i32 s34, s59, 15
    s_add_u32 s33, s33, s34
    s_mul_i32 s34, s37, 480
    s_add_u32 s33, s33, s34
    s_lshl_b32 s33, s33, 10
    s_add_u32 s33, s33, 5242880
    s_cmp_ge_u32 s30, 30
    s_cselect_b32 s50, 1073741824, s33
    s_lshl_b32 s30, s24, 3
    s_add_u32 s30, s30, 6
    s_mul_i32 s31, s30, 26
    s_lshr_b32 s31, s31, 8
    s_mul_i32 s32, s31, 10
    s_sub_u32 s32, s30, s32
    s_mul_i32 s33, s31, 10240
    s_lshl_b32 s34, s32, 5
    s_add_u32 s33, s33, s34
    s_add_u32 s33, s33, 77824
    v_add_u32_e64 v8, s33, v14
    ds_read_b64_tr_b16 v[104:105], v8
    ds_read_b64_tr_b16 v[106:107], v8 offset:1280
    s_cmp_ge_u32 s32, 5
    s_cselect_b32 s33, 235, 0
    s_add_u32 s33, s33, s32
    s_mul_i32 s34, s31, 5
    s_add_u32 s33, s33, s34
    s_mul_i32 s34, s59, 15
    s_add_u32 s33, s33, s34
    s_mul_i32 s34, s37, 480
    s_add_u32 s33, s33, s34
    s_lshl_b32 s33, s33, 10
    s_add_u32 s33, s33, 5242880
    s_cmp_ge_u32 s30, 30
    s_cselect_b32 s51, 1073741824, s33
    s_lshl_b32 s30, s24, 3
    s_add_u32 s30, s30, 7
    s_mul_i32 s31, s30, 26
    s_lshr_b32 s31, s31, 8
    s_mul_i32 s32, s31, 10
    s_sub_u32 s32, s30, s32
    s_mul_i32 s33, s31, 10240
    s_lshl_b32 s34, s32, 5
    s_add_u32 s33, s33, s34
    s_add_u32 s33, s33, 77824
    v_add_u32_e64 v8, s33, v14
    ds_read_b64_tr_b16 v[108:109], v8
    ds_read_b64_tr_b16 v[110:111], v8 offset:1280
    s_cmp_ge_u32 s32, 5
    s_cselect_b32 s33, 235, 0
    s_add_u32 s33, s33, s32
    s_mul_i32 s34, s31, 5
    s_add_u32 s33, s33, s34
    s_mul_i32 s34, s59, 15
    s_add_u32 s33, s33, s34
    s_mul_i32 s34, s37, 480
    s_add_u32 s33, s33, s34
    s_lshl_b32 s33, s33, 10
    s_add_u32 s33, s33, 5242880
    s_cmp_ge_u32 s30, 30
    s_cselect_b32 s52, 1073741824, s33
    s_waitcnt lgkmcnt(14)
    buffer_store_dwordx4 v[80:83], v1, s[8:11], s45 offen sc1
    s_waitcnt lgkmcnt(12)
    buffer_store_dwordx4 v[84:87], v1, s[8:11], s46 offen sc1
    s_waitcnt lgkmcnt(10)
    buffer_store_dwordx4 v[88:91], v1, s[8:11], s47 offen sc1
    s_waitcnt lgkmcnt(8)
    buffer_store_dwordx4 v[92:95], v1, s[8:11], s48 offen sc1
    s_waitcnt lgkmcnt(6)
    buffer_store_dwordx4 v[96:99], v1, s[8:11], s49 offen sc1
    s_waitcnt lgkmcnt(4)
    buffer_store_dwordx4 v[100:103], v1, s[8:11], s50 offen sc1
    s_waitcnt lgkmcnt(2)
    buffer_store_dwordx4 v[104:107], v1, s[8:11], s51 offen sc1
    s_waitcnt lgkmcnt(0)
    buffer_store_dwordx4 v[108:111], v1, s[8:11], s52 offen sc1
    buffer_load_dwordx4 a[0:3], v1, s[8:11], s54 offen sc1
    buffer_load_dwordx4 a[4:7], v1, s[8:11], s54 offen offset:1024 sc1
    buffer_load_dwordx4 a[8:11], v1, s[8:11], s54 offen offset:2048 sc1
    buffer_load_dwordx4 a[12:15], v1, s[8:11], s54 offen offset:3072 sc1
    s_add_u32 s54, s54, 4096
    buffer_load_dwordx4 a[16:19], v1, s[8:11], s54 offen sc1
    buffer_load_dwordx4 a[20:23], v1, s[8:11], s54 offen offset:1024 sc1
    buffer_load_dwordx4 a[24:27], v1, s[8:11], s54 offen offset:2048 sc1
    buffer_load_dwordx4 a[28:31], v1, s[8:11], s54 offen offset:3072 sc1
    s_add_u32 s54, s54, 4096
    buffer_load_dwordx4 a[32:35], v1, s[8:11], s54 offen sc1
    buffer_load_dwordx4 a[36:39], v1, s[8:11], s54 offen offset:1024 sc1
    buffer_load_dwordx4 a[40:43], v1, s[8:11], s54 offen offset:2048 sc1
    buffer_load_dwordx4 a[44:47], v1, s[8:11], s54 offen offset:3072 sc1
    s_add_u32 s54, s54, 4096
    buffer_load_dwordx4 a[48:51], v1, s[8:11], s54 offen sc1
    buffer_load_dwordx4 a[52:55], v1, s[8:11], s54 offen offset:1024 sc1
    buffer_load_dwordx4 a[56:59], v1, s[8:11], s54 offen offset:2048 sc1
    buffer_load_dwordx4 a[60:63], v1, s[8:11], s54 offen offset:3072 sc1
    s_add_u32 s54, s54, 4096
    buffer_load_dwordx4 a[64:67], v1, s[8:11], s54 offen sc1
    buffer_load_dwordx4 a[68:71], v1, s[8:11], s54 offen offset:1024 sc1
    buffer_load_dwordx4 a[72:75], v1, s[8:11], s54 offen offset:2048 sc1
    buffer_load_dwordx4 a[76:79], v1, s[8:11], s54 offen offset:3072 sc1
    s_add_u32 s54, s54, 4096
    buffer_load_dwordx4 a[80:83], v1, s[8:11], s54 offen sc1
    buffer_load_dwordx4 a[84:87], v1, s[8:11], s54 offen offset:1024 sc1
    buffer_load_dwordx4 a[88:91], v1, s[8:11], s54 offen offset:2048 sc1
    buffer_load_dwordx4 a[92:95], v1, s[8:11], s54 offen offset:3072 sc1
    s_add_u32 s54, s54, 4096
    buffer_load_dwordx4 a[96:99], v1, s[8:11], s54 offen sc1
    buffer_load_dwordx4 a[100:103], v1, s[8:11], s54 offen offset:1024 sc1
    buffer_load_dwordx4 a[104:107], v1, s[8:11], s54 offen offset:2048 sc1
    buffer_load_dwordx4 a[108:111], v1, s[8:11], s54 offen offset:3072 sc1
    s_add_u32 s54, s54, 4096
    buffer_load_dwordx4 a[112:115], v1, s[8:11], s54 offen sc1
    buffer_load_dwordx4 a[116:119], v1, s[8:11], s54 offen offset:1024 sc1
    buffer_load_dwordx4 a[120:123], v1, s[8:11], s54 offen offset:2048 sc1
    buffer_load_dwordx4 a[124:127], v1, s[8:11], s54 offen offset:3072 sc1
    s_add_u32 s54, s54, 4096
    buffer_load_dwordx4 a[128:131], v1, s[8:11], s54 offen sc1
    buffer_load_dwordx4 a[132:135], v1, s[8:11], s54 offen offset:1024 sc1
    buffer_load_dwordx4 a[136:139], v1, s[8:11], s54 offen offset:2048 sc1
    buffer_load_dwordx4 a[140:143], v1, s[8:11], s54 offen offset:3072 sc1
    s_add_u32 s54, s54, 4096
    buffer_load_dwordx4 a[144:147], v1, s[8:11], s54 offen sc1
    buffer_load_dwordx4 a[148:151], v1, s[8:11], s54 offen offset:1024 sc1
    buffer_load_dwordx4 a[152:155], v1, s[8:11], s54 offen offset:2048 sc1
    buffer_load_dwordx4 a[156:159], v1, s[8:11], s54 offen offset:3072 sc1
    s_add_u32 s54, s54, 4096
    buffer_load_dwordx4 a[160:163], v1, s[8:11], s54 offen sc1
    buffer_load_dwordx4 a[164:167], v1, s[8:11], s54 offen offset:1024 sc1
    buffer_load_dwordx4 a[168:171], v1, s[8:11], s54 offen offset:2048 sc1
    buffer_load_dwordx4 a[172:175], v1, s[8:11], s54 offen offset:3072 sc1
    s_add_u32 s54, s54, 4096
    buffer_load_dwordx4 a[176:179], v1, s[8:11], s54 offen sc1
    buffer_load_dwordx4 a[180:183], v1, s[8:11], s54 offen offset:1024 sc1
    buffer_load_dwordx4 a[184:187], v1, s[8:11], s54 offen offset:2048 sc1
    buffer_load_dwordx4 a[188:191], v1, s[8:11], s54 offen offset:3072 sc1
    s_add_u32 s54, s54, 4096
    buffer_load_dwordx4 a[192:195], v1, s[8:11], s54 offen sc1
    buffer_load_dwordx4 a[196:199], v1, s[8:11], s54 offen offset:1024 sc1
    s_add_u32 s36, s36, 512
    v_lshrrev_b32 v4, 5, v2
    v_lshlrev_b32 v3, 11, v2
    v_lshl_add_u32 v3, v4, 28, v3
    v_mov_b32_e64 v4, 1
    s_waitcnt vmcnt(50)
    s_barrier
    s_cmp_lg_u32 s24, 0
    s_cbranch_scc1 sig_22
    buffer_store_byte v4, v3, s[8:11], s36 offen sc1
sig_22:
    s_mov_b32 s12, s80
    s_mov_b32 s13, s81
    s_mov_b32 s14, 2621440
    s_mov_b32 s15, 0x20000
    s_and_b32 s34, s26, 7
    s_lshl_b32 s34, s34, 2
    s_add_u32 s34, s34, s24
    s_mul_i32 s34, s34, 384
    v_min_u32 v8, 2, v2
    v_lshl_add_u32 v8, v8, 7, s34
    v_min_u32 v8, L_C-L_join, v8
    v_add_u32 v8, L_join-L_pc, v8
    global_load_dword v5, v8, s[6:7]
    s_lshl_b32 s30, s25, 5
    s_add_u32 s30, s30, s26
    s_lshl_b32 s30, s30, 7
    s_add_u32 s30, s30, 22544384
    s_lshl_b32 s31, s25, 2
    s_lshr_b32 s28, s26, 3
    s_add_u32 s31, s31, s28
    s_lshl_b32 s31, s31, 11
    s_add_u32 s31, s31, 22676480
    s_cmp_lg_u32 s24, 1
    s_cbranch_scc1 sp_23_d
    s_nop 0
    s_mov_b32 s29, 262144
sp_23:
    s_load_dwordx4 s[64:67], s[84:85], s31 offset:0 glc
    s_load_dwordx4 s[68:71], s[84:85], s31 offset:128 glc
    s_load_dwordx4 s[72:75], s[84:85], s31 offset:256 glc
    s_load_dwordx4 s[76:79], s[84:85], s31 offset:384 glc
    s_waitcnt lgkmcnt(0)
    s_and_b32 s64, s64, s65
    s_and_b32 s64, s64, s66
    s_and_b32 s64, s64, s67
    s_and_b32 s64, s64, s68
    s_and_b32 s64, s64, s69
    s_and_b32 s64, s64, s70
    s_and_b32 s64, s64, s71
    s_and_b32 s64, s64, s72
    s_and_b32 s64, s64, s73
    s_and_b32 s64, s64, s74
    s_and_b32 s64, s64, s75
    s_and_b32 s64, s64, s76
    s_and_b32 s64, s64, s77
    s_and_b32 s64, s64, s78
    s_and_b32 s64, s64, s79
    s_cmp_eq_u32 s64, 0x01010101
    s_cbranch_scc1 sp_23_d
    s_sleep 2
    s_sub_u32 s29, s29, 1
    s_cbranch_scc0 sp_23
sp_23_d:
    s_cmp_lg_u32 s24, 0
    s_cbranch_scc1 sp_24_d
    s_mov_b32 s29, 262144
sp_24:
    s_load_dwordx4 s[64:67], s[84:85], s30 offset:0 glc
    s_waitcnt lgkmcnt(0)
    s_and_b32 s64, s64, s65
    s_and_b32 s64, s64, s66
    s_and_b32 s64, s64, s67
    s_cmp_eq_u32 s64, 0x01010101
    s_cbranch_scc1 sp_24_d
    s_sleep 2
    s_sub_u32 s29, s29, 1
    s_cbranch_scc0 sp_24
sp_24_d:
    s_barrier
L_join:
    s_lshl_b32 s30, s25, 3
    s_lshr_b32 s31, s26, 2
    s_add_u32 s40, s30, s31
    s_and_b32 s41, s26, 3
    s_mul_i32 s42, s40, 81920
    s_mul_i32 s32, s24, 20480
    s_add_u32 s42, s42, s32
    s_add_u32 s42, s42, 7340032
    buffer_load_dwordx4 v[220:223], v1, s[8:11], s42 offen sc1
    buffer_load_dwordx4 v[224:227], v1, s[8:11], s42 offen offset:1024 sc1
    buffer_load_dwordx4 v[228:231], v1, s[8:11], s42 offen offset:2048 sc1
    buffer_load_dwordx4 v[232:235], v1, s[8:11], s42 offen offset:3072 sc1
    s_add_u32 s42, s42, 4096
    buffer_load_dwordx4 v[236:239], v1, s[8:11], s42 offen sc1
    buffer_load_dwordx4 v[240:243], v1, s[8:11], s42 offen offset:1024 sc1
    buffer_load_dwordx4 a[200:203], v1, s[8:11], s42 offen offset:2048 sc1
    buffer_load_dwordx4 a[204:207], v1, s[8:11], s42 offen offset:3072 sc1
    s_add_u32 s42, s42, 4096
    buffer_load_dwordx4 a[208:211], v1, s[8:11], s42 offen sc1
    buffer_load_dwordx4 a[212:215], v1, s[8:11], s42 offen offset:1024 sc1
    buffer_load_dwordx4 a[216:219], v1, s[8:11], s42 offen offset:2048 sc1
    buffer_load_dwordx4 a[220:223], v1, s[8:11], s42 offen offset:3072 sc1
    s_add_u32 s42, s42, 4096
    buffer_load_dwordx4 a[224:227], v1, s[8:11], s42 offen sc1
    buffer_load_dwordx4 a[228:231], v1, s[8:11], s42 offen offset:1024 sc1
    buffer_load_dwordx4 a[232:235], v1, s[8:11], s42 offen offset:2048 sc1
    buffer_load_dwordx4 a[236:239], v1, s[8:11], s42 offen offset:3072 sc1
    s_add_u32 s42, s42, 4096
    buffer_load_dwordx4 a[240:243], v1, s[8:11], s42 offen sc1
    buffer_load_dwordx4 a[244:247], v1, s[8:11], s42 offen offset:1024 sc1
    buffer_load_dwordx4 a[248:251], v1, s[8:11], s42 offen offset:2048 sc1
    buffer_load_dwordx4 a[252:255], v1, s[8:11], s42 offen offset:3072 sc1
    s_and_b32 s34, s26, 7
    s_lshl_b32 s34, s34, 2
    s_add_u32 s34, s34, s24
    s_mul_i32 s34, s34, 384
    v_min_u32 v10, 2, v2
    v_lshl_add_u32 v10, v10, 7, s34
    v_min_u32 v10, L_D-L_C, v10
    v_add_u32 v10, L_C-L_pc, v10
    global_load_dword v5, v10, s[6:7]
    s_mul_i32 s43, s24, 15360
    s_add_u32 s43, s43, 22020096
    v_and_b32 v10, 31, v2
    v_cmp_gt_u32 vcc, 22, v10
    s_nop 1
    v_cndmask_b32 v10, 18, v10, vcc
    v_lshrrev_b32 v12, 5, v2
    v_lshlrev_b32_e64 v10, 4, v10
    s_movk_i32 s30, 384
    v_mad_u32_u24 v6, v12, s30, v10
    v_lshl_add_u32 v7, v12, 30, v10
    v_xor_b32 v8, 1073741824, v7
    s_lshl_b32 s44, s24, 1
    s_min_u32 s31, s24, 2
    s_add_u32 s44, s44, s31
    v_and_b32_e64 v10, 31, v2
    v_mul_u32_u24 v9, 1280, v10
    v_lshl_add_u32 v9, v12, 4, v9
    v_lshlrev_b32_e64 v15, 3, v10
    v_lshl_add_u32 v15, v12, 30, v15
    s_mul_i32 s45, s40, 40960
    s_mul_i32 s31, s41, 320
    s_add_u32 s45, s45, s31
    s_lshl_b32 s31, s44, 5
    s_add_u32 s45, s45, s31
    v_bfe_u32 v14, v2, 4, 1
    v_mul_u32_u24 v14, 20480, v14
    v_and_b32 v11, 15, v2
    v_lshl_add_u32 v14, v11, 4, v14
    v_lshl_add_u32 v14, v12, 8, v14
    s_mul_i32 s46, s40, 40960
    s_mul_i32 s31, s41, 5120
    s_add_u32 s46, s46, s31
    s_lshl_b32 s31, s44, 9
    s_add_u32 s46, s46, s31
    s_add_u32 s46, s46, 12582912
    s_lshl_b32 s47, s40, 12
    s_lshl_b32 s31, s41, 2
    s_add_u32 s31, s31, s24
    s_lshl_b32 s31, s31, 8
    s_add_u32 s47, s47, s31
    s_add_u32 s47, s47, 22216704
    s_lshr_b32 s48, s40, 2
    s_lshl_b32 s48, s48, 11
    s_and_b32 s31, s26, 15
    s_lshl_b32 s31, s31, 2
    s_add_u32 s48, s48, s31
    s_add_u32 s48, s48, 22577152
    s_lshl_b32 s34, s26, 2
    s_add_u32 s34, s34, s24
    s_mul_i32 s34, s34, 512
    s_add_u32 s34, s34, 22020096
    s_lshl_b32 s30, s24, 14
    s_cmp_eq_u32 s24, 0
    s_cselect_b32 s33, 2048, 0
    s_add_u32 s30, s30, s33
    s_add_u32 s30, s30, 94208
    v_add_u32_e64 v191, s30, v1
    s_add_u32 s31, s24, 1
    s_and_b32 s31, s31, 3
    s_lshl_b32 s30, s31, 14
    s_cmp_eq_u32 s31, 0
    s_cselect_b32 s33, 2048, 0
    s_add_u32 s30, s30, s33
    s_add_u32 s30, s30, 94208
    s_min_u32 s32, s31, 2
    s_lshl_b32 s31, s31, 1
    s_add_u32 s31, s31, s32
    s_sub_u32 s31, s44, s31
    s_cselect_b32 s32, 10, 0
    s_add_u32 s31, s31, s32
    s_lshl_b32 s31, s31, 11
    s_add_u32 s30, s30, s31
    v_add_u32 v188, s30, v1
    s_add_u32 s31, s24, 2
    s_and_b32 s31, s31, 3
    s_lshl_b32 s30, s31, 14
    s_cmp_eq_u32 s31, 0
    s_cselect_b32 s33, 2048, 0
    s_add_u32 s30, s30, s33
    s_add_u32 s30, s30, 94208
    s_min_u32 s32, s31, 2
    s_lshl_b32 s31, s31, 1
    s_add_u32 s31, s31, s32
    s_sub_u32 s31, s44, s31
    s_cselect_b32 s32, 10, 0
    s_add_u32 s31, s31, s32
    s_lshl_b32 s31, s31, 11
    s_add_u32 s30, s30, s31
    v_add_u32 v189, s30, v1
    s_add_u32 s31, s24, 3
    s_and_b32 s31, s31, 3
    s_lshl_b32 s30, s31, 14
    s_cmp_eq_u32 s31, 0
    s_cselect_b32 s33, 2048, 0
    s_add_u32 s30, s30, s33
    s_add_u32 s30, s30, 94208
    s_min_u32 s32, s31, 2
    s_lshl_b32 s31, s31, 1
    s_add_u32 s31, s31, s32
    s_sub_u32 s31, s44, s31
    s_cselect_b32 s32, 10, 0
    s_add_u32 s31, s31, s32
    s_lshl_b32 s31, s31, 11
    s_add_u32 s30, s30, s31
    v_add_u32 v190, s30, v1
    s_lshl_b32 s31, s25, 2
    s_lshr_b32 s28, s26, 3
    s_add_u32 s31, s31, s28
    s_lshl_b32 s31, s31, 11
    s_add_u32 s31, s31, 22675456
    s_lshl_b32 s28, s24, 8
    s_add_u32 s31, s31, s28
    s_mov_b32 s29, 262144
sp_26:
    s_load_dwordx4 s[64:67], s[84:85], s31 offset:0 glc
    s_load_dwordx4 s[68:71], s[84:85], s31 offset:128 glc
    s_waitcnt lgkmcnt(0)
    s_and_b32 s64, s64, s65
    s_and_b32 s64, s64, s66
    s_and_b32 s64, s64, s67
    s_and_b32 s64, s64, s68
    s_and_b32 s64, s64, s69
    s_and_b32 s64, s64, s70
    s_and_b32 s64, s64, s71
    s_cmp_eq_u32 s64, 0x01010101
    s_cbranch_scc1 sp_26_d
    s_sleep 2
    s_sub_u32 s29, s29, 1
    s_cbranch_scc0 sp_26
sp_26_d:
    buffer_load_dwordx4 v[128:131], v6, s[8:11], s43 offen offset:0 sc1
    buffer_load_dwordx4 v[132:135], v6, s[8:11], s43 offen offset:768 sc1
    buffer_load_dwordx4 v[136:139], v7, s[8:11], s43 offen offset:1536 sc1
    s_add_u32 s43, s43, 1920
    buffer_load_dwordx4 v[140:143], v6, s[8:11], s43 offen offset:0 sc1
    buffer_load_dwordx4 v[144:147], v6, s[8:11], s43 offen offset:768 sc1
    buffer_load_dwordx4 v[148:151], v8, s[8:11], s43 offen offset:1536 sc1
    s_add_u32 s43, s43, 1920
    buffer_load_dwordx4 v[152:155], v6, s[8:11], s43 offen offset:0 sc1
    buffer_load_dwordx4 v[156:159], v6, s[8:11], s43 offen offset:768 sc1
    buffer_load_dwordx4 v[160:163], v7, s[8:11], s43 offen offset:1536 sc1
    s_add_u32 s43, s43, 1920
    buffer_load_dwordx4 v[164:167], v6, s[8:11], s43 offen offset:0 sc1
    buffer_load_dwordx4 v[168:171], v6, s[8:11], s43 offen offset:768 sc1
    buffer_load_dwordx4 v[172:175], v8, s[8:11], s43 offen offset:1536 sc1
    s_add_u32 s43, s43, 1920
    buffer_load_dwordx4 v[176:179], v6, s[8:11], s43 offen offset:0 sc1
    buffer_load_dwordx4 v[180:183], v6, s[8:11], s43 offen offset:768 sc1
    buffer_load_dwordx4 v[184:187], v7, s[8:11], s43 offen offset:1536 sc1
    s_waitcnt vmcnt(14)
    v_mfma_f32_32x32x16_bf16 v[96:111], v[128:131], v[220:223], 0
    s_waitcnt vmcnt(13)
    v_mfma_f32_32x32x16_bf16 v[96:111], v[132:135], v[224:227], v[96:111]
    s_waitcnt vmcnt(12)
    v_mfma_f32_32x32x16_bf16 v[96:111], v[136:139], v[236:239], v[96:111]
    s_add_u32 s43, s43, 1920
    buffer_load_dwordx4 v[128:131], v6, s[8:11], s43 offen offset:0 sc1
    buffer_load_dwordx4 v[132:135], v6, s[8:11], s43 offen offset:768 sc1
    buffer_load_dwordx4 v[136:139], v8, s[8:11], s43 offen offset:1536 sc1
    s_waitcnt vmcnt(14)
    v_mfma_f32_32x32x16_bf16 v[112:127], v[140:143], v[228:231], 0
    s_nop 5
    v_add_f32 v106, 0x358637bd, v106
    v_rcp_f32 v106, v106
    s_nop 0
    v_mul_f32 v96, v96, v106
    v_mul_f32 v97, v97, v106
    v_mul_f32_e64 v98, v98, v106
    s_waitcnt vmcnt(13)
    v_mfma_f32_32x32x16_bf16 v[112:127], v[144:147], v[232:235], v[112:127]
    v_mul_f32 v99, v99, v106
    v_mul_f32 v100, v100, v106
    v_mul_f32 v101, v101, v106
    v_mul_f32 v102, v102, v106
    v_mul_f32 v103, v103, v106
    v_mul_f32_e64 v104, v104, v106
    s_waitcnt vmcnt(12)
    v_mfma_f32_32x32x16_bf16 v[112:127], v[148:151], v[236:239], v[112:127]
    v_mul_f32_e64 v105, v105, v106
    v_cvt_pk_bf16_f32 v200, v96, v97
    v_cvt_pk_bf16_f32 v201, v98, v99
    v_cvt_pk_bf16_f32 v202, v100, v101
    v_cvt_pk_bf16_f32 v203, v102, v103
    v_cvt_pk_bf16_f32 v204, v104, v105
    s_nop 0
    v_mfma_f32_32x32x16_bf16 v[16:31], a[0:3], v[200:203], 0
    s_add_u32 s43, s43, 1920
    buffer_load_dwordx4 v[140:143], v6, s[8:11], s43 offen offset:0 sc1
    v_mfma_f32_32x32x16_bf16 v[32:47], a[4:7], v[200:203], 0
    buffer_load_dwordx4 v[144:147], v6, s[8:11], s43 offen offset:768 sc1
    buffer_load_dwordx4 v[148:151], v7, s[8:11], s43 offen offset:1536 sc1
    v_mfma_f32_32x32x16_bf16 v[48:63], a[8:11], v[200:203], 0
    v_mfma_f32_32x32x16_bf16 v[64:79], a[12:15], v[200:203], 0
    v_mfma_f32_32x32x16_bf16 v[80:95], a[16:19], v[200:203], 0
    s_waitcnt vmcnt(14)
    v_mfma_f32_32x32x16_bf16 v[96:111], v[152:155], v[240:243], 0
    v_add_f32 v122, 0x358637bd, v122
    v_rcp_f32 v122, v122
    s_nop 0
    v_mul_f32 v112, v112, v122
    v_mul_f32 v113, v113, v122
    v_mul_f32 v114, v114, v122
    s_waitcnt vmcnt(13)
    v_mfma_f32_32x32x16_bf16 v[96:111], v[156:159], a[200:203], v[96:111]
    v_mul_f32 v115, v115, v122
    v_mul_f32 v116, v116, v122
    v_mul_f32 v117, v117, v122
    v_mul_f32 v118, v118, v122
    v_mul_f32 v119, v119, v122
    v_mul_f32_e64 v120, v120, v122
    s_waitcnt vmcnt(12)
    v_mfma_f32_32x32x16_bf16 v[96:111], v[160:163], a[212:215], v[96:111]
    v_mul_f32_e64 v121, v121, v122
    v_cvt_pk_bf16_f32 v205, v112, v113
    v_cvt_pk_bf16_f32 v206, v114, v115
    v_cvt_pk_bf16_f32 v207, v116, v117
    v_cvt_pk_bf16_f32 v208, v118, v119
    v_cvt_pk_bf16_f32 v209, v120, v121
    v_mfma_f32_32x32x16_bf16 v[16:31], a[20:23], v[204:207], v[16:31]
    s_add_u32 s43, s43, 1920
    buffer_load_dwordx4 v[152:155], v6, s[8:11], s43 offen offset:0 sc1
    v_mfma_f32_32x32x16_bf16 v[32:47], a[24:27], v[204:207], v[32:47]
    buffer_load_dwordx4 v[156:159], v6, s[8:11], s43 offen offset:768 sc1
    buffer_load_dwordx4 v[160:163], v8, s[8:11], s43 offen offset:1536 sc1
    v_mfma_f32_32x32x16_bf16 v[48:63], a[28:31], v[204:207], v[48:63]
    v_mfma_f32_32x32x16_bf16 v[64:79], a[32:35], v[204:207], v[64:79]
    v_mfma_f32_32x32x16_bf16 v[80:95], a[36:39], v[204:207], v[80:95]
    s_waitcnt vmcnt(14)
    v_mfma_f32_32x32x16_bf16 v[112:127], v[164:167], a[204:207], 0
    v_add_f32 v106, 0x358637bd, v106
    v_rcp_f32 v106, v106
    s_nop 0
    v_mul_f32 v96, v96, v106
    v_mul_f32 v97, v97, v106
    v_mul_f32_e64 v98, v98, v106
    s_waitcnt vmcnt(13)
    v_mfma_f32_32x32x16_bf16 v[112:127], v[168:171], a[208:211], v[112:127]
    v_mul_f32 v99, v99, v106
    v_mul_f32 v100, v100, v106
    v_mul_f32 v101, v101, v106
    v_mul_f32 v102, v102, v106
    v_mul_f32 v103, v103, v106
    v_mul_f32_e64 v104, v104, v106
    s_waitcnt vmcnt(12)
    v_mfma_f32_32x32x16_bf16 v[112:127], v[172:175], a[212:215], v[112:127]
    v_mul_f32_e64 v105, v105, v106
    v_cvt_pk_bf16_f32 v210, v96, v97
    v_cvt_pk_bf16_f32 v211, v98, v99
    v_cvt_pk_bf16_f32 v212, v100, v101
    v_cvt_pk_bf16_f32 v213, v102, v103
    v_cvt_pk_bf16_f32 v214, v104, v105
    v_mfma_f32_32x32x16_bf16 v[16:31], a[40:43], v[208:211], v[16:31]
    buffer_load_dwordx4 v[164:167], v9, s[16:19], s45 offen offset:0
    buffer_load_dwordx4 v[168:171], v9, s[16:19], s45 offen offset:32
    v_mfma_f32_32x32x16_bf16 v[32:47], a[44:47], v[208:211], v[32:47]
    buffer_load_dwordx4 v[172:175], v9, s[16:19], s45 offen offset:64
    buffer_load_dwordx4 a[0:3], v1, s[8:11], s55 offen sc1
    v_mfma_f32_32x32x16_bf16 v[48:63], a[48:51], v[208:211], v[48:63]
    buffer_load_dwordx4 a[4:7], v1, s[8:11], s55 offen offset:1024 sc1
    buffer_load_dwordx4 a[8:11], v1, s[8:11], s55 offen offset:2048 sc1
    v_mfma_f32_32x32x16_bf16 v[64:79], a[52:55], v[208:211], v[64:79]
    buffer_load_dwordx4 a[12:15], v1, s[8:11], s55 offen offset:3072 sc1
    v_mfma_f32_32x32x16_bf16 v[80:95], a[56:59], v[208:211], v[80:95]
    s_waitcnt vmcnt(18)
    v_mfma_f32_32x32x16_bf16 v[96:111], v[176:179], a[216:219], 0
    v_add_f32 v122, 0x358637bd, v122
    v_rcp_f32 v122, v122
    s_nop 0
    v_mul_f32 v112, v112, v122
    v_mul_f32 v113, v113, v122
    v_mul_f32_e64 v114, v114, v122
    s_waitcnt vmcnt(17)
    v_mfma_f32_32x32x16_bf16 v[96:111], v[180:183], a[220:223], v[96:111]
    v_mul_f32 v115, v115, v122
    v_mul_f32 v116, v116, v122
    v_mul_f32 v117, v117, v122
    v_mul_f32 v118, v118, v122
    v_mul_f32 v119, v119, v122
    v_mul_f32_e64 v120, v120, v122
    s_waitcnt vmcnt(16)
    v_mfma_f32_32x32x16_bf16 v[96:111], v[184:187], a[232:235], v[96:111]
    v_mul_f32_e64 v121, v121, v122
    v_cvt_pk_bf16_f32 v215, v112, v113
    v_cvt_pk_bf16_f32 v216, v114, v115
    v_cvt_pk_bf16_f32 v217, v116, v117
    v_cvt_pk_bf16_f32 v218, v118, v119
    v_cvt_pk_bf16_f32 v219, v120, v121
    v_mfma_f32_32x32x16_bf16 v[16:31], a[60:63], v[212:215], v[16:31]
    s_add_u32 s55, s55, 4096
    buffer_load_dwordx4 a[16:19], v1, s[8:11], s55 offen sc1
    v_mfma_f32_32x32x16_bf16 v[32:47], a[64:67], v[212:215], v[32:47]
    buffer_load_dwordx4 a[20:23], v1, s[8:11], s55 offen offset:1024 sc1
    buffer_load_dwordx4 a[24:27], v1, s[8:11], s55 offen offset:2048 sc1
    v_mfma_f32_32x32x16_bf16 v[48:63], a[68:71], v[212:215], v[48:63]
    buffer_load_dwordx4 a[28:31], v1, s[8:11], s55 offen offset:3072 sc1
    v_mfma_f32_32x32x16_bf16 v[64:79], a[72:75], v[212:215], v[64:79]
    v_mfma_f32_32x32x16_bf16 v[80:95], a[76:79], v[212:215], v[80:95]
    v_mfma_f32_32x32x16_bf16 v[16:31], a[80:83], v[216:219], v[16:31]
    v_mfma_f32_32x32x16_bf16 v[32:47], a[84:87], v[216:219], v[32:47]
    v_mfma_f32_32x32x16_bf16 v[48:63], a[88:91], v[216:219], v[48:63]
    v_mfma_f32_32x32x16_bf16 v[64:79], a[92:95], v[216:219], v[64:79]
    v_mfma_f32_32x32x16_bf16 v[80:95], a[96:99], v[216:219], v[80:95]
    s_waitcnt vmcnt(19)
    v_mfma_f32_32x32x16_bf16 v[112:127], v[128:131], a[224:227], 0
    v_add_f32 v106, 0x358637bd, v106
    v_rcp_f32 v106, v106
    s_nop 0
    v_mul_f32 v96, v96, v106
    v_mul_f32 v97, v97, v106
    v_mul_f32_e64 v98, v98, v106
    s_waitcnt vmcnt(18)
    v_mfma_f32_32x32x16_bf16 v[112:127], v[132:135], a[228:231], v[112:127]
    v_mul_f32 v99, v99, v106
    v_mul_f32 v100, v100, v106
    v_mul_f32 v101, v101, v106
    v_mul_f32 v102, v102, v106
    v_mul_f32 v103, v103, v106
    v_mul_f32_e64 v104, v104, v106
    s_waitcnt vmcnt(17)
    v_mfma_f32_32x32x16_bf16 v[112:127], v[136:139], a[232:235], v[112:127]
    v_mul_f32_e64 v105, v105, v106
    v_cvt_pk_bf16_f32 v220, v96, v97
    v_cvt_pk_bf16_f32 v221, v98, v99
    v_cvt_pk_bf16_f32 v222, v100, v101
    v_cvt_pk_bf16_f32 v223, v102, v103
    v_cvt_pk_bf16_f32 v224, v104, v105
    s_nop 0
    v_mfma_f32_32x32x16_bf16 v[16:31], a[100:103], v[220:223], v[16:31]
    s_add_u32 s55, s55, 4096
    buffer_load_dwordx4 a[32:35], v1, s[8:11], s55 offen sc1
    v_mfma_f32_32x32x16_bf16 v[32:47], a[104:107], v[220:223], v[32:47]
    buffer_load_dwordx4 a[36:39], v1, s[8:11], s55 offen offset:1024 sc1
    buffer_load_dwordx4 a[40:43], v1, s[8:11], s55 offen offset:2048 sc1
    v_mfma_f32_32x32x16_bf16 v[48:63], a[108:111], v[220:223], v[48:63]
    buffer_load_dwordx4 a[44:47], v1, s[8:11], s55 offen offset:3072 sc1
    v_mfma_f32_32x32x16_bf16 v[64:79], a[112:115], v[220:223], v[64:79]
    v_mfma_f32_32x32x16_bf16 v[80:95], a[116:119], v[220:223], v[80:95]
    s_waitcnt vmcnt(20)
    v_mfma_f32_32x32x16_bf16 v[96:111], v[140:143], a[236:239], 0
    v_add_f32 v122, 0x358637bd, v122
    v_rcp_f32 v122, v122
    s_nop 0
    v_mul_f32 v112, v112, v122
    v_mul_f32 v113, v113, v122
    v_mul_f32 v114, v114, v122
    s_waitcnt vmcnt(19)
    v_mfma_f32_32x32x16_bf16 v[96:111], v[144:147], a[240:243], v[96:111]
    v_mul_f32 v115, v115, v122
    v_mul_f32 v116, v116, v122
    v_mul_f32 v117, v117, v122
    v_mul_f32 v118, v118, v122
    v_mul_f32 v119, v119, v122
    v_mul_f32_e64 v120, v120, v122
    s_waitcnt vmcnt(18)
    v_mfma_f32_32x32x16_bf16 v[96:111], v[148:151], a[252:255], v[96:111]
    v_mul_f32_e64 v121, v121, v122
    v_cvt_pk_bf16_f32 v225, v112, v113
    v_cvt_pk_bf16_f32 v226, v114, v115
    v_cvt_pk_bf16_f32 v227, v116, v117
    v_cvt_pk_bf16_f32 v228, v118, v119
    v_cvt_pk_bf16_f32 v229, v120, v121
    v_mfma_f32_32x32x16_bf16 v[16:31], a[120:123], v[224:227], v[16:31]
    s_add_u32 s55, s55, 4096
    buffer_load_dwordx4 a[48:51], v1, s[8:11], s55 offen sc1
    v_mfma_f32_32x32x16_bf16 v[32:47], a[124:127], v[224:227], v[32:47]
    buffer_load_dwordx4 a[52:55], v1, s[8:11], s55 offen offset:1024 sc1
    buffer_load_dwordx4 a[56:59], v1, s[8:11], s55 offen offset:2048 sc1
    v_mfma_f32_32x32x16_bf16 v[48:63], a[128:131], v[224:227], v[48:63]
    buffer_load_dwordx4 a[60:63], v1, s[8:11], s55 offen offset:3072 sc1
    v_mfma_f32_32x32x16_bf16 v[64:79], a[132:135], v[224:227], v[64:79]
    v_mfma_f32_32x32x16_bf16 v[80:95], a[136:139], v[224:227], v[80:95]
    s_waitcnt vmcnt(21)
    v_mfma_f32_32x32x16_bf16 v[112:127], v[152:155], a[244:247], 0
    v_add_f32 v106, 0x358637bd, v106
    v_rcp_f32 v106, v106
    s_nop 0
    v_mul_f32 v96, v96, v106
    v_mul_f32 v97, v97, v106
    v_mul_f32_e64 v98, v98, v106
    s_waitcnt vmcnt(20)
    v_mfma_f32_32x32x16_bf16 v[112:127], v[156:159], a[248:251], v[112:127]
    v_mul_f32 v99, v99, v106
    v_mul_f32 v100, v100, v106
    v_mul_f32 v101, v101, v106
    v_mul_f32 v102, v102, v106
    v_mul_f32 v103, v103, v106
    v_mul_f32_e64 v104, v104, v106
    s_waitcnt vmcnt(19)
    v_mfma_f32_32x32x16_bf16 v[112:127], v[160:163], a[252:255], v[112:127]
    v_mul_f32_e64 v105, v105, v106
    v_cvt_pk_bf16_f32 v230, v96, v97
    v_cvt_pk_bf16_f32 v231, v98, v99
    v_cvt_pk_bf16_f32 v232, v100, v101
    v_cvt_pk_bf16_f32 v233, v102, v103
    v_cvt_pk_bf16_f32 v234, v104, v105
    s_add_u32 s55, s55, 4096
    buffer_load_dwordx4 a[64:67], v1, s[8:11], s55 offen sc1
    buffer_load_dwordx4 a[68:71], v1, s[8:11], s55 offen offset:1024 sc1
    buffer_load_dwordx4 a[72:75], v1, s[8:11], s55 offen offset:2048 sc1
    buffer_load_dwordx4 a[76:79], v1, s[8:11], s55 offen offset:3072 sc1
    v_mfma_f32_32x32x16_bf16 v[16:31], a[140:143], v[228:231], v[16:31]
    v_add_f32 v122, 0x358637bd, v122
    v_rcp_f32 v122, v122
    s_nop 0
    v_mul_f32 v112, v112, v122
    v_mul_f32 v113, v113, v122
    v_mul_f32_e64 v114, v114, v122
    v_mfma_f32_32x32x16_bf16 v[32:47], a[144:147], v[228:231], v[32:47]
    v_mul_f32 v115, v115, v122
    v_mul_f32 v116, v116, v122
    v_mul_f32 v117, v117, v122
    v_mul_f32 v118, v118, v122
    v_mul_f32 v119, v119, v122
    v_mul_f32 v120, v120, v122
    v_mfma_f32_32x32x16_bf16 v[48:63], a[148:151], v[228:231], v[48:63]
    v_mul_f32_e64 v121, v121, v122
    v_cvt_pk_bf16_f32 v235, v112, v113
    v_cvt_pk_bf16_f32 v236, v114, v115
    v_cvt_pk_bf16_f32 v237, v116, v117
    v_cvt_pk_bf16_f32 v238, v118, v119
    v_cvt_pk_bf16_f32 v239, v120, v121
    v_mfma_f32_32x32x16_bf16 v[64:79], a[152:155], v[228:231], v[64:79]
    v_mfma_f32_32x32x16_bf16 v[80:95], a[156:159], v[228:231], v[80:95]
    v_mfma_f32_32x32x16_bf16 v[80:95], a[176:179], v[232:235], v[80:95]
    s_add_u32 s55, s55, 4096
    buffer_load_dwordx4 a[80:83], v1, s[8:11], s55 offen sc1
    v_mfma_f32_32x32x16_bf16 v[80:95], a[196:199], v[236:239], v[80:95]
    buffer_load_dwordx4 a[84:87], v1, s[8:11], s55 offen offset:1024 sc1
    buffer_load_dwordx4 a[88:91], v1, s[8:11], s55 offen offset:2048 sc1
    v_mfma_f32_32x32x16_bf16 v[64:79], a[172:175], v[232:235], v[64:79]
    buffer_load_dwordx4 a[92:95], v1, s[8:11], s55 offen offset:3072 sc1
    v_mfma_f32_32x32x16_bf16 v[64:79], a[192:195], v[236:239], v[64:79]
    v_mfma_f32_32x32x16_bf16 v[48:63], a[168:171], v[232:235], v[48:63]
    s_nop 5
    ds_write_b128 v191, v[88:91] offset:18432
    v_mfma_f32_32x32x16_bf16 v[48:63], a[188:191], v[236:239], v[48:63]
    ds_write_b128 v191, v[92:95] offset:19456
    v_mfma_f32_32x32x16_bf16 v[32:47], a[164:167], v[232:235], v[32:47]
    ds_write_b128 v191, v[80:83] offset:16384
    v_mfma_f32_32x32x16_bf16 v[32:47], a[184:187], v[236:239], v[32:47]
    ds_write_b128 v191, v[84:87] offset:17408
    v_mfma_f32_32x32x16_bf16 v[16:31], a[160:163], v[232:235], v[16:31]
    ds_write_b128 v191, v[72:75] offset:14336
    v_mfma_f32_32x32x16_bf16 v[16:31], a[180:183], v[236:239], v[16:31]
    ds_write_b128 v191, v[76:79] offset:15360
    ds_write_b128 v191, v[64:67] offset:12288
    ds_write_b128 v191, v[68:71] offset:13312
    s_nop 0
    s_add_u32 s55, s55, 4096
    buffer_load_dwordx4 a[96:99], v1, s[8:11], s55 offen sc1
    ds_write_b128 v191, v[56:59] offset:10240
    ds_write_b128 v191, v[60:63] offset:11264
    buffer_load_dwordx4 a[100:103], v1, s[8:11], s55 offen offset:1024 sc1
    ds_write_b128 v191, v[48:51] offset:8192
    ds_write_b128 v191, v[52:55] offset:9216
    buffer_load_dwordx4 a[104:107], v1, s[8:11], s55 offen offset:2048 sc1
    ds_write_b128 v191, v[40:43] offset:6144
    ds_write_b128 v191, v[44:47] offset:7168
    buffer_load_dwordx4 a[108:111], v1, s[8:11], s55 offen offset:3072 sc1
    s_cmp_lt_u32 s24, 2
    s_cbranch_scc1 w2_29
    ds_write_b128 v191, v[32:35] offset:4096
    ds_write_b128 v191, v[36:39] offset:5120
w2_29:
    s_add_u32 s55, s55, 4096
    buffer_load_dwordx4 a[112:115], v1, s[8:11], s55 offen sc1
    buffer_load_dwordx4 a[116:119], v1, s[8:11], s55 offen offset:1024 sc1
    buffer_load_dwordx4 a[120:123], v1, s[8:11], s55 offen offset:2048 sc1
    buffer_load_dwordx4 a[124:127], v1, s[8:11], s55 offen offset:3072 sc1
    s_add_u32 s55, s55, 4096
    buffer_load_dwordx4 a[128:131], v1, s[8:11], s55 offen sc1
    buffer_load_dwordx4 a[132:135], v1, s[8:11], s55 offen offset:1024 sc1
    s_waitcnt vmcnt(36)
    v_lshlrev_b32 v128, 16, v164
    v_and_b32 v129, 0xffff0000, v164
    v_lshlrev_b32_e64 v130, 16, v165
    v_and_b32 v131, 0xffff0000, v165
    v_lshlrev_b32_e64 v132, 16, v166
    v_and_b32 v133, 0xffff0000, v166
    v_lshlrev_b32_e64 v134, 16, v167
    v_and_b32 v135, 0xffff0000, v167
    s_waitcnt vmcnt(35)
    v_lshlrev_b32 v136, 16, v168
    v_and_b32 v137, 0xffff0000, v168
    v_lshlrev_b32_e64 v138, 16, v169
    v_and_b32 v139, 0xffff0000, v169
    v_lshlrev_b32_e64 v140, 16, v170
    v_and_b32 v141, 0xffff0000, v170
    v_lshlrev_b32_e64 v142, 16, v171
    v_and_b32 v143, 0xffff0000, v171
    s_waitcnt vmcnt(34)
    v_lshlrev_b32 v144, 16, v172
    v_and_b32 v145, 0xffff0000, v172
    v_lshlrev_b32_e64 v146, 16, v173
    v_and_b32 v147, 0xffff0000, v173
    v_lshlrev_b32_e64 v148, 16, v174
    v_and_b32 v149, 0xffff0000, v174
    v_lshlrev_b32_e64 v150, 16, v175
    v_and_b32 v151, 0xffff0000, v175
    v_pk_add_f32 v[16:17], v[16:17], v[128:129]
    v_pk_add_f32 v[18:19], v[18:19], v[130:131]
    v_pk_add_f32 v[20:21], v[20:21], v[132:133]
    v_pk_add_f32 v[22:23], v[22:23], v[134:135]
    v_pk_add_f32 v[24:25], v[24:25], v[136:137]
    v_pk_add_f32 v[26:27], v[26:27], v[138:139]
    v_pk_add_f32 v[28:29], v[28:29], v[140:141]
    v_pk_add_f32 v[30:31], v[30:31], v[142:143]
    v_pk_add_f32 v[32:33], v[32:33], v[144:145]
    v_pk_add_f32 v[34:35], v[34:35], v[146:147]
    v_pk_add_f32 v[36:37], v[36:37], v[148:149]
    v_pk_add_f32 v[38:39], v[38:39], v[150:151]
    s_waitcnt lgkmcnt(0)
    s_barrier
    buffer_load_dwordx4 a[136:139], v1, s[8:11], s55 offen offset:2048 sc1
    buffer_load_dwordx4 a[140:143], v1, s[8:11], s55 offen offset:3072 sc1
    s_add_u32 s55, s55, 4096
    buffer_load_dwordx4 a[144:147], v1, s[8:11], s55 offen sc1
    buffer_load_dwordx4 a[148:151], v1, s[8:11], s55 offen offset:1024 sc1
    ds_read_b128 v[40:43], v188 offset:0
    ds_read_b128 v[44:47], v188 offset:1024
    ds_read_b128 v[48:51], v189 offset:0
    ds_read_b128 v[52:55], v189 offset:1024
    ds_read_b128 v[56:59], v190 offset:0
    ds_read_b128 v[60:63], v190 offset:1024
    ds_read_b128 v[64:67], v188 offset:2048
    ds_read_b128 v[68:71], v188 offset:3072
    ds_read_b128 v[72:75], v189 offset:2048
    ds_read_b128 v[76:79], v189 offset:3072
    ds_read_b128 v[80:83], v190 offset:2048
    ds_read_b128 v[84:87], v190 offset:3072
    s_cmp_ge_u32 s24, 2
    s_cbranch_scc1 r2_30
    ds_read_b128 v[88:91], v188 offset:4096
    ds_read_b128 v[92:95], v188 offset:5120
    ds_read_b128 v[96:99], v189 offset:4096
    ds_read_b128 v[100:103], v189 offset:5120
    ds_read_b128 v[104:107], v190 offset:4096
    ds_read_b128 v[108:111], v190 offset:5120
r2_30:
    s_waitcnt lgkmcnt(11)
    v_pk_add_f32 v[16:17], v[16:17], v[40:41]
    v_pk_add_f32 v[18:19], v[18:19], v[42:43]
    s_waitcnt lgkmcnt(10)
    v_pk_add_f32 v[20:21], v[20:21], v[44:45]
    v_pk_add_f32 v[22:23], v[22:23], v[46:47]
    s_waitcnt lgkmcnt(9)
    v_pk_add_f32 v[16:17], v[16:17], v[48:49]
    v_pk_add_f32 v[18:19], v[18:19], v[50:51]
    s_waitcnt lgkmcnt(8)
    v_pk_add_f32 v[20:21], v[20:21], v[52:53]
    v_pk_add_f32 v[22:23], v[22:23], v[54:55]
    s_waitcnt lgkmcnt(7)
    v_pk_add_f32 v[16:17], v[16:17], v[56:57]
    v_pk_add_f32 v[18:19], v[18:19], v[58:59]
    s_waitcnt lgkmcnt(6)
    v_pk_add_f32 v[20:21], v[20:21], v[60:61]
    v_pk_add_f32 v[22:23], v[22:23], v[62:63]
    v_cvt_pk_bf16_f32 v152, v16, v17
    v_cvt_pk_bf16_f32 v153, v18, v19
    v_cvt_pk_bf16_f32 v154, v20, v21
    v_cvt_pk_bf16_f32 v155, v22, v23
    s_waitcnt lgkmcnt(5)
    v_pk_add_f32 v[24:25], v[24:25], v[64:65]
    v_pk_add_f32 v[26:27], v[26:27], v[66:67]
    s_waitcnt lgkmcnt(4)
    v_pk_add_f32 v[28:29], v[28:29], v[68:69]
    v_pk_add_f32 v[30:31], v[30:31], v[70:71]
    s_waitcnt lgkmcnt(3)
    v_pk_add_f32 v[24:25], v[24:25], v[72:73]
    v_pk_add_f32 v[26:27], v[26:27], v[74:75]
    s_waitcnt lgkmcnt(2)
    v_pk_add_f32 v[28:29], v[28:29], v[76:77]
    v_pk_add_f32 v[30:31], v[30:31], v[78:79]
    s_waitcnt lgkmcnt(1)
    v_pk_add_f32 v[24:25], v[24:25], v[80:81]
    v_pk_add_f32 v[26:27], v[26:27], v[82:83]
    s_waitcnt lgkmcnt(0)
    v_pk_add_f32 v[28:29], v[28:29], v[84:85]
    v_pk_add_f32 v[30:31], v[30:31], v[86:87]
    v_cvt_pk_bf16_f32 v156, v24, v25
    v_cvt_pk_bf16_f32 v157, v26, v27
    v_cvt_pk_bf16_f32 v158, v28, v29
    v_cvt_pk_bf16_f32 v159, v30, v31
    s_waitcnt lgkmcnt(5)
    v_pk_add_f32 v[32:33], v[32:33], v[88:89]
    v_pk_add_f32 v[34:35], v[34:35], v[90:91]
    s_waitcnt lgkmcnt(4)
    v_pk_add_f32 v[36:37], v[36:37], v[92:93]
    v_pk_add_f32 v[38:39], v[38:39], v[94:95]
    s_waitcnt lgkmcnt(3)
    v_pk_add_f32 v[32:33], v[32:33], v[96:97]
    v_pk_add_f32 v[34:35], v[34:35], v[98:99]
    s_waitcnt lgkmcnt(2)
    v_pk_add_f32 v[36:37], v[36:37], v[100:101]
    v_pk_add_f32 v[38:39], v[38:39], v[102:103]
    s_waitcnt lgkmcnt(1)
    v_pk_add_f32 v[32:33], v[32:33], v[104:105]
    v_pk_add_f32 v[34:35], v[34:35], v[106:107]
    s_waitcnt lgkmcnt(0)
    v_pk_add_f32 v[36:37], v[36:37], v[108:109]
    v_pk_add_f32 v[38:39], v[38:39], v[110:111]
    v_cvt_pk_bf16_f32 v160, v32, v33
    v_cvt_pk_bf16_f32 v161, v34, v35
    v_cvt_pk_bf16_f32 v162, v36, v37
    v_cvt_pk_bf16_f32 v163, v38, v39
    buffer_store_dwordx4 v[152:155], v14, s[8:11], s46 offen offset:0 sc1
    buffer_store_dwordx4 v[156:159], v14, s[8:11], s46 offen offset:512 sc1
    s_cmp_lt_u32 s24, 2
    s_cselect_b32 s32, 0, 1073741824
    s_cselect_b32 s33, -1, 0
    v_add_u32 v14, s32, v14
    buffer_store_dwordx4 v[160:163], v14, s[8:11], s46 offen offset:1024 sc1
    v_mov_b32 v200, 0
    v_mov_b32 v201, 0
    v_mov_b32 v204, 0x3f803f80
    v_and_b32 v208, s33, v160
    v_and_b32 v209, s33, v161
    v_and_b32 v210, s33, v162
    v_and_b32 v211, s33, v163
    v_dot2_f32_bf16 v200, v152, v204, v200
    v_dot2_f32_bf16 v201, v152, v152, v201
    v_dot2_f32_bf16 v200, v153, v204, v200
    v_dot2_f32_bf16 v201, v153, v153, v201
    v_dot2_f32_bf16 v200, v154, v204, v200
    v_dot2_f32_bf16 v201, v154, v154, v201
    v_dot2_f32_bf16 v200, v155, v204, v200
    v_dot2_f32_bf16 v201, v155, v155, v201
    v_dot2_f32_bf16 v200, v156, v204, v200
    v_dot2_f32_bf16 v201, v156, v156, v201
    v_dot2_f32_bf16 v200, v157, v204, v200
    v_dot2_f32_bf16 v201, v157, v157, v201
    v_dot2_f32_bf16 v200, v158, v204, v200
    v_dot2_f32_bf16 v201, v158, v158, v201
    v_dot2_f32_bf16 v200, v159, v204, v200
    v_dot2_f32_bf16 v201, v159, v159, v201
    v_dot2_f32_bf16 v200, v208, v204, v200
    v_dot2_f32_bf16 v201, v208, v208, v201
    v_dot2_f32_bf16 v200, v209, v204, v200
    v_dot2_f32_bf16 v201, v209, v209, v201
    v_dot2_f32_bf16 v200, v210, v204, v200
    v_dot2_f32_bf16 v201, v210, v210, v201
    v_dot2_f32_bf16 v200, v211, v204, v200
    v_dot2_f32_bf16 v201, v211, v211, v201
    s_nop 2
    v_mov_b32 v202, v200
    v_mov_b32 v203, v201
    s_nop 0
    v_permlane32_swap_b32 v200, v202
    v_permlane32_swap_b32 v201, v203
    v_add_f32 v200, v200, v202
    v_add_f32 v201, v201, v203
    buffer_store_dwordx2 v[200:201], v15, s[8:11], s47 offen sc1
    v_lshrrev_b32 v4, 4, v2
    v_lshlrev_b32 v3, 7, v2
    v_lshl_add_u32 v3, v4, 28, v3
    v_mov_b32 v4, 0x01010101
    s_waitcnt vmcnt(0)
    s_barrier
    s_cmp_lg_u32 s24, 0
    s_cbranch_scc1 sig_31
    buffer_store_dword v4, v3, s[8:11], s48 offen sc1
sig_31:
    buffer_load_dwordx4 a[152:155], v1, s[8:11], s55 offen offset:2048 sc1
    buffer_load_dwordx4 a[156:159], v1, s[8:11], s55 offen offset:3072 sc1
    s_add_u32 s55, s55, 4096
    buffer_load_dwordx4 a[160:163], v1, s[8:11], s55 offen sc1
    buffer_load_dwordx4 a[164:167], v1, s[8:11], s55 offen offset:1024 sc1
    buffer_load_dwordx4 a[168:171], v1, s[8:11], s55 offen offset:2048 sc1
    buffer_load_dwordx4 a[172:175], v1, s[8:11], s55 offen offset:3072 sc1
    s_add_u32 s55, s55, 4096
    buffer_load_dwordx4 a[176:179], v1, s[8:11], s55 offen sc1
    buffer_load_dwordx4 a[180:183], v1, s[8:11], s55 offen offset:1024 sc1
    buffer_load_dwordx4 a[184:187], v1, s[8:11], s55 offen offset:2048 sc1
    buffer_load_dwordx4 a[188:191], v1, s[8:11], s55 offen offset:3072 sc1
    s_add_u32 s55, s55, 4096
    buffer_load_dwordx4 a[192:195], v1, s[8:11], s55 offen sc1
    buffer_load_dwordx4 a[196:199], v1, s[8:11], s55 offen offset:1024 sc1
L_C:
    s_and_b32 s30, s25, 1
    s_lshl_b32 s30, s30, 3
    s_lshr_b32 s31, s26, 2
    s_add_u32 s40, s30, s31
    s_lshr_b32 s30, s25, 1
    s_lshl_b32 s30, s30, 2
    s_and_b32 s31, s26, 3
    s_add_u32 s41, s30, s31
    s_and_b32 s32, s24, 1
    s_lshr_b32 s33, s24, 1
    s_mul_i32 s43, s24, 10240
    s_mul_i32 s42, s40, 163840
    s_add_u32 s42, s42, 12582912
    s_lshl_b32 s34, s31, 2
    s_add_u32 s34, s34, s24
    s_mul_i32 s34, s34, 2560
    s_add_u32 s42, s42, s43
    s_mul_i32 s30, s41, 12
    s_mul_i32 s31, s32, 6
    s_add_u32 s30, s30, s31
    s_add_u32 s30, s30, s33
    s_lshl_b32 s44, s30, 5
    s_add_u32 s44, s44, 22478848
    s_mul_i32 s46, s40, 393216
    s_lshl_b32 s30, s30, 8
    s_add_u32 s46, s46, s30
    s_add_u32 s46, s46, 15728640
    s_lshl_b32 s45, s40, 2
    s_add_u32 s45, s45, s24
    s_lshl_b32 s45, s45, 12
    s_add_u32 s45, s45, 22216704
    s_lshl_b32 s47, s40, 11
    s_lshl_b32 s30, s41, 2
    s_add_u32 s47, s47, s30
    s_add_u32 s48, s47, 22609920
    s_add_u32 s47, s47, 22642688
    v_lshrrev_b32 v13, 5, v2
    v_lshlrev_b32 v14, 4, v13
    s_add_u32 s49, s44, 6144
    v_and_b32_e64 v15, 15, v2
    v_bfe_u32 v12, v2, 4, 1
    v_mul_u32_u24 v6, 20480, v12
    v_lshl_add_u32 v6, v15, 4, v6
    v_lshl_add_u32 v6, v13, 8, v6
    s_mul_i32 s30, s33, 10240
    v_add_u32_e64 v7, s30, v6
    v_add_u32 v6, 98304, v7
    v_add_u32 v8, 40960, v7
    v_mul_u32_u24 v11, 49152, v12
    v_lshl_add_u32 v11, v15, 4, v11
    v_lshl_add_u32 v10, v13, 9, v11
    v_lshl_add_u32 v11, v13, 30, v11
    s_mul_i32 s30, s24, 6144
    s_add_u32 s30, s30, 139264
    v_add_u32 v164, s30, v1
    s_xor_b32 s30, s24, 2
    s_mul_i32 s30, s30, 6144
    s_add_u32 s30, s30, 139264
    v_add_u32 v165, s30, v1
    v_and_b32 v12, 31, v2
    v_lshlrev_b32_e64 v9, 4, v12
    v_add_u32 v9, 81920, v9
    s_lshr_b32 s30, s25, 1
    s_lshl_b32 s30, s30, 2
    s_lshr_b32 s31, s26, 3
    s_add_u32 s30, s30, s31
    s_lshl_b32 s30, s30, 3
    s_bfe_u32 s31, s26, 0x10002
    s_add_u32 s57, s30, s31
    s_mul_i32 s30, s57, 49152
    s_and_b32 s31, s26, 3
    s_lshl_b32 s31, s31, 2
    s_add_u32 s31, s31, s24
    s_mul_i32 s31, s31, 3072
    s_add_u32 s30, s30, s31
    s_add_u32 s58, s30, 15728640
    v_min_u32 v166, 47, v2
    v_cmp_lt_u32 vcc, 23, v166
    v_lshlrev_b32_e64 v166, 7, v166
    v_add_u32 v167, 95232, v166
    v_cndmask_b32 v166, v166, v167, vcc
    s_lshl_b32 s30, s40, 4
    s_add_u32 s30, s30, s41
    s_lshl_b32 s30, s30, 7
    s_add_u32 s30, s30, 22577152
    s_and_b32 s31, s24, 1
    s_lshl_b32 s31, s31, 3
    s_add_u32 s37, s30, s31
    s_mov_b32 s29, 262144
sp_33:
    s_load_dwordx2 s[64:65], s[84:85], s37 offset:0 glc
    s_waitcnt lgkmcnt(0)
    s_and_b32 s64, s64, s65
    s_cmp_eq_u32 s64, 0x01010101
    s_cbranch_scc1 sp_33_d
    s_sleep 2
    s_sub_u32 s29, s29, 1
    s_cbranch_scc0 sp_33
sp_33_d:
    s_add_u32 m0, s43, 98304
    s_add_u32 s36, s42, 0
    buffer_load_dwordx4 v1, s[8:11], s36 offen sc1 lds
    buffer_load_dwordx4 v1, s[8:11], s36 offen offset:1024 sc1 lds
    buffer_load_dwordx4 v1, s[8:11], s36 offen offset:2048 sc1 lds
    buffer_load_dwordx4 v1, s[8:11], s36 offen offset:3072 sc1 lds
    s_add_u32 m0, s43, 102400
    s_add_u32 s36, s42, 4096
    buffer_load_dwordx4 v1, s[8:11], s36 offen sc1 lds
    buffer_load_dwordx4 v1, s[8:11], s36 offen offset:1024 sc1 lds
    buffer_load_dwordx4 v1, s[8:11], s36 offen offset:2048 sc1 lds
    buffer_load_dwordx4 v1, s[8:11], s36 offen offset:3072 sc1 lds
    s_add_u32 m0, s43, 106496
    s_add_u32 s36, s42, 8192
    buffer_load_dwordx4 v1, s[8:11], s36 offen sc1 lds
    buffer_load_dwordx4 v1, s[8:11], s36 offen offset:1024 sc1 lds
    s_lshl_b32 s31, s25, 2
    s_lshr_b32 s28, s26, 3
    s_add_u32 s31, s31, s28
    s_lshl_b32 s31, s31, 11
    s_add_u32 s31, s31, 22676992
    s_cmp_lg_u32 s24, 1
    s_cbranch_scc1 sp_34_d
    s_mov_b32 s29, 262144
sp_34:
    s_load_dwordx4 s[64:67], s[84:85], s31 offset:0 glc
    s_load_dwordx4 s[68:71], s[84:85], s31 offset:128 glc
    s_load_dwordx4 s[72:75], s[84:85], s31 offset:256 glc
    s_load_dwordx4 s[76:79], s[84:85], s31 offset:384 glc
    s_waitcnt lgkmcnt(0)
    s_and_b32 s64, s64, s65
    s_and_b32 s64, s64, s66
    s_and_b32 s64, s64, s67
    s_and_b32 s64, s64, s68
    s_and_b32 s64, s64, s69
    s_and_b32 s64, s64, s70
    s_and_b32 s64, s64, s71
    s_and_b32 s64, s64, s72
    s_and_b32 s64, s64, s73
    s_and_b32 s64, s64, s74
    s_and_b32 s64, s64, s75
    s_and_b32 s64, s64, s76
    s_and_b32 s64, s64, s77
    s_and_b32 s64, s64, s78
    s_and_b32 s64, s64, s79
    s_cmp_eq_u32 s64, 0x01010101
    s_cbranch_scc1 sp_34_d
    s_sleep 2
    s_sub_u32 s29, s29, 1
    s_cbranch_scc0 sp_34
sp_34_d:
    s_cmp_lg_u32 s24, 0
    s_cbranch_scc1 sp_35_d
    s_mov_b32 s29, 262144
sp_35:
    s_load_dwordx16 s[64:79], s[84:85], s30 offset:0 glc
    s_waitcnt lgkmcnt(0)
    s_and_b32 s64, s64, s65
    s_and_b32 s64, s64, s66
    s_and_b32 s64, s64, s67
    s_and_b32 s64, s64, s68
    s_and_b32 s64, s64, s69
    s_and_b32 s64, s64, s70
    s_and_b32 s64, s64, s71
    s_and_b32 s64, s64, s72
    s_and_b32 s64, s64, s73
    s_and_b32 s64, s64, s74
    s_and_b32 s64, s64, s75
    s_and_b32 s64, s64, s76
    s_and_b32 s64, s64, s77
    s_and_b32 s64, s64, s78
    s_and_b32 s64, s64, s79
    s_cmp_eq_u32 s64, 0x01010101
    s_cbranch_scc1 sp_35_d
    s_sleep 2
    s_sub_u32 s29, s29, 1
    s_cbranch_scc0 sp_35
sp_35_d:
    buffer_load_dwordx4 a[200:203], v1, s[8:11], s55 offen offset:2048 sc1
    buffer_load_dwordx4 a[204:207], v1, s[8:11], s55 offen offset:3072 sc1
    s_add_u32 s55, s55, 4096
    buffer_load_dwordx4 a[208:211], v1, s[8:11], s55 offen sc1
    buffer_load_dwordx4 a[212:215], v1, s[8:11], s55 offen offset:1024 sc1
    buffer_load_dwordx4 a[216:219], v1, s[8:11], s55 offen offset:2048 sc1
    buffer_load_dwordx4 a[220:223], v1, s[8:11], s55 offen offset:3072 sc1
    s_waitcnt vmcnt(12)
    s_barrier
    buffer_load_dwordx4 v[64:67], v1, s[8:11], s45 offen offset:0 sc1
    buffer_load_dwordx4 v[68:71], v1, s[8:11], s45 offen offset:1024 sc1
    buffer_load_dwordx4 v[72:75], v1, s[8:11], s45 offen offset:2048 sc1
    buffer_load_dwordx4 v[76:79], v1, s[8:11], s45 offen offset:3072 sc1
    ds_read_b128 v[112:115], v6 offset:0
    ds_read_b128 v[116:119], v6 offset:512
    ds_read_b128 v[120:123], v6 offset:1024
    ds_read_b128 v[124:127], v6 offset:1536
    s_waitcnt lgkmcnt(2)
    v_mfma_f32_32x32x16_bf16 v[16:31], a[0:3], v[112:115], 0
    s_add_u32 s55, s55, 4096
    buffer_load_dwordx4 a[224:227], v1, s[8:11], s55 offen sc1
    v_mfma_f32_32x32x16_bf16 v[32:47], a[4:7], v[112:115], 0
    ds_read_b128 v[128:131], v6 offset:2048
    v_mfma_f32_32x32x16_bf16 v[48:63], a[8:11], v[112:115], 0
    buffer_load_dwordx4 a[228:231], v1, s[8:11], s55 offen offset:1024 sc1
    v_mfma_f32_32x32x16_bf16 v[16:31], a[12:15], v[116:119], v[16:31]
    buffer_load_dwordx4 a[232:235], v1, s[8:11], s55 offen offset:2048 sc1
    v_mfma_f32_32x32x16_bf16 v[32:47], a[16:19], v[116:119], v[32:47]
    ds_read_b128 v[132:135], v6 offset:2560
    v_mfma_f32_32x32x16_bf16 v[48:63], a[20:23], v[116:119], v[48:63]
    s_waitcnt lgkmcnt(2)
    buffer_load_dwordx4 a[236:239], v1, s[8:11], s55 offen offset:3072 sc1
    v_mfma_f32_32x32x16_bf16 v[16:31], a[24:27], v[120:123], v[16:31]
    v_mfma_f32_32x32x16_bf16 v[32:47], a[28:31], v[120:123], v[32:47]
    ds_read_b128 v[112:115], v6 offset:3072
    v_mfma_f32_32x32x16_bf16 v[48:63], a[32:35], v[120:123], v[48:63]
    s_add_u32 m0, s43, 0
    s_add_u32 s36, s42, 40960
    buffer_load_dwordx4 v1, s[8:11], s36 offen sc1 lds
    v_mfma_f32_32x32x16_bf16 v[16:31], a[36:39], v[124:127], v[16:31]
    buffer_load_dwordx4 v1, s[8:11], s36 offen offset:1024 sc1 lds
    v_mfma_f32_32x32x16_bf16 v[32:47], a[40:43], v[124:127], v[32:47]
    ds_read_b128 v[116:119], v6 offset:3584
    v_mfma_f32_32x32x16_bf16 v[48:63], a[44:47], v[124:127], v[48:63]
    s_waitcnt lgkmcnt(2)
    buffer_load_dwordx4 v1, s[8:11], s36 offen offset:2048 sc1 lds
    v_mfma_f32_32x32x16_bf16 v[16:31], a[48:51], v[128:131], v[16:31]
    s_waitcnt vmcnt(17)
    s_waitcnt lgkmcnt(0)
    s_barrier
    buffer_load_dwordx4 v1, s[8:11], s36 offen offset:3072 sc1 lds
    v_mfma_f32_32x32x16_bf16 v[32:47], a[52:55], v[128:131], v[32:47]
    ds_read_b128 v[120:123], v6 offset:4096
    v_mfma_f32_32x32x16_bf16 v[48:63], a[56:59], v[128:131], v[48:63]
    s_add_u32 m0, s43, 4096
    s_add_u32 s36, s42, 45056
    buffer_load_dwordx4 v1, s[8:11], s36 offen sc1 lds
    v_mfma_f32_32x32x16_bf16 v[16:31], a[60:63], v[132:135], v[16:31]
    v_mfma_f32_32x32x16_bf16 v[32:47], a[64:67], v[132:135], v[32:47]
    ds_read_b128 v[124:127], v6 offset:4608
    v_mfma_f32_32x32x16_bf16 v[48:63], a[68:71], v[132:135], v[48:63]
    buffer_load_dwordx4 v1, s[8:11], s36 offen offset:1024 sc1 lds
    v_mfma_f32_32x32x16_bf16 v[16:31], a[72:75], v[112:115], v[16:31]
    buffer_load_dwordx4 v1, s[8:11], s36 offen offset:2048 sc1 lds
    v_mfma_f32_32x32x16_bf16 v[32:47], a[76:79], v[112:115], v[32:47]
    ds_read_b128 v[128:131], v6 offset:5120
    v_mfma_f32_32x32x16_bf16 v[48:63], a[80:83], v[112:115], v[48:63]
    buffer_load_dwordx4 v1, s[8:11], s36 offen offset:3072 sc1 lds
    v_mfma_f32_32x32x16_bf16 v[16:31], a[84:87], v[116:119], v[16:31]
    s_add_u32 m0, s43, 8192
    s_add_u32 s36, s42, 49152
    buffer_load_dwordx4 v1, s[8:11], s36 offen sc1 lds
    v_mfma_f32_32x32x16_bf16 v[32:47], a[88:91], v[116:119], v[32:47]
    ds_read_b128 v[132:135], v6 offset:5632
    v_mfma_f32_32x32x16_bf16 v[48:63], a[92:95], v[116:119], v[48:63]
    s_waitcnt lgkmcnt(2)
    buffer_load_dwordx4 v1, s[8:11], s36 offen offset:1024 sc1 lds
    v_mfma_f32_32x32x16_bf16 v[16:31], a[96:99], v[120:123], v[16:31]
    v_mfma_f32_32x32x16_bf16 v[32:47], a[100:103], v[120:123], v[32:47]
    ds_read_b128 v[112:115], v6 offset:6144
    v_mfma_f32_32x32x16_bf16 v[48:63], a[104:107], v[120:123], v[48:63]
    buffer_load_dwordx4 v[136:139], v14, s[8:11], s44 offen offset:0 sc1
    v_mfma_f32_32x32x16_bf16 v[16:31], a[108:111], v[124:127], v[16:31]
    buffer_load_dwordx4 v[140:143], v14, s[8:11], s49 offen offset:0 sc1
    v_mfma_f32_32x32x16_bf16 v[32:47], a[112:115], v[124:127], v[32:47]
    ds_read_b128 v[116:119], v6 offset:6656
    v_mfma_f32_32x32x16_bf16 v[48:63], a[116:119], v[124:127], v[48:63]
    s_waitcnt lgkmcnt(2)
    buffer_load_dwordx4 v[144:147], v14, s[8:11], s44 offen offset:64 sc1
    v_mfma_f32_32x32x16_bf16 v[16:31], a[120:123], v[128:131], v[16:31]
    s_waitcnt vmcnt(19)
    v_add_f32 v64, v64, v68
    v_add_f32 v65, v65, v69
    v_add_f32_e64 v66, v66, v70
    buffer_load_dwordx4 v[148:151], v14, s[8:11], s49 offen offset:64 sc1
    v_mfma_f32_32x32x16_bf16 v[32:47], a[124:127], v[128:131], v[32:47]
    v_add_f32 v67, v67, v71
    s_waitcnt vmcnt(19)
    v_add_f32 v64, v64, v72
    v_add_f32 v65, v65, v73
    ds_read_b128 v[120:123], v6 offset:7168
    v_mfma_f32_32x32x16_bf16 v[48:63], a[128:131], v[128:131], v[48:63]
    v_add_f32 v66, v66, v74
    v_add_f32 v67, v67, v75
    s_waitcnt vmcnt(18)
    v_add_f32 v64, v64, v76
    buffer_load_dwordx4 v[152:155], v14, s[8:11], s44 offen offset:128 sc1
    v_mfma_f32_32x32x16_bf16 v[16:31], a[132:135], v[132:135], v[16:31]
    v_add_f32 v65, v65, v77
    v_add_f32 v66, v66, v78
    v_add_f32 v67, v67, v79
    v_mov_b32 v68, v64
    v_mov_b32 v69, v65
    v_mov_b32 v70, v66
    v_mfma_f32_32x32x16_bf16 v[32:47], a[136:139], v[132:135], v[32:47]
    v_mov_b32_e64 v71, v67
    v_permlane16_swap_b32 v64, v68
    v_permlane16_swap_b32 v65, v69
    ds_read_b128 v[124:127], v6 offset:7680
    v_mfma_f32_32x32x16_bf16 v[48:63], a[140:143], v[132:135], v[48:63]
    v_permlane16_swap_b32 v66, v70
    v_permlane16_swap_b32 v67, v71
    s_waitcnt lgkmcnt(2)
    buffer_load_dwordx4 v[156:159], v14, s[8:11], s49 offen offset:128 sc1
    v_mfma_f32_32x32x16_bf16 v[16:31], a[144:147], v[112:115], v[16:31]
    v_add_f32 v64, v64, v68
    v_add_f32 v65, v65, v69
    v_add_f32 v66, v66, v70
    v_add_f32 v67, v67, v71
    v_mov_b32 v68, v64
    v_mov_b32_e64 v69, v65
    v_mfma_f32_32x32x16_bf16 v[32:47], a[148:151], v[112:115], v[32:47]
    v_mov_b32 v70, v66
    v_mov_b32_e64 v71, v67
    v_permlane32_swap_b32 v64, v68
    ds_read_b128 v[128:131], v6 offset:8192
    v_mfma_f32_32x32x16_bf16 v[48:63], a[152:155], v[112:115], v[48:63]
    v_permlane32_swap_b32 v65, v69
    v_permlane32_swap_b32 v66, v70
    v_permlane32_swap_b32 v67, v71
    v_add_f32 v64, v64, v68
    v_add_f32 v65, v65, v69
    v_add_f32 v66, v66, v70
    v_mfma_f32_32x32x16_bf16 v[16:31], a[156:159], v[116:119], v[16:31]
    v_add_f32 v67, v67, v71
    s_lshl_b32 s35, s24, 9
    s_add_u32 s35, s35, 81920
    v_and_b32_e64 v12, 15, v2
    v_lshl_add_u32 v12, v12, 5, s35
    v_mul_f32 v72, 0x3acccccd, v64
    v_mfma_f32_32x32x16_bf16 v[32:47], a[160:163], v[116:119], v[32:47]
    v_mul_f32 v75, 0x3acccccd, v65
    v_fma_f32 v75, -v72, v72, v75
    v_max_f32_e64 v75, 0, v75
    ds_read_b128 v[132:135], v6 offset:8704
    v_mfma_f32_32x32x16_bf16 v[48:63], a[164:167], v[116:119], v[48:63]
    v_add_f32 v75, 0x3727c5ac, v75
    v_rsq_f32 v68, v75
    s_nop 0
    v_mul_f32 v73, 0xc0135761, v68
    v_mul_f32 v68, v68, v68
    s_waitcnt lgkmcnt(2)
    v_mfma_f32_32x32x16_bf16 v[16:31], a[168:171], v[120:123], v[16:31]
    v_mul_f32 v74, 0x3d372713, v73
    v_mul_f32_e64 v74, v74, v68
    v_mul_f32 v76, 0x3acccccd, v66
    v_mul_f32 v79, 0x3acccccd, v67
    v_fma_f32 v79, -v76, v76, v79
    v_max_f32_e64 v79, 0, v79
    v_mfma_f32_32x32x16_bf16 v[32:47], a[172:175], v[120:123], v[32:47]
    v_add_f32 v79, 0x3727c5ac, v79
    v_rsq_f32_e64 v68, v79
    ds_read_b128 v[112:115], v6 offset:9216
    v_mfma_f32_32x32x16_bf16 v[48:63], a[176:179], v[120:123], v[48:63]
    v_mul_f32 v77, 0xc0135761, v68
    v_mul_f32_e64 v68, v68, v68
    v_mul_f32 v78, 0x3d372713, v77
    v_mul_f32_e64 v78, v78, v68
    s_and_b32 s34, s26, 7
    s_lshl_b32 s34, s34, 2
    v_mfma_f32_32x32x16_bf16 v[16:31], a[180:183], v[124:127], v[16:31]
    s_add_u32 s34, s34, s24
    s_mul_i32 s34, s34, 256
    v_min_u32 v13, 1, v2
    v_lshl_add_u32 v13, v13, 7, s34
    v_min_u32 v13, L_end-L_D, v13
    v_add_u32 v13, L_D-L_pc, v13
    v_mfma_f32_32x32x16_bf16 v[32:47], a[184:187], v[124:127], v[32:47]
    global_load_dword v5, v13, s[6:7]
    ds_read_b128 v[116:119], v6 offset:9728
    v_mfma_f32_32x32x16_bf16 v[48:63], a[188:191], v[124:127], v[48:63]
    s_waitcnt lgkmcnt(2)
    v_mfma_f32_32x32x16_bf16 v[16:31], a[192:195], v[128:131], v[16:31]
    s_waitcnt vmcnt(7)
    s_waitcnt lgkmcnt(0)
    s_barrier
    v_mfma_f32_32x32x16_bf16 v[32:47], a[196:199], v[128:131], v[32:47]
    ds_read_b128 v[120:123], v7 offset:0
    v_mfma_f32_32x32x16_bf16 v[48:63], a[200:203], v[128:131], v[48:63]
    v_mfma_f32_32x32x16_bf16 v[16:31], a[204:207], v[132:135], v[16:31]
    v_mfma_f32_32x32x16_bf16 v[32:47], a[208:211], v[132:135], v[32:47]
    ds_read_b128 v[124:127], v7 offset:512
    v_mfma_f32_32x32x16_bf16 v[48:63], a[212:215], v[132:135], v[48:63]
    v_mfma_f32_32x32x16_bf16 v[16:31], a[216:219], v[112:115], v[16:31]
    ds_write_b128 v12, v[72:75] offset:0
    v_mfma_f32_32x32x16_bf16 v[32:47], a[220:223], v[112:115], v[32:47]
    ds_read_b128 v[128:131], v7 offset:1024
    v_mfma_f32_32x32x16_bf16 v[48:63], a[224:227], v[112:115], v[48:63]
    ds_write_b128 v12, v[76:79] offset:16
    v_mfma_f32_32x32x16_bf16 v[16:31], a[228:231], v[116:119], v[16:31]
    v_mfma_f32_32x32x16_bf16 v[32:47], a[232:235], v[116:119], v[32:47]
    ds_read_b128 v[132:135], v7 offset:1536
    v_mfma_f32_32x32x16_bf16 v[48:63], a[236:239], v[116:119], v[48:63]
    s_waitcnt lgkmcnt(4)
    v_mfma_f32_32x32x16_bf16 v[64:79], a[0:3], v[120:123], 0
    s_add_u32 m0, s43, 40960
    s_add_u32 s36, s42, 81920
    buffer_load_dwordx4 v1, s[8:11], s36 offen sc1 lds
    v_mfma_f32_32x32x16_bf16 v[80:95], a[4:7], v[120:123], 0
    ds_read_b128 v[112:115], v7 offset:2048
    v_mfma_f32_32x32x16_bf16 v[96:111], a[8:11], v[120:123], 0
    s_nop 0
    ds_write_b128 v164, v[20:23] offset:0
    buffer_load_dwordx4 v1, s[8:11], s36 offen offset:1024 sc1 lds
    v_mfma_f32_32x32x16_bf16 v[64:79], a[12:15], v[124:127], v[64:79]
    v_mfma_f32_32x32x16_bf16 v[80:95], a[16:19], v[124:127], v[80:95]
    ds_read_b128 v[116:119], v7 offset:2560
    ds_write_b128 v164, v[28:31] offset:1024
    v_mfma_f32_32x32x16_bf16 v[96:111], a[20:23], v[124:127], v[96:111]
    s_waitcnt lgkmcnt(4)
    buffer_load_dwordx4 v1, s[8:11], s36 offen offset:2048 sc1 lds
    v_mfma_f32_32x32x16_bf16 v[64:79], a[24:27], v[128:131], v[64:79]
    ds_write_b128 v164, v[36:39] offset:2048
    buffer_load_dwordx4 v1, s[8:11], s36 offen offset:3072 sc1 lds
    v_mfma_f32_32x32x16_bf16 v[80:95], a[28:31], v[128:131], v[80:95]
    ds_read_b128 v[120:123], v7 offset:3072
    v_mfma_f32_32x32x16_bf16 v[96:111], a[32:35], v[128:131], v[96:111]
    ds_write_b128 v164, v[44:47] offset:3072
    v_mfma_f32_32x32x16_bf16 v[64:79], a[36:39], v[132:135], v[64:79]
    s_add_u32 m0, s43, 45056
    s_add_u32 s36, s42, 86016
    buffer_load_dwordx4 v1, s[8:11], s36 offen sc1 lds
    v_mfma_f32_32x32x16_bf16 v[80:95], a[40:43], v[132:135], v[80:95]
    ds_read_b128 v[124:127], v7 offset:3584
    ds_write_b128 v164, v[52:55] offset:4096
    v_mfma_f32_32x32x16_bf16 v[96:111], a[44:47], v[132:135], v[96:111]
    s_waitcnt lgkmcnt(6)
    buffer_load_dwordx4 v1, s[8:11], s36 offen offset:1024 sc1 lds
    v_mfma_f32_32x32x16_bf16 v[64:79], a[48:51], v[112:115], v[64:79]
    ds_write_b128 v164, v[60:63] offset:5120
    v_mfma_f32_32x32x16_bf16 v[80:95], a[52:55], v[112:115], v[80:95]
    ds_read_b128 v[128:131], v7 offset:4096
    v_mfma_f32_32x32x16_bf16 v[96:111], a[56:59], v[112:115], v[96:111]
    buffer_load_dwordx4 v1, s[8:11], s36 offen offset:2048 sc1 lds
    v_mfma_f32_32x32x16_bf16 v[64:79], a[60:63], v[116:119], v[64:79]
    s_waitcnt lgkmcnt(0)
    s_barrier
    ds_read_b128 v[20:23], v165 offset:0
    ds_read_b128 v[28:31], v165 offset:1024
    ds_read_b128 v[36:39], v165 offset:2048
    ds_read_b128 v[44:47], v165 offset:3072
    v_mfma_f32_32x32x16_bf16 v[80:95], a[64:67], v[116:119], v[80:95]
    ds_read_b128 v[132:135], v7 offset:4608
    ds_read_b128 v[52:55], v165 offset:4096
    ds_read_b128 v[60:63], v165 offset:5120
    ds_read_b128 v[160:163], v9 offset:0
    v_mfma_f32_32x32x16_bf16 v[96:111], a[68:71], v[116:119], v[96:111]
    s_waitcnt lgkmcnt(7)
    v_add_f32 v16, v16, v20
    v_add_f32 v17, v17, v21
    v_add_f32 v18, v18, v22
    buffer_load_dwordx4 v1, s[8:11], s36 offen offset:3072 sc1 lds
    v_mfma_f32_32x32x16_bf16 v[64:79], a[72:75], v[120:123], v[64:79]
    v_add_f32 v19, v19, v23
    s_waitcnt lgkmcnt(5)
    v_add_f32_e64 v32, v32, v36
    s_add_u32 m0, s43, 49152
    s_add_u32 s36, s42, 90112
    buffer_load_dwordx4 v1, s[8:11], s36 offen sc1 lds
    v_mfma_f32_32x32x16_bf16 v[80:95], a[76:79], v[120:123], v[80:95]
    v_add_f32 v33, v33, v37
    v_add_f32 v34, v34, v38
    v_add_f32 v35, v35, v39
    s_waitcnt lgkmcnt(2)
    v_add_f32_e64 v48, v48, v52
    ds_read_b128 v[112:115], v7 offset:5120
    v_mfma_f32_32x32x16_bf16 v[96:111], a[80:83], v[120:123], v[96:111]
    v_add_f32 v49, v49, v53
    v_add_f32 v50, v50, v54
    v_add_f32 v51, v51, v55
    v_add_f32 v24, v24, v28
    buffer_load_dwordx4 v1, s[8:11], s36 offen offset:1024 sc1 lds
    v_mfma_f32_32x32x16_bf16 v[64:79], a[84:87], v[124:127], v[64:79]
    v_add_f32 v25, v25, v29
    v_add_f32 v26, v26, v30
    v_add_f32 v27, v27, v31
    v_add_f32 v40, v40, v44
    v_add_f32 v41, v41, v45
    v_add_f32 v42, v42, v46
    v_add_f32_e64 v43, v43, v47
    v_mfma_f32_32x32x16_bf16 v[80:95], a[88:91], v[124:127], v[80:95]
    s_waitcnt lgkmcnt(2)
    v_add_f32 v56, v56, v60
    v_add_f32 v57, v57, v61
    v_add_f32 v58, v58, v62
    v_add_f32_e64 v59, v59, v63
    ds_read_b128 v[116:119], v7 offset:5632
    v_mfma_f32_32x32x16_bf16 v[96:111], a[92:95], v[124:127], v[96:111]
    s_waitcnt vmcnt(16) lgkmcnt(2)
    v_fma_f32 v16, -v160, v136, v16
    s_add_u32 m0, s43, 98304
    s_add_u32 s36, s42, 122880
    buffer_load_dwordx4 v1, s[8:11], s36 offen sc1 lds
    v_mfma_f32_32x32x16_bf16 v[64:79], a[96:99], v[128:131], v[64:79]
    v_fma_f32 v17, -v160, v137, v17
    v_fma_f32 v18, -v160, v138, v18
    v_fma_f32 v19, -v160, v139, v19
    s_waitcnt vmcnt(15)
    v_fma_f32 v32, -v160, v144, v32
    v_fma_f32 v33, -v160, v145, v33
    v_fma_f32 v34, -v160, v146, v34
    v_fma_f32 v35, -v160, v147, v35
    s_waitcnt vmcnt(13)
    v_fma_f32 v48, -v160, v152, v48
    v_mfma_f32_32x32x16_bf16 v[80:95], a[100:103], v[128:131], v[80:95]
    v_fma_f32 v49, -v160, v153, v49
    v_fma_f32 v50, -v160, v154, v50
    v_fma_f32 v51, -v160, v155, v51
    v_mul_f32 v20, v16, v16
    ds_read_b128 v[120:123], v7 offset:6144
    v_mfma_f32_32x32x16_bf16 v[96:111], a[104:107], v[128:131], v[96:111]
    v_mul_f32 v21, v17, v17
    v_mul_f32 v22, v18, v18
    v_mul_f32 v23, v19, v19
    v_mul_f32 v36, v32, v32
    buffer_load_dwordx4 v1, s[8:11], s36 offen offset:1024 sc1 lds
    v_mfma_f32_32x32x16_bf16 v[64:79], a[108:111], v[132:135], v[64:79]
    v_mul_f32 v37, v33, v33
    v_mul_f32 v38, v34, v34
    v_mul_f32 v39, v35, v35
    v_mul_f32 v52, v48, v48
    buffer_load_dwordx4 v1, s[8:11], s36 offen offset:2048 sc1 lds
    v_mfma_f32_32x32x16_bf16 v[80:95], a[112:115], v[132:135], v[80:95]
    v_mul_f32 v53, v49, v49
    v_mul_f32 v54, v50, v50
    v_mul_f32_e64 v55, v51, v51
    v_fma_f32 v20, v20, v162, v161
    ds_read_b128 v[124:127], v7 offset:6656
    v_mfma_f32_32x32x16_bf16 v[96:111], a[116:119], v[132:135], v[96:111]
    v_fma_f32 v21, v21, v162, v161
    v_fma_f32 v22, v22, v162, v161
    v_fma_f32 v23, v23, v162, v161
    v_fma_f32 v36, v36, v162, v161
    v_fma_f32 v37, v37, v162, v161
    v_fma_f32 v38, v38, v162, v161
    s_waitcnt lgkmcnt(2)
    v_mfma_f32_32x32x16_bf16 v[64:79], a[120:123], v[112:115], v[64:79]
    v_fma_f32 v39, v39, v162, v161
    v_fma_f32 v52, v52, v162, v161
    v_fma_f32 v53, v53, v162, v161
    v_fma_f32 v54, v54, v162, v161
    buffer_load_dwordx4 v1, s[8:11], s36 offen offset:3072 sc1 lds
    v_mfma_f32_32x32x16_bf16 v[80:95], a[124:127], v[112:115], v[80:95]
    v_fma_f32 v55, v55, v162, v161
    v_mul_f32 v20, v20, v16
    v_mul_f32 v21, v21, v17
    v_mul_f32 v22, v22, v18
    ds_read_b128 v[128:131], v7 offset:7168
    v_mfma_f32_32x32x16_bf16 v[96:111], a[128:131], v[112:115], v[96:111]
    v_mul_f32 v23, v23, v19
    v_mul_f32 v36, v36, v32
    v_mul_f32_e64 v37, v37, v33
    s_add_u32 m0, s43, 102400
    s_add_u32 s36, s42, 126976
    buffer_load_dwordx4 v1, s[8:11], s36 offen sc1 lds
    v_mfma_f32_32x32x16_bf16 v[64:79], a[132:135], v[116:119], v[64:79]
    v_mul_f32 v38, v38, v34
    v_mul_f32 v39, v39, v35
    v_mul_f32 v52, v52, v48
    v_mul_f32 v53, v53, v49
    v_mul_f32 v54, v54, v50
    v_mul_f32 v55, v55, v51
    v_mfma_f32_32x32x16_bf16 v[80:95], a[136:139], v[116:119], v[80:95]
    v_exp_f32_e64 v20, v20
    v_fma_f32 v24, -v160, v140, v24
    v_exp_f32_e64 v21, v21
    ds_read_b128 v[132:135], v7 offset:7680
    v_mfma_f32_32x32x16_bf16 v[96:111], a[140:143], v[116:119], v[96:111]
    v_fma_f32 v25, -v160, v141, v25
    v_exp_f32 v22, v22
    s_waitcnt lgkmcnt(2)
    buffer_load_dwordx4 v1, s[8:11], s36 offen offset:1024 sc1 lds
    v_mfma_f32_32x32x16_bf16 v[64:79], a[144:147], v[120:123], v[64:79]
    v_fma_f32 v26, -v160, v142, v26
    v_exp_f32_e64 v23, v23
    v_fma_f32 v27, -v160, v143, v27
    buffer_load_dwordx4 v1, s[8:11], s36 offen offset:2048 sc1 lds
    v_mfma_f32_32x32x16_bf16 v[80:95], a[148:151], v[120:123], v[80:95]
    v_exp_f32_e64 v36, v36
    v_fma_f32 v40, -v160, v148, v40
    ds_read_b128 v[112:115], v7 offset:8192
    v_mfma_f32_32x32x16_bf16 v[96:111], a[152:155], v[120:123], v[96:111]
    v_exp_f32_e64 v37, v37
    v_fma_f32 v41, -v160, v149, v41
    v_exp_f32_e64 v38, v38
    v_fma_f32 v42, -v160, v150, v42
    v_exp_f32_e64 v39, v39
    v_mfma_f32_32x32x16_bf16 v[64:79], a[156:159], v[124:127], v[64:79]
    v_fma_f32 v43, -v160, v151, v43
    v_exp_f32 v52, v52
    s_waitcnt vmcnt(18)
    v_fma_f32 v56, -v160, v156, v56
    buffer_load_dwordx4 v1, s[8:11], s36 offen offset:3072 sc1 lds
    v_mfma_f32_32x32x16_bf16 v[80:95], a[160:163], v[124:127], v[80:95]
    v_exp_f32_e64 v53, v53
    v_fma_f32 v57, -v160, v157, v57
    v_exp_f32_e64 v54, v54
    ds_read_b128 v[116:119], v7 offset:8704
    v_mfma_f32_32x32x16_bf16 v[96:111], a[164:167], v[124:127], v[96:111]
    v_fma_f32 v58, -v160, v158, v58
    s_waitcnt lgkmcnt(2)
    s_add_u32 m0, s43, 106496
    s_add_u32 s36, s42, 131072
    buffer_load_dwordx4 v1, s[8:11], s36 offen sc1 lds
    v_mfma_f32_32x32x16_bf16 v[64:79], a[168:171], v[128:131], v[64:79]
    v_exp_f32 v55, v55
    v_fma_f32 v59, -v160, v159, v59
    v_fma_f32 v20, v20, v163, v163
    v_fma_f32 v21, v21, v163, v163
    v_fma_f32 v22, v22, v163, v163
    v_fma_f32 v23, v23, v163, v163
    v_mfma_f32_32x32x16_bf16 v[80:95], a[172:175], v[128:131], v[80:95]
    v_fma_f32 v36, v36, v163, v163
    v_fma_f32 v37, v37, v163, v163
    v_fma_f32 v38, v38, v163, v163
    v_fma_f32 v39, v39, v163, v163
    ds_read_b128 v[120:123], v7 offset:9216
    v_mfma_f32_32x32x16_bf16 v[96:111], a[176:179], v[128:131], v[96:111]
    v_fma_f32 v52, v52, v163, v163
    v_fma_f32 v53, v53, v163, v163
    v_fma_f32 v54, v54, v163, v163
    v_fma_f32 v55, v55, v163, v163
    buffer_load_dwordx4 v1, s[8:11], s36 offen offset:1024 sc1 lds
    v_mfma_f32_32x32x16_bf16 v[64:79], a[180:183], v[132:135], v[64:79]
    v_rcp_f32 v20, v20
    v_mul_f32 v16, v16, v24
    v_rcp_f32 v21, v21
    v_mul_f32 v17, v17, v25
    v_mfma_f32_32x32x16_bf16 v[80:95], a[184:187], v[132:135], v[80:95]
    v_rcp_f32 v22, v22
    v_mul_f32 v18, v18, v26
    v_rcp_f32_e64 v23, v23
    ds_read_b128 v[124:127], v7 offset:9728
    v_mfma_f32_32x32x16_bf16 v[96:111], a[188:191], v[132:135], v[96:111]
    v_mul_f32 v19, v19, v27
    v_rcp_f32_e64 v36, v36
    s_waitcnt lgkmcnt(2)
    buffer_load_dwordx4 v[176:179], v1, s[8:11], s56 offen sc1
    v_mfma_f32_32x32x16_bf16 v[64:79], a[192:195], v[112:115], v[64:79]
    v_mul_f32 v32, v32, v40
    v_rcp_f32_e64 v37, v37
    s_waitcnt vmcnt(11)
    s_waitcnt lgkmcnt(0)
    s_barrier
    buffer_load_dwordx4 v[180:183], v1, s[8:11], s56 offen offset:1024 sc1
    v_mfma_f32_32x32x16_bf16 v[80:95], a[196:199], v[112:115], v[80:95]
    v_mul_f32 v33, v33, v41
    v_rcp_f32 v38, v38
    v_mul_f32_e64 v34, v34, v42
    ds_read_b128 v[128:131], v8 offset:0
    v_mfma_f32_32x32x16_bf16 v[96:111], a[200:203], v[112:115], v[96:111]
    v_rcp_f32 v39, v39
    v_mul_f32 v35, v35, v43
    buffer_load_dwordx4 v[184:187], v1, s[8:11], s56 offen offset:2048 sc1
    v_mfma_f32_32x32x16_bf16 v[64:79], a[204:207], v[116:119], v[64:79]
    v_rcp_f32 v52, v52
    v_mul_f32 v48, v48, v56
    v_rcp_f32 v53, v53
    v_mul_f32 v49, v49, v57
    v_rcp_f32_e64 v54, v54
    v_mfma_f32_32x32x16_bf16 v[80:95], a[208:211], v[116:119], v[80:95]
    v_mul_f32 v50, v50, v58
    v_rcp_f32 v55, v55
    v_mul_f32_e64 v51, v51, v59
    ds_read_b128 v[132:135], v8 offset:512
    v_mfma_f32_32x32x16_bf16 v[96:111], a[212:215], v[116:119], v[96:111]
    v_mul_f32 v16, v16, v20
    v_mul_f32 v17, v17, v21
    v_mul_f32_e64 v18, v18, v22
    buffer_load_dwordx4 v[188:191], v1, s[8:11], s56 offen offset:3072 sc1
    v_mfma_f32_32x32x16_bf16 v[64:79], a[216:219], v[120:123], v[64:79]
    v_mul_f32 v19, v19, v23
    v_mul_f32 v32, v32, v36
    v_mul_f32 v33, v33, v37
    v_mul_f32 v34, v34, v38
    v_mul_f32 v35, v35, v39
    v_mul_f32 v48, v48, v52
    v_mul_f32_e64 v49, v49, v53
    v_mfma_f32_32x32x16_bf16 v[80:95], a[220:223], v[120:123], v[80:95]
    v_mul_f32 v50, v50, v54
    v_mul_f32 v51, v51, v55
    v_cvt_pk_bf16_f32 v28, v16, v17
    v_cvt_pk_bf16_f32 v29, v18, v19
    ds_read_b128 v[112:115], v8 offset:1024
    v_mfma_f32_32x32x16_bf16 v[96:111], a[224:227], v[120:123], v[96:111]
    v_cvt_pk_bf16_f32 v30, v32, v33
    v_cvt_pk_bf16_f32 v31, v34, v35
    v_cvt_pk_bf16_f32 v44, v48, v49
    v_cvt_pk_bf16_f32 v45, v50, v51
    s_add_u32 s56, s56, 4096
    buffer_load_dwordx4 v[192:195], v1, s[8:11], s56 offen sc1
    v_mfma_f32_32x32x16_bf16 v[64:79], a[228:231], v[124:127], v[64:79]
    v_mov_b32 v46, v44
    v_mov_b32 v47, v45
    v_permlane32_swap_b32 v28, v30
    v_permlane32_swap_b32 v29, v31
    buffer_load_dwordx4 v[196:199], v1, s[8:11], s56 offen offset:1024 sc1
    v_mfma_f32_32x32x16_bf16 v[80:95], a[232:235], v[124:127], v[80:95]
    v_permlane32_swap_b32 v44, v46
    v_permlane32_swap_b32 v45, v47
    ds_read_b128 v[116:119], v8 offset:1536
    v_mfma_f32_32x32x16_bf16 v[96:111], a[236:239], v[124:127], v[96:111]
    buffer_store_dwordx4 v[28:31], v10, s[8:11], s46 offen sc1
    buffer_store_dwordx4 v[44:47], v11, s[8:11], s46 offen offset:1024 sc1
    s_waitcnt lgkmcnt(2)
    v_mfma_f32_32x32x16_bf16 v[16:31], a[0:3], v[128:131], 0
    buffer_load_dwordx4 v[200:203], v1, s[8:11], s56 offen offset:2048 sc1
    v_mfma_f32_32x32x16_bf16 v[32:47], a[4:7], v[128:131], 0
    ds_read_b128 v[120:123], v8 offset:2048
    v_mfma_f32_32x32x16_bf16 v[48:63], a[8:11], v[128:131], 0
    ds_write_b128 v164, v[68:71] offset:0
    buffer_load_dwordx4 v[204:207], v1, s[8:11], s56 offen offset:3072 sc1
    v_mfma_f32_32x32x16_bf16 v[16:31], a[12:15], v[132:135], v[16:31]
    v_mfma_f32_32x32x16_bf16 v[32:47], a[16:19], v[132:135], v[32:47]
    ds_read_b128 v[124:127], v8 offset:2560
    ds_write_b128 v164, v[76:79] offset:1024
    v_mfma_f32_32x32x16_bf16 v[48:63], a[20:23], v[132:135], v[48:63]
    s_waitcnt lgkmcnt(4)
    s_add_u32 s56, s56, 4096
    buffer_load_dwordx4 v[208:211], v1, s[8:11], s56 offen sc1
    v_mfma_f32_32x32x16_bf16 v[16:31], a[24:27], v[112:115], v[16:31]
    ds_write_b128 v164, v[84:87] offset:2048
    v_mfma_f32_32x32x16_bf16 v[32:47], a[28:31], v[112:115], v[32:47]
    ds_read_b128 v[128:131], v8 offset:3072
    v_mfma_f32_32x32x16_bf16 v[48:63], a[32:35], v[112:115], v[48:63]
    ds_write_b128 v164, v[92:95] offset:3072
    buffer_load_dwordx4 v[212:215], v1, s[8:11], s56 offen offset:1024 sc1
    v_mfma_f32_32x32x16_bf16 v[16:31], a[36:39], v[116:119], v[16:31]
    v_mfma_f32_32x32x16_bf16 v[32:47], a[40:43], v[116:119], v[32:47]
    ds_read_b128 v[132:135], v8 offset:3584
    ds_write_b128 v164, v[100:103] offset:4096
    v_mfma_f32_32x32x16_bf16 v[48:63], a[44:47], v[116:119], v[48:63]
    s_waitcnt lgkmcnt(6)
    buffer_load_dwordx4 v[216:219], v1, s[8:11], s56 offen offset:2048 sc1
    v_mfma_f32_32x32x16_bf16 v[16:31], a[48:51], v[120:123], v[16:31]
    ds_write_b128 v164, v[108:111] offset:5120
    v_mfma_f32_32x32x16_bf16 v[32:47], a[52:55], v[120:123], v[32:47]
    ds_read_b128 v[112:115], v8 offset:4096
    v_mfma_f32_32x32x16_bf16 v[48:63], a[56:59], v[120:123], v[48:63]
    buffer_load_dwordx4 v[220:223], v1, s[8:11], s56 offen offset:3072 sc1
    v_mfma_f32_32x32x16_bf16 v[16:31], a[60:63], v[124:127], v[16:31]
    s_waitcnt lgkmcnt(0)
    s_barrier
    ds_read_b128 v[68:71], v165 offset:0
    ds_read_b128 v[76:79], v165 offset:1024
    ds_read_b128 v[84:87], v165 offset:2048
    ds_read_b128 v[92:95], v165 offset:3072
    v_mfma_f32_32x32x16_bf16 v[32:47], a[64:67], v[124:127], v[32:47]
    ds_read_b128 v[116:119], v8 offset:4608
    ds_read_b128 v[100:103], v165 offset:4096
    ds_read_b128 v[108:111], v165 offset:5120
    ds_read_b128 v[160:163], v9 offset:512
    v_mfma_f32_32x32x16_bf16 v[48:63], a[68:71], v[124:127], v[48:63]
    s_waitcnt lgkmcnt(7)
    v_add_f32_e64 v64, v64, v68
    s_add_u32 s56, s56, 4096
    buffer_load_dwordx4 v[224:227], v1, s[8:11], s56 offen sc1
    v_mfma_f32_32x32x16_bf16 v[16:31], a[72:75], v[128:131], v[16:31]
    v_add_f32 v65, v65, v69
    v_add_f32 v66, v66, v70
    v_add_f32 v67, v67, v71
    s_waitcnt lgkmcnt(5)
    v_add_f32 v80, v80, v84
    v_add_f32 v81, v81, v85
    v_add_f32 v82, v82, v86
    v_add_f32 v83, v83, v87
    v_mfma_f32_32x32x16_bf16 v[32:47], a[76:79], v[128:131], v[32:47]
    s_waitcnt lgkmcnt(2)
    v_add_f32 v96, v96, v100
    v_add_f32 v97, v97, v101
    v_add_f32 v98, v98, v102
    v_add_f32_e64 v99, v99, v103
    ds_read_b128 v[120:123], v8 offset:5120
    v_mfma_f32_32x32x16_bf16 v[48:63], a[80:83], v[128:131], v[48:63]
    v_add_f32 v72, v72, v76
    v_add_f32 v73, v73, v77
    v_add_f32 v74, v74, v78
    v_add_f32 v75, v75, v79
    buffer_load_dwordx4 v[228:231], v1, s[8:11], s56 offen offset:1024 sc1
    v_mfma_f32_32x32x16_bf16 v[16:31], a[84:87], v[132:135], v[16:31]
    v_add_f32 v88, v88, v92
    v_add_f32 v89, v89, v93
    v_add_f32 v90, v90, v94
    v_add_f32 v91, v91, v95
    buffer_load_dwordx4 v[232:235], v1, s[8:11], s56 offen offset:2048 sc1
    v_mfma_f32_32x32x16_bf16 v[32:47], a[88:91], v[132:135], v[32:47]
    s_waitcnt lgkmcnt(2)
    v_add_f32 v104, v104, v108
    v_add_f32 v105, v105, v109
    v_add_f32 v106, v106, v110
    v_add_f32_e64 v107, v107, v111
    ds_read_b128 v[124:127], v8 offset:5632
    v_mfma_f32_32x32x16_bf16 v[48:63], a[92:95], v[132:135], v[48:63]
    s_waitcnt lgkmcnt(2)
    v_fma_f32 v64, -v160, v136, v64
    v_fma_f32 v65, -v160, v137, v65
    v_fma_f32 v66, -v160, v138, v66
    v_fma_f32 v67, -v160, v139, v67
    v_fma_f32 v80, -v160, v144, v80
    v_fma_f32 v81, -v160, v145, v81
    v_mfma_f32_32x32x16_bf16 v[16:31], a[96:99], v[112:115], v[16:31]
    v_fma_f32 v82, -v160, v146, v82
    v_fma_f32 v83, -v160, v147, v83
    v_fma_f32 v96, -v160, v152, v96
    v_fma_f32 v97, -v160, v153, v97
    buffer_load_dwordx4 v[236:239], v1, s[8:11], s56 offen offset:3072 sc1
    v_mfma_f32_32x32x16_bf16 v[32:47], a[100:103], v[112:115], v[32:47]
    v_fma_f32 v98, -v160, v154, v98
    v_fma_f32 v99, -v160, v155, v99
    v_mul_f32 v68, v64, v64
    ds_read_b128 v[128:131], v8 offset:6144
    v_mfma_f32_32x32x16_bf16 v[48:63], a[104:107], v[112:115], v[48:63]
    v_mul_f32 v69, v65, v65
    v_mul_f32 v70, v66, v66
    v_mul_f32 v71, v67, v67
    v_mul_f32 v84, v80, v80
    v_mul_f32 v85, v81, v81
    v_mul_f32 v86, v82, v82
    v_mul_f32_e64 v87, v83, v83
    v_mfma_f32_32x32x16_bf16 v[16:31], a[108:111], v[116:119], v[16:31]
    v_mul_f32 v100, v96, v96
    v_mul_f32 v101, v97, v97
    v_mul_f32_e64 v102, v98, v98
    s_add_u32 s56, s56, 4096
    buffer_load_dwordx4 v[240:243], v1, s[8:11], s56 offen sc1
    v_mfma_f32_32x32x16_bf16 v[32:47], a[112:115], v[116:119], v[32:47]
    v_mul_f32_e64 v103, v99, v99
    v_fma_f32 v68, v68, v162, v161
    v_fma_f32 v69, v69, v162, v161
    v_fma_f32 v70, v70, v162, v161
    ds_read_b128 v[132:135], v8 offset:6656
    v_mfma_f32_32x32x16_bf16 v[48:63], a[116:119], v[116:119], v[48:63]
    v_fma_f32 v71, v71, v162, v161
    v_fma_f32 v84, v84, v162, v161
    v_fma_f32 v85, v85, v162, v161
    v_fma_f32 v86, v86, v162, v161
    v_fma_f32 v87, v87, v162, v161
    v_fma_f32 v100, v100, v162, v161
    s_waitcnt lgkmcnt(2)
    v_mfma_f32_32x32x16_bf16 v[16:31], a[120:123], v[120:123], v[16:31]
    v_fma_f32 v101, v101, v162, v161
    v_fma_f32 v102, v102, v162, v161
    v_fma_f32 v103, v103, v162, v161
    v_mul_f32 v68, v68, v64
    buffer_load_dwordx4 v[244:247], v1, s[8:11], s56 offen offset:1024 sc1
    v_mfma_f32_32x32x16_bf16 v[32:47], a[124:127], v[120:123], v[32:47]
    v_mul_f32 v69, v69, v65
    v_mul_f32 v70, v70, v66
    v_mul_f32 v71, v71, v67
    v_mul_f32 v84, v84, v80
    ds_read_b128 v[112:115], v8 offset:7168
    v_mfma_f32_32x32x16_bf16 v[48:63], a[128:131], v[120:123], v[48:63]
    v_mul_f32 v85, v85, v81
    v_mul_f32 v86, v86, v82
    v_mul_f32 v87, v87, v83
    v_mul_f32 v100, v100, v96
    buffer_load_dwordx4 v[248:251], v1, s[8:11], s56 offen offset:2048 sc1
    v_mfma_f32_32x32x16_bf16 v[16:31], a[132:135], v[124:127], v[16:31]
    v_mul_f32 v101, v101, v97
    v_mul_f32 v102, v102, v98
    v_mul_f32 v103, v103, v99
    v_exp_f32 v68, v68
    v_fma_f32 v72, -v160, v140, v72
    v_mfma_f32_32x32x16_bf16 v[32:47], a[136:139], v[124:127], v[32:47]
    v_exp_f32_e64 v69, v69
    v_fma_f32 v73, -v160, v141, v73
    ds_read_b128 v[116:119], v8 offset:7680
    v_mfma_f32_32x32x16_bf16 v[48:63], a[140:143], v[124:127], v[48:63]
    v_exp_f32_e64 v70, v70
    v_fma_f32 v74, -v160, v142, v74
    s_waitcnt lgkmcnt(2)
    buffer_load_dwordx4 v[252:255], v1, s[8:11], s56 offen offset:3072 sc1
    v_mfma_f32_32x32x16_bf16 v[16:31], a[144:147], v[128:131], v[16:31]
    v_exp_f32 v71, v71
    v_fma_f32 v75, -v160, v143, v75
    v_exp_f32_e64 v84, v84
    v_fma_f32 v88, -v160, v148, v88
    v_exp_f32_e64 v85, v85
    v_mfma_f32_32x32x16_bf16 v[32:47], a[148:151], v[128:131], v[32:47]
    v_fma_f32 v89, -v160, v149, v89
    v_exp_f32_e64 v86, v86
    v_fma_f32 v90, -v160, v150, v90
    ds_read_b128 v[120:123], v8 offset:8192
    v_mfma_f32_32x32x16_bf16 v[48:63], a[152:155], v[128:131], v[48:63]
    v_exp_f32 v87, v87
    s_add_u32 m0, s43, 0
    s_add_u32 s56, s56, 4096
    buffer_load_dwordx4 v1, s[8:11], s56 offen sc1 lds
    v_mfma_f32_32x32x16_bf16 v[16:31], a[156:159], v[132:135], v[16:31]
    v_fma_f32 v91, -v160, v151, v91
    v_exp_f32_e64 v100, v100
    v_fma_f32 v104, -v160, v156, v104
    v_exp_f32_e64 v101, v101
    v_fma_f32 v105, -v160, v157, v105
    v_mfma_f32_32x32x16_bf16 v[32:47], a[160:163], v[132:135], v[32:47]
    v_exp_f32_e64 v102, v102
    v_fma_f32 v106, -v160, v158, v106
    ds_read_b128 v[124:127], v8 offset:8704
    v_mfma_f32_32x32x16_bf16 v[48:63], a[164:167], v[132:135], v[48:63]
    v_exp_f32_e64 v103, v103
    v_fma_f32 v107, -v160, v159, v107
    s_waitcnt lgkmcnt(2)
    buffer_load_dwordx4 v1, s[8:11], s56 offen offset:1024 sc1 lds
    v_mfma_f32_32x32x16_bf16 v[16:31], a[168:171], v[112:115], v[16:31]
    v_fma_f32 v68, v68, v163, v163
    v_fma_f32 v69, v69, v163, v163
    v_fma_f32 v70, v70, v163, v163
    v_fma_f32 v71, v71, v163, v163
    v_fma_f32 v84, v84, v163, v163
    v_fma_f32 v85, v85, v163, v163
    v_fma_f32 v86, v86, v163, v163
    v_mfma_f32_32x32x16_bf16 v[32:47], a[172:175], v[112:115], v[32:47]
    v_fma_f32 v87, v87, v163, v163
    v_fma_f32 v100, v100, v163, v163
    v_fma_f32 v101, v101, v163, v163
    v_fma_f32 v102, v102, v163, v163
    ds_read_b128 v[128:131], v8 offset:9216
    v_mfma_f32_32x32x16_bf16 v[48:63], a[176:179], v[112:115], v[48:63]
    v_fma_f32 v103, v103, v163, v163
    v_rcp_f32 v68, v68
    v_mul_f32_e64 v64, v64, v72
    buffer_load_dwordx4 v1, s[8:11], s56 offen offset:2048 sc1 lds
    v_mfma_f32_32x32x16_bf16 v[16:31], a[180:183], v[116:119], v[16:31]
    v_rcp_f32 v69, v69
    v_mul_f32 v65, v65, v73
    v_rcp_f32 v70, v70
    v_mul_f32 v66, v66, v74
    v_mfma_f32_32x32x16_bf16 v[32:47], a[184:187], v[116:119], v[32:47]
    v_rcp_f32 v71, v71
    v_mul_f32 v67, v67, v75
    v_rcp_f32_e64 v84, v84
    ds_read_b128 v[132:135], v8 offset:9728
    v_mfma_f32_32x32x16_bf16 v[48:63], a[188:191], v[116:119], v[48:63]
    v_mul_f32 v80, v80, v88
    v_rcp_f32_e64 v85, v85
    s_waitcnt lgkmcnt(2)
    buffer_load_dwordx4 v1, s[8:11], s56 offen offset:3072 sc1 lds
    v_mfma_f32_32x32x16_bf16 v[16:31], a[192:195], v[120:123], v[16:31]
    v_mul_f32 v81, v81, v89
    v_rcp_f32 v86, v86
    v_mul_f32 v82, v82, v90
    s_waitcnt vmcnt(26)
    s_waitcnt lgkmcnt(0)
    s_barrier
    v_mfma_f32_32x32x16_bf16 v[32:47], a[196:199], v[120:123], v[32:47]
    v_rcp_f32 v87, v87
    v_mul_f32 v83, v83, v91
    ds_read_b128 v[112:115], v6 offset:0
    v_mfma_f32_32x32x16_bf16 v[48:63], a[200:203], v[120:123], v[48:63]
    v_rcp_f32 v100, v100
    v_mul_f32 v96, v96, v104
    s_add_u32 m0, s43, 4096
    s_add_u32 s56, s56, 4096
    buffer_load_dwordx4 v1, s[8:11], s56 offen sc1 lds
    v_mfma_f32_32x32x16_bf16 v[16:31], a[204:207], v[124:127], v[16:31]
    v_rcp_f32 v101, v101
    v_mul_f32 v97, v97, v105
    buffer_load_dwordx4 v1, s[8:11], s56 offen offset:1024 sc1 lds
    v_mfma_f32_32x32x16_bf16 v[32:47], a[208:211], v[124:127], v[32:47]
    v_rcp_f32 v102, v102
    v_mul_f32 v98, v98, v106
    v_rcp_f32_e64 v103, v103
    ds_read_b128 v[116:119], v6 offset:512
    v_mfma_f32_32x32x16_bf16 v[48:63], a[212:215], v[124:127], v[48:63]
    v_mul_f32 v99, v99, v107
    v_mul_f32 v64, v64, v68
    v_mul_f32 v65, v65, v69
    v_mul_f32 v66, v66, v70
    v_mul_f32 v67, v67, v71
    v_mul_f32 v80, v80, v84
    v_mfma_f32_32x32x16_bf16 v[16:31], a[216:219], v[128:131], v[16:31]
    v_mul_f32 v81, v81, v85
    v_mul_f32 v82, v82, v86
    v_mul_f32 v83, v83, v87
    v_mul_f32 v96, v96, v100
    buffer_load_dwordx4 v1, s[8:11], s56 offen offset:2048 sc1 lds
    v_mfma_f32_32x32x16_bf16 v[32:47], a[220:223], v[128:131], v[32:47]
    v_mul_f32 v97, v97, v101
    v_mul_f32 v98, v98, v102
    v_mul_f32_e64 v99, v99, v103
    v_cvt_pk_bf16_f32 v76, v64, v65
    ds_read_b128 v[120:123], v6 offset:1024
    v_mfma_f32_32x32x16_bf16 v[48:63], a[224:227], v[128:131], v[48:63]
    v_cvt_pk_bf16_f32 v77, v66, v67
    v_cvt_pk_bf16_f32 v78, v80, v81
    v_cvt_pk_bf16_f32 v79, v82, v83
    v_cvt_pk_bf16_f32 v92, v96, v97
    v_cvt_pk_bf16_f32 v93, v98, v99
    v_mov_b32 v94, v92
    v_mov_b32 v95, v93
    v_mfma_f32_32x32x16_bf16 v[16:31], a[228:231], v[132:135], v[16:31]
    s_add_u32 s46, s46, 98304
    v_permlane32_swap_b32 v76, v78
    v_permlane32_swap_b32 v77, v79
    buffer_load_dwordx4 v1, s[8:11], s56 offen offset:3072 sc1 lds
    v_mfma_f32_32x32x16_bf16 v[32:47], a[232:235], v[132:135], v[32:47]
    v_permlane32_swap_b32 v92, v94
    v_permlane32_swap_b32 v93, v95
    ds_read_b128 v[124:127], v6 offset:1536
    v_mfma_f32_32x32x16_bf16 v[48:63], a[236:239], v[132:135], v[48:63]
    buffer_store_dwordx4 v[76:79], v10, s[8:11], s46 offen sc1
    buffer_store_dwordx4 v[92:95], v11, s[8:11], s46 offen offset:1024 sc1
    s_waitcnt lgkmcnt(2)
    v_mfma_f32_32x32x16_bf16 v[64:79], a[0:3], v[112:115], 0
    s_add_u32 m0, s43, 8192
    s_add_u32 s56, s56, 4096
    buffer_load_dwordx4 v1, s[8:11], s56 offen sc1 lds
    v_mfma_f32_32x32x16_bf16 v[80:95], a[4:7], v[112:115], 0
    ds_read_b128 v[128:131], v6 offset:2048
    v_mfma_f32_32x32x16_bf16 v[96:111], a[8:11], v[112:115], 0
    ds_write_b128 v164, v[20:23] offset:0
    buffer_load_dwordx4 v1, s[8:11], s56 offen offset:1024 sc1 lds
    v_mfma_f32_32x32x16_bf16 v[64:79], a[12:15], v[116:119], v[64:79]
    v_mfma_f32_32x32x16_bf16 v[80:95], a[16:19], v[116:119], v[80:95]
    ds_read_b128 v[132:135], v6 offset:2560
    ds_write_b128 v164, v[28:31] offset:1024
    v_mfma_f32_32x32x16_bf16 v[96:111], a[20:23], v[116:119], v[96:111]
    s_waitcnt lgkmcnt(4)
    s_add_u32 m0, s43, 38912
    s_nop 0
    buffer_load_dwordx4 v1, s[8:11], s56 offen offset:2048 sc1 lds
    v_mfma_f32_32x32x16_bf16 v[64:79], a[24:27], v[120:123], v[64:79]
    ds_write_b128 v164, v[36:39] offset:2048
    v_mfma_f32_32x32x16_bf16 v[80:95], a[28:31], v[120:123], v[80:95]
    ds_read_b128 v[112:115], v6 offset:3072
    v_mfma_f32_32x32x16_bf16 v[96:111], a[32:35], v[120:123], v[96:111]
    ds_write_b128 v164, v[44:47] offset:3072
    buffer_load_dwordx4 v1, s[8:11], s56 offen offset:3072 sc1 lds
    v_mfma_f32_32x32x16_bf16 v[64:79], a[36:39], v[124:127], v[64:79]
    v_mfma_f32_32x32x16_bf16 v[80:95], a[40:43], v[124:127], v[80:95]
    ds_read_b128 v[116:119], v6 offset:3584
    ds_write_b128 v164, v[52:55] offset:4096
    v_mfma_f32_32x32x16_bf16 v[96:111], a[44:47], v[124:127], v[96:111]
    s_waitcnt lgkmcnt(6)
    s_add_u32 m0, s43, 43008
    s_add_u32 s56, s56, 4096
    buffer_load_dwordx4 v1, s[8:11], s56 offen sc1 lds
    v_mfma_f32_32x32x16_bf16 v[64:79], a[48:51], v[128:131], v[64:79]
    ds_write_b128 v164, v[60:63] offset:5120
    v_mfma_f32_32x32x16_bf16 v[80:95], a[52:55], v[128:131], v[80:95]
    ds_read_b128 v[120:123], v6 offset:4096
    v_mfma_f32_32x32x16_bf16 v[96:111], a[56:59], v[128:131], v[96:111]
    buffer_load_dwordx4 v1, s[8:11], s56 offen offset:1024 sc1 lds
    v_mfma_f32_32x32x16_bf16 v[64:79], a[60:63], v[132:135], v[64:79]
    v_lshrrev_b32 v4, 4, v2
    v_lshlrev_b32 v3, 7, v2
    v_lshl_add_u32 v3, v4, 28, v3
    v_mov_b32 v4, 0x01010101
    s_waitcnt vmcnt(6)
    s_waitcnt lgkmcnt(0)
    s_barrier
    s_cmp_lg_u32 s24, 0
    s_cbranch_scc1 sig_36
    buffer_store_dword v4, v3, s[8:11], s48 offen sc1
sig_36:
    ds_read_b128 v[20:23], v165 offset:0
    ds_read_b128 v[28:31], v165 offset:1024
    ds_read_b128 v[36:39], v165 offset:2048
    ds_read_b128 v[44:47], v165 offset:3072
    v_mfma_f32_32x32x16_bf16 v[80:95], a[64:67], v[132:135], v[80:95]
    ds_read_b128 v[124:127], v6 offset:4608
    ds_read_b128 v[52:55], v165 offset:4096
    ds_read_b128 v[60:63], v165 offset:5120
    ds_read_b128 v[160:163], v9 offset:1024
    v_mfma_f32_32x32x16_bf16 v[96:111], a[68:71], v[132:135], v[96:111]
    s_waitcnt lgkmcnt(7)
    v_add_f32 v16, v16, v20
    v_add_f32 v17, v17, v21
    v_add_f32_e64 v18, v18, v22
    buffer_load_dwordx4 v1, s[8:11], s56 offen offset:2048 sc1 lds
    v_mfma_f32_32x32x16_bf16 v[64:79], a[72:75], v[112:115], v[64:79]
    v_add_f32 v19, v19, v23
    s_waitcnt lgkmcnt(5)
    v_add_f32 v32, v32, v36
    v_add_f32 v33, v33, v37
    v_add_f32 v34, v34, v38
    v_add_f32 v35, v35, v39
    s_waitcnt lgkmcnt(2)
    v_add_f32 v48, v48, v52
    v_add_f32 v49, v49, v53
    v_add_f32 v50, v50, v54
    v_mfma_f32_32x32x16_bf16 v[80:95], a[76:79], v[112:115], v[80:95]
    v_add_f32 v51, v51, v55
    v_add_f32 v24, v24, v28
    v_add_f32 v25, v25, v29
    v_add_f32 v26, v26, v30
    v_add_f32_e64 v27, v27, v31
    ds_read_b128 v[128:131], v6 offset:5120
    v_mfma_f32_32x32x16_bf16 v[96:111], a[80:83], v[112:115], v[96:111]
    v_add_f32 v40, v40, v44
    v_add_f32 v41, v41, v45
    v_add_f32 v42, v42, v46
    v_add_f32 v43, v43, v47
    s_waitcnt lgkmcnt(2)
    v_add_f32 v56, v56, v60
    buffer_load_dwordx4 v1, s[8:11], s56 offen offset:3072 sc1 lds
    v_mfma_f32_32x32x16_bf16 v[64:79], a[84:87], v[116:119], v[64:79]
    v_add_f32 v57, v57, v61
    v_add_f32 v58, v58, v62
    v_add_f32 v59, v59, v63
    s_waitcnt lgkmcnt(1)
    v_fma_f32 v16, -v160, v136, v16
    v_fma_f32 v17, -v160, v137, v17
    v_fma_f32 v18, -v160, v138, v18
    v_fma_f32 v19, -v160, v139, v19
    v_mfma_f32_32x32x16_bf16 v[80:95], a[88:91], v[116:119], v[80:95]
    v_fma_f32 v32, -v160, v144, v32
    v_fma_f32 v33, -v160, v145, v33
    v_fma_f32 v34, -v160, v146, v34
    v_fma_f32 v35, -v160, v147, v35
    v_fma_f32 v48, -v160, v152, v48
    ds_read_b128 v[132:135], v6 offset:5632
    v_mfma_f32_32x32x16_bf16 v[96:111], a[92:95], v[116:119], v[96:111]
    v_fma_f32 v49, -v160, v153, v49
    v_fma_f32 v50, -v160, v154, v50
    s_add_u32 m0, s43, 47104
    s_add_u32 s56, s56, 4096
    buffer_load_dwordx4 v1, s[8:11], s56 offen sc1 lds
    v_mfma_f32_32x32x16_bf16 v[64:79], a[96:99], v[120:123], v[64:79]
    v_fma_f32 v51, -v160, v155, v51
    v_mul_f32 v20, v16, v16
    v_mul_f32 v21, v17, v17
    v_mul_f32 v22, v18, v18
    v_mul_f32 v23, v19, v19
    v_mul_f32 v36, v32, v32
    v_mul_f32 v37, v33, v33
    v_mul_f32_e64 v38, v34, v34
    v_mfma_f32_32x32x16_bf16 v[80:95], a[100:103], v[120:123], v[80:95]
    v_mul_f32 v39, v35, v35
    v_mul_f32 v52, v48, v48
    v_mul_f32 v53, v49, v49
    v_mul_f32 v54, v50, v50
    ds_read_b128 v[112:115], v6 offset:6144
    v_mfma_f32_32x32x16_bf16 v[96:111], a[104:107], v[120:123], v[96:111]
    v_mul_f32_e64 v55, v51, v51
    v_fma_f32 v20, v20, v162, v161
    v_fma_f32 v21, v21, v162, v161
    v_fma_f32 v22, v22, v162, v161
    v_fma_f32 v23, v23, v162, v161
    buffer_load_dwordx4 v1, s[8:11], s56 offen offset:1024 sc1 lds
    v_mfma_f32_32x32x16_bf16 v[64:79], a[108:111], v[124:127], v[64:79]
    v_fma_f32 v36, v36, v162, v161
    v_fma_f32 v37, v37, v162, v161
    v_fma_f32 v38, v38, v162, v161
    v_fma_f32 v39, v39, v162, v161
    v_fma_f32 v52, v52, v162, v161
    v_fma_f32 v53, v53, v162, v161
    v_fma_f32 v54, v54, v162, v161
    v_fma_f32 v55, v55, v162, v161
    v_mfma_f32_32x32x16_bf16 v[80:95], a[112:115], v[124:127], v[80:95]
    v_mul_f32 v20, v20, v16
    v_mul_f32 v21, v21, v17
    v_mul_f32 v22, v22, v18
    v_mul_f32 v23, v23, v19
    v_mul_f32_e64 v36, v36, v32
    ds_read_b128 v[116:119], v6 offset:6656
    v_mfma_f32_32x32x16_bf16 v[96:111], a[116:119], v[124:127], v[96:111]
    v_mul_f32 v37, v37, v33
    v_mul_f32 v38, v38, v34
    v_mul_f32 v39, v39, v35
    s_waitcnt lgkmcnt(2)
    buffer_load_dwordx4 v1, s[8:11], s56 offen offset:2048 sc1 lds
    v_mfma_f32_32x32x16_bf16 v[64:79], a[120:123], v[128:131], v[64:79]
    v_mul_f32 v52, v52, v48
    v_mul_f32 v53, v53, v49
    v_mul_f32 v54, v54, v50
    v_mul_f32 v55, v55, v51
    v_exp_f32_e64 v20, v20
    v_fma_f32 v24, -v160, v140, v24
    v_mfma_f32_32x32x16_bf16 v[80:95], a[124:127], v[128:131], v[80:95]
    v_exp_f32_e64 v21, v21
    v_fma_f32 v25, -v160, v141, v25
    v_exp_f32_e64 v22, v22
    v_fma_f32 v26, -v160, v142, v26
    ds_read_b128 v[120:123], v6 offset:7168
    v_mfma_f32_32x32x16_bf16 v[96:111], a[128:131], v[128:131], v[96:111]
    v_exp_f32_e64 v23, v23
    v_fma_f32 v27, -v160, v143, v27
    v_exp_f32_e64 v36, v36
    buffer_load_dwordx4 v1, s[8:11], s56 offen offset:3072 sc1 lds
    v_mfma_f32_32x32x16_bf16 v[64:79], a[132:135], v[132:135], v[64:79]
    v_fma_f32 v40, -v160, v148, v40
    v_exp_f32_e64 v37, v37
    v_fma_f32 v41, -v160, v149, v41
    v_exp_f32_e64 v38, v38
    v_fma_f32 v42, -v160, v150, v42
    v_mfma_f32_32x32x16_bf16 v[80:95], a[136:139], v[132:135], v[80:95]
    v_exp_f32_e64 v39, v39
    v_fma_f32 v43, -v160, v151, v43
    v_exp_f32_e64 v52, v52
    ds_read_b128 v[124:127], v6 offset:7680
    v_mfma_f32_32x32x16_bf16 v[96:111], a[140:143], v[132:135], v[96:111]
    v_fma_f32 v56, -v160, v156, v56
    v_exp_f32 v53, v53
    s_waitcnt lgkmcnt(2)
    s_add_u32 s56, s56, 4096
    buffer_load_dwordx4 a[0:3], v1, s[8:11], s56 offen sc1
    v_mfma_f32_32x32x16_bf16 v[64:79], a[144:147], v[112:115], v[64:79]
    v_fma_f32 v57, -v160, v157, v57
    v_exp_f32_e64 v54, v54
    v_fma_f32 v58, -v160, v158, v58
    v_exp_f32_e64 v55, v55
    v_fma_f32 v59, -v160, v159, v59
    v_fma_f32 v20, v20, v163, v163
    v_mfma_f32_32x32x16_bf16 v[80:95], a[148:151], v[112:115], v[80:95]
    v_fma_f32 v21, v21, v163, v163
    v_fma_f32 v22, v22, v163, v163
    v_fma_f32 v23, v23, v163, v163
    v_fma_f32 v36, v36, v163, v163
    ds_read_b128 v[128:131], v6 offset:8192
    v_mfma_f32_32x32x16_bf16 v[96:111], a[152:155], v[112:115], v[96:111]
    v_fma_f32 v37, v37, v163, v163
    v_fma_f32 v38, v38, v163, v163
    v_fma_f32 v39, v39, v163, v163
    v_fma_f32 v52, v52, v163, v163
    v_fma_f32 v53, v53, v163, v163
    buffer_load_dwordx4 a[4:7], v1, s[8:11], s56 offen offset:1024 sc1
    v_mfma_f32_32x32x16_bf16 v[64:79], a[156:159], v[116:119], v[64:79]
    v_fma_f32 v54, v54, v163, v163
    v_fma_f32 v55, v55, v163, v163
    v_rcp_f32 v20, v20
    v_mul_f32 v16, v16, v24
    v_rcp_f32 v21, v21
    v_mul_f32 v17, v17, v25
    v_mfma_f32_32x32x16_bf16 v[80:95], a[160:163], v[116:119], v[80:95]
    v_rcp_f32 v22, v22
    v_mul_f32 v18, v18, v26
    ds_read_b128 v[132:135], v6 offset:8704
    s_waitcnt lgkmcnt(0)
    s_barrier
    v_mfma_f32_32x32x16_bf16 v[96:111], a[164:167], v[116:119], v[96:111]
    v_rcp_f32 v23, v23
    v_mul_f32 v19, v19, v27
    buffer_load_dwordx4 a[8:11], v1, s[8:11], s56 offen offset:2048 sc1
    v_mfma_f32_32x32x16_bf16 v[64:79], a[168:171], v[120:123], v[64:79]
    v_rcp_f32 v36, v36
    v_mul_f32 v32, v32, v40
    v_rcp_f32 v37, v37
    v_mul_f32 v33, v33, v41
    buffer_load_dwordx4 a[12:15], v1, s[8:11], s56 offen offset:3072 sc1
    v_mfma_f32_32x32x16_bf16 v[80:95], a[172:175], v[120:123], v[80:95]
    v_rcp_f32 v38, v38
    v_mul_f32 v34, v34, v42
    v_rcp_f32_e64 v39, v39
    ds_read_b128 v[112:115], v6 offset:9216
    v_mfma_f32_32x32x16_bf16 v[96:111], a[176:179], v[120:123], v[96:111]
    v_mul_f32 v35, v35, v43
    v_rcp_f32 v52, v52
    v_mul_f32 v48, v48, v56
    v_rcp_f32 v53, v53
    v_mul_f32_e64 v49, v49, v57
    v_mfma_f32_32x32x16_bf16 v[64:79], a[180:183], v[124:127], v[64:79]
    v_rcp_f32 v54, v54
    v_mul_f32 v50, v50, v58
    s_add_u32 s56, s56, 4096
    buffer_load_dwordx4 a[16:19], v1, s[8:11], s56 offen sc1
    v_mfma_f32_32x32x16_bf16 v[80:95], a[184:187], v[124:127], v[80:95]
    v_rcp_f32 v55, v55
    v_mul_f32 v51, v51, v59
    v_mul_f32 v16, v16, v20
    v_mul_f32 v17, v17, v21
    v_mul_f32_e64 v18, v18, v22
    ds_read_b128 v[116:119], v6 offset:9728
    v_mfma_f32_32x32x16_bf16 v[96:111], a[188:191], v[124:127], v[96:111]
    v_mul_f32 v19, v19, v23
    v_mul_f32 v32, v32, v36
    v_mul_f32 v33, v33, v37
    v_mul_f32 v34, v34, v38
    v_mul_f32 v35, v35, v39
    v_mul_f32_e64 v48, v48, v52
    s_waitcnt lgkmcnt(0)
    v_mfma_f32_32x32x16_bf16 v[64:79], a[192:195], v[128:131], v[64:79]
    v_mul_f32 v49, v49, v53
    v_mul_f32 v50, v50, v54
    v_mul_f32_e64 v51, v51, v55
    v_cvt_pk_bf16_f32 v28, v16, v17
    v_cvt_pk_bf16_f32 v29, v18, v19
    buffer_load_dwordx4 a[20:23], v1, s[8:11], s56 offen offset:1024 sc1
    v_mfma_f32_32x32x16_bf16 v[64:79], a[204:207], v[132:135], v[64:79]
    v_cvt_pk_bf16_f32 v30, v32, v33
    v_cvt_pk_bf16_f32 v31, v34, v35
    v_cvt_pk_bf16_f32 v44, v48, v49
    v_cvt_pk_bf16_f32 v45, v50, v51
    v_mov_b32 v46, v44
    v_mov_b32 v47, v45
    s_add_u32 s46, s46, 98304
    v_mfma_f32_32x32x16_bf16 v[64:79], a[216:219], v[112:115], v[64:79]
    v_permlane32_swap_b32 v28, v30
    v_permlane32_swap_b32 v29, v31
    v_permlane32_swap_b32 v44, v46
    v_permlane32_swap_b32 v45, v47
    buffer_store_dwordx4 v[28:31], v10, s[8:11], s46 offen sc1
    v_mfma_f32_32x32x16_bf16 v[64:79], a[228:231], v[116:119], v[64:79]
    buffer_store_dwordx4 v[44:47], v11, s[8:11], s46 offen offset:1024 sc1
    buffer_load_dwordx4 a[24:27], v1, s[8:11], s56 offen offset:2048 sc1
    v_mfma_f32_32x32x16_bf16 v[80:95], a[196:199], v[128:131], v[80:95]
    v_mfma_f32_32x32x16_bf16 v[80:95], a[208:211], v[132:135], v[80:95]
    v_mfma_f32_32x32x16_bf16 v[80:95], a[220:223], v[112:115], v[80:95]
    buffer_load_dwordx4 a[28:31], v1, s[8:11], s56 offen offset:3072 sc1
    s_nop 5
    ds_write_b128 v164, v[68:71] offset:0
    v_mfma_f32_32x32x16_bf16 v[80:95], a[232:235], v[116:119], v[80:95]
    v_mfma_f32_32x32x16_bf16 v[96:111], a[200:203], v[128:131], v[96:111]
    ds_write_b128 v164, v[76:79] offset:1024
    v_mfma_f32_32x32x16_bf16 v[96:111], a[212:215], v[132:135], v[96:111]
    buffer_load_dword v5, v166, s[8:11], s58 offen sc1
    v_mfma_f32_32x32x16_bf16 v[96:111], a[224:227], v[112:115], v[96:111]
    s_nop 6
    ds_write_b128 v164, v[84:87] offset:2048
    v_mfma_f32_32x32x16_bf16 v[96:111], a[236:239], v[116:119], v[96:111]
    ds_write_b128 v164, v[92:95] offset:3072
    s_nop 10
    ds_write_b128 v164, v[100:103] offset:4096
    ds_write_b128 v164, v[108:111] offset:5120
    v_add_u32 v167, s43, v1
    s_waitcnt lgkmcnt(0)
    s_barrier
    ds_read_b128 v[68:71], v165 offset:0
    ds_read_b128 v[76:79], v165 offset:1024
    ds_read_b128 v[84:87], v165 offset:2048
    ds_read_b128 v[92:95], v165 offset:3072
    ds_read_b128 v[100:103], v165 offset:4096
    ds_read_b128 v[108:111], v165 offset:5120
    ds_read_b128 v[160:163], v9 offset:1536
    s_waitcnt lgkmcnt(6)
    v_pk_add_f32 v[64:65], v[64:65], v[68:69]
    v_pk_add_f32 v[66:67], v[66:67], v[70:71]
    s_waitcnt lgkmcnt(4)
    v_pk_add_f32 v[80:81], v[80:81], v[84:85]
    v_pk_add_f32 v[82:83], v[82:83], v[86:87]
    s_waitcnt lgkmcnt(2)
    s_nop 0
    v_pk_add_f32 v[96:97], v[96:97], v[100:101]
    v_pk_add_f32 v[98:99], v[98:99], v[102:103]
    v_pk_add_f32 v[72:73], v[72:73], v[76:77]
    v_pk_add_f32 v[74:75], v[74:75], v[78:79]
    v_pk_add_f32 v[88:89], v[88:89], v[92:93]
    v_pk_add_f32 v[90:91], v[90:91], v[94:95]
    s_waitcnt lgkmcnt(1)
    v_pk_add_f32 v[104:105], v[104:105], v[108:109]
    v_pk_add_f32 v[106:107], v[106:107], v[110:111]
    s_waitcnt lgkmcnt(0)
    v_pk_fma_f32 v[64:65], v[160:161], v[136:137], v[64:65] op_sel_hi:[0,1,1] neg_lo:[1,0,0] neg_hi:[1,0,0]
    v_pk_fma_f32 v[66:67], v[160:161], v[138:139], v[66:67] op_sel_hi:[0,1,1] neg_lo:[1,0,0] neg_hi:[1,0,0]
    v_pk_fma_f32 v[80:81], v[160:161], v[144:145], v[80:81] op_sel_hi:[0,1,1] neg_lo:[1,0,0] neg_hi:[1,0,0]
    v_pk_fma_f32 v[82:83], v[160:161], v[146:147], v[82:83] op_sel_hi:[0,1,1] neg_lo:[1,0,0] neg_hi:[1,0,0]
    v_pk_fma_f32 v[96:97], v[160:161], v[152:153], v[96:97] op_sel_hi:[0,1,1] neg_lo:[1,0,0] neg_hi:[1,0,0]
    v_pk_fma_f32 v[98:99], v[160:161], v[154:155], v[98:99] op_sel_hi:[0,1,1] neg_lo:[1,0,0] neg_hi:[1,0,0]
    v_pk_mul_f32 v[68:69], v[64:65], v[64:65]
    v_pk_mul_f32 v[70:71], v[66:67], v[66:67]
    v_pk_mul_f32 v[84:85], v[80:81], v[80:81]
    v_pk_mul_f32 v[86:87], v[82:83], v[82:83]
    v_pk_mul_f32 v[100:101], v[96:97], v[96:97]
    v_pk_mul_f32 v[102:103], v[98:99], v[98:99]
    v_pk_fma_f32 v[68:69], v[68:69], v[162:163], v[160:161] op_sel:[0,0,1] op_sel_hi:[1,0,1]
    v_pk_fma_f32 v[70:71], v[70:71], v[162:163], v[160:161] op_sel:[0,0,1] op_sel_hi:[1,0,1]
    v_pk_fma_f32 v[84:85], v[84:85], v[162:163], v[160:161] op_sel:[0,0,1] op_sel_hi:[1,0,1]
    v_pk_fma_f32 v[86:87], v[86:87], v[162:163], v[160:161] op_sel:[0,0,1] op_sel_hi:[1,0,1]
    v_pk_fma_f32 v[100:101], v[100:101], v[162:163], v[160:161] op_sel:[0,0,1] op_sel_hi:[1,0,1]
    v_pk_fma_f32 v[102:103], v[102:103], v[162:163], v[160:161] op_sel:[0,0,1] op_sel_hi:[1,0,1]
    v_pk_mul_f32 v[68:69], v[68:69], v[64:65]
    v_pk_mul_f32 v[70:71], v[70:71], v[66:67]
    v_pk_mul_f32 v[84:85], v[84:85], v[80:81]
    v_pk_mul_f32 v[86:87], v[86:87], v[82:83]
    v_pk_mul_f32 v[100:101], v[100:101], v[96:97]
    v_pk_mul_f32 v[102:103], v[102:103], v[98:99]
    v_pk_fma_f32 v[72:73], v[160:161], v[140:141], v[72:73] op_sel_hi:[0,1,1] neg_lo:[1,0,0] neg_hi:[1,0,0]
    v_pk_fma_f32 v[74:75], v[160:161], v[142:143], v[74:75] op_sel_hi:[0,1,1] neg_lo:[1,0,0] neg_hi:[1,0,0]
    v_pk_fma_f32 v[88:89], v[160:161], v[148:149], v[88:89] op_sel_hi:[0,1,1] neg_lo:[1,0,0] neg_hi:[1,0,0]
    v_pk_fma_f32 v[90:91], v[160:161], v[150:151], v[90:91] op_sel_hi:[0,1,1] neg_lo:[1,0,0] neg_hi:[1,0,0]
    v_pk_fma_f32 v[104:105], v[160:161], v[156:157], v[104:105] op_sel_hi:[0,1,1] neg_lo:[1,0,0] neg_hi:[1,0,0]
    v_pk_fma_f32 v[106:107], v[160:161], v[158:159], v[106:107] op_sel_hi:[0,1,1] neg_lo:[1,0,0] neg_hi:[1,0,0]
    v_pk_mul_f32 v[72:73], v[64:65], v[72:73]
    v_pk_mul_f32 v[74:75], v[66:67], v[74:75]
    v_pk_mul_f32 v[88:89], v[80:81], v[88:89]
    v_pk_mul_f32 v[90:91], v[82:83], v[90:91]
    v_pk_mul_f32 v[104:105], v[96:97], v[104:105]
    v_pk_mul_f32 v[106:107], v[98:99], v[106:107]
    v_exp_f32 v68, v68
    v_exp_f32 v69, v69
    v_exp_f32 v70, v70
    v_exp_f32 v71, v71
    v_exp_f32 v84, v84
    v_exp_f32 v85, v85
    v_exp_f32 v86, v86
    v_exp_f32 v87, v87
    v_exp_f32 v100, v100
    v_exp_f32 v101, v101
    v_exp_f32 v102, v102
    v_exp_f32 v103, v103
    v_pk_fma_f32 v[68:69], v[68:69], v[162:163], v[162:163] op_sel:[0,1,1] op_sel_hi:[1,1,1]
    v_pk_fma_f32 v[70:71], v[70:71], v[162:163], v[162:163] op_sel:[0,1,1] op_sel_hi:[1,1,1]
    v_pk_fma_f32 v[84:85], v[84:85], v[162:163], v[162:163] op_sel:[0,1,1] op_sel_hi:[1,1,1]
    v_pk_fma_f32 v[86:87], v[86:87], v[162:163], v[162:163] op_sel:[0,1,1] op_sel_hi:[1,1,1]
    v_pk_fma_f32 v[100:101], v[100:101], v[162:163], v[162:163] op_sel:[0,1,1] op_sel_hi:[1,1,1]
    v_pk_fma_f32 v[102:103], v[102:103], v[162:163], v[162:163] op_sel:[0,1,1] op_sel_hi:[1,1,1]
    v_rcp_f32 v68, v68
    v_rcp_f32 v69, v69
    v_rcp_f32 v70, v70
    v_rcp_f32 v71, v71
    v_rcp_f32 v84, v84
    v_rcp_f32 v85, v85
    v_rcp_f32 v86, v86
    v_rcp_f32 v87, v87
    v_rcp_f32 v100, v100
    v_rcp_f32 v101, v101
    v_rcp_f32 v102, v102
    v_rcp_f32 v103, v103
    v_pk_mul_f32 v[64:65], v[72:73], v[68:69]
    v_pk_mul_f32 v[66:67], v[74:75], v[70:71]
    v_pk_mul_f32 v[80:81], v[88:89], v[84:85]
    v_pk_mul_f32 v[82:83], v[90:91], v[86:87]
    v_pk_mul_f32 v[96:97], v[104:105], v[100:101]
    v_pk_mul_f32 v[98:99], v[106:107], v[102:103]
    v_cvt_pk_bf16_f32 v76, v64, v65
    v_cvt_pk_bf16_f32 v77, v66, v67
    v_cvt_pk_bf16_f32 v78, v80, v81
    v_cvt_pk_bf16_f32 v79, v82, v83
    v_cvt_pk_bf16_f32 v92, v96, v97
    v_cvt_pk_bf16_f32 v93, v98, v99
    v_mov_b32 v94, v92
    v_mov_b32 v95, v93
    s_add_u32 s46, s46, 98304
    v_permlane32_swap_b32 v76, v78
    v_permlane32_swap_b32 v77, v79
    v_permlane32_swap_b32 v92, v94
    v_permlane32_swap_b32 v93, v95
    buffer_store_dwordx4 v[76:79], v10, s[8:11], s46 offen sc1
    buffer_store_dwordx4 v[92:95], v11, s[8:11], s46 offen offset:1024 sc1
L_D:
    s_and_b32 s30, s25, 1
    s_lshl_b32 s30, s30, 2
    s_and_b32 s31, s26, 3
    s_add_u32 s41, s30, s31
    s_lshr_b32 s33, s57, 3
    s_lshl_b32 s33, s33, 1
    s_and_b32 s30, s57, 1
    s_add_u32 s33, s33, s30
    s_lshl_b32 s33, s33, 3
    s_add_u32 s33, s33, s41
    s_lshl_b32 s33, s33, 7
    s_add_u32 s32, s33, 22609920
    s_add_u32 s33, s33, 22642688
    v_and_b32 v13, 15, v2
    v_lshrrev_b32 v4, 4, v2
    v_lshlrev_b32 v3, 7, v2
    v_lshl_add_u32 v3, v4, 28, v3
    v_mov_b32 v4, 0x01010101
    s_lshl_b32 s30, s24, 4
    s_add_u32 s32, s32, s30
    s_add_u32 s33, s33, s30
    s_mov_b32 s29, 262144
sp_37:
    s_load_dwordx4 s[64:67], s[84:85], s32 offset:0 glc
    s_waitcnt lgkmcnt(0)
    s_and_b32 s64, s64, s65
    s_and_b32 s64, s64, s66
    s_and_b32 s64, s64, s67
    s_cmp_eq_u32 s64, 0x01010101
    s_cbranch_scc1 sp_37_d
    s_sleep 2
    s_sub_u32 s29, s29, 1
    s_cbranch_scc0 sp_37
sp_37_d:
    s_waitcnt vmcnt(0)
    s_barrier
    s_cmp_lg_u32 s24, 0
    s_cbranch_scc1 sig_38
    s_nop 0
    buffer_store_dword v4, v3, s[8:11], s47 offen sc1
sig_38:
    ds_read_b128 a[80:83], v167 offset:0
    ds_read_b128 a[84:87], v167 offset:1024
    ds_read_b128 a[88:91], v167 offset:2048
    ds_read_b128 a[92:95], v167 offset:3072
    ds_read_b128 a[96:99], v167 offset:4096
    ds_read_b128 a[100:103], v167 offset:5120
    ds_read_b128 a[104:107], v167 offset:6144
    ds_read_b128 a[108:111], v167 offset:7168
    ds_read_b128 a[112:115], v167 offset:8192
    ds_read_b128 a[116:119], v167 offset:9216
    ds_read_b128 a[120:123], v167 offset:40960
    ds_read_b128 a[124:127], v167 offset:41984
    ds_read_b128 a[128:131], v167 offset:43008
    ds_read_b128 a[132:135], v167 offset:44032
    ds_read_b128 a[136:139], v167 offset:45056
    ds_read_b128 a[140:143], v167 offset:46080
    ds_read_b128 a[144:147], v167 offset:47104
    ds_read_b128 a[148:151], v167 offset:48128
    ds_read_b128 a[152:155], v167 offset:49152
    ds_read_b128 a[156:159], v167 offset:50176
    s_mul_i32 s30, s57, 49152
    s_add_u32 s30, s30, 15728640
    v_mov_b32_e64 v11, v166
    s_mul_i32 s31, s24, 12288
    s_add_u32 s49, s30, s31
    s_nop 0
    s_add_u32 s50, s49, 98304
    s_add_u32 s51, s49, 196608
    s_add_u32 s52, s49, 294912
    buffer_load_dwordx4 v[68:71], v1, s[8:11], s49 offen sc1
    buffer_load_dwordx4 v[72:75], v1, s[8:11], s49 offen offset:1024 sc1
    buffer_load_dwordx4 v[76:79], v1, s[8:11], s49 offen offset:2048 sc1
    buffer_load_dwordx4 v[80:83], v1, s[8:11], s49 offen offset:3072 sc1
    s_add_u32 s49, s49, 4096
    buffer_load_dwordx4 v[84:87], v1, s[8:11], s49 offen sc1
    s_add_u32 s56, s56, 4096
    buffer_load_dwordx4 a[32:35], v1, s[8:11], s56 offen sc1
    buffer_load_dwordx4 a[36:39], v1, s[8:11], s56 offen offset:1024 sc1
    buffer_load_dwordx4 v[88:91], v1, s[8:11], s49 offen offset:1024 sc1
    buffer_load_dwordx4 a[40:43], v1, s[8:11], s56 offen offset:2048 sc1
    buffer_load_dwordx4 a[44:47], v1, s[8:11], s56 offen offset:3072 sc1
    s_add_u32 s56, s56, 4096
    buffer_load_dwordx4 a[48:51], v1, s[8:11], s56 offen sc1
    buffer_load_dwordx4 a[52:55], v1, s[8:11], s56 offen offset:1024 sc1
    buffer_load_dwordx4 a[56:59], v1, s[8:11], s56 offen offset:2048 sc1
    buffer_load_dwordx4 v[92:95], v1, s[8:11], s49 offen offset:2048 sc1
    buffer_load_dwordx4 a[60:63], v1, s[8:11], s56 offen offset:3072 sc1
    s_add_u32 s56, s56, 4096
    buffer_load_dwordx4 a[64:67], v1, s[8:11], s56 offen sc1
    buffer_load_dwordx4 a[68:71], v1, s[8:11], s56 offen offset:1024 sc1
    buffer_load_dwordx4 a[72:75], v1, s[8:11], s56 offen offset:2048 sc1
    buffer_load_dwordx4 a[76:79], v1, s[8:11], s56 offen offset:3072 sc1
    buffer_load_dwordx4 v[96:99], v1, s[8:11], s49 offen offset:3072 sc1
    s_add_u32 s49, s49, 4096
    buffer_load_dwordx4 v[100:103], v1, s[8:11], s49 offen sc1
    buffer_load_dwordx4 v[104:107], v1, s[8:11], s49 offen offset:1024 sc1
    buffer_load_dwordx4 v[108:111], v1, s[8:11], s49 offen offset:2048 sc1
    buffer_load_dwordx4 v[112:115], v1, s[8:11], s49 offen offset:3072 sc1
    v_lshrrev_b32 v12, 5, v2
    v_lshlrev_b32 v12, 8, v12
    v_lshl_add_u32 v12, v13, 4, v12
    v_bfe_u32 v14, v2, 4, 1
    v_lshl_add_u32 v6, v14, 3, v12
    s_lshr_b32 s30, s24, 1
    s_lshl_b32 s30, s30, 1
    s_add_u32 s30, s30, s57
    s_mul_i32 s30, s30, 20480
    s_and_b32 s34, s24, 1
    s_mul_i32 s31, s41, 2560
    s_add_u32 s42, s30, s31
    s_add_u32 s42, s42, 12582912
    s_lshl_b32 s31, s34, 10
    s_add_u32 s35, s42, s31
    s_mul_i32 s31, s41, 160
    s_add_u32 s43, s30, s31
    buffer_load_dwordx2 v[56:57], v6, s[8:11], s35 offen offset:0 sc1
    buffer_load_dwordx2 v[58:59], v6, s[8:11], s35 offen offset:512 sc1
    buffer_load_dwordx2 v[60:61], v6, s[8:11], s42 offen offset:2048 sc1
    s_add_u32 s35, s35, 81920
    s_add_u32 s42, s42, 81920
    buffer_load_dwordx2 v[62:63], v6, s[8:11], s35 offen offset:0 sc1
    buffer_load_dwordx2 v[64:65], v6, s[8:11], s35 offen offset:512 sc1
    buffer_load_dwordx2 v[66:67], v6, s[8:11], s42 offen offset:2048 sc1
    v_mul_u32_u24 v12, 1280, v13
    v_lshrrev_b32_e64 v8, 4, v2
    v_lshl_add_u32 v8, v8, 3, v12
    s_lshl_b32 s31, s34, 30
    v_add_u32 v8, s31, v8
    v_lshl_add_u32 v12, v14, 5, v12
    v_lshrrev_b32_e64 v7, 5, v2
    v_lshl_add_u32 v7, v7, 4, v12
    s_lshl_b32 s31, s34, 6
    v_add_u32 v7, s31, v7
    s_lshl_b32 s31, s24, 10
    v_add_u32_e64 v9, s31, v1
    s_lshr_b32 s31, s24, 1
    s_mul_i32 s31, s31, 20480
    v_add_u32 v10, s31, v1
    s_lshl_b32 s31, s34, 13
    v_add_u32_e64 v15, s31, v10
    s_mov_b32 s29, 262144
sp_43:
    s_load_dwordx4 s[64:67], s[84:85], s33 offset:0 glc
    s_waitcnt lgkmcnt(0)
    s_and_b32 s64, s64, s65
    s_and_b32 s64, s64, s66
    s_and_b32 s64, s64, s67
    s_cmp_eq_u32 s64, 0x01010101
    s_cbranch_scc1 sp_43_d
    s_sleep 2
    s_sub_u32 s29, s29, 1
    s_cbranch_scc0 sp_43
sp_43_d:
    s_waitcnt vmcnt(29)
    v_mfma_f32_16x16x32_bf16 v[16:19], v[176:179], v[68:71], 0
    v_mfma_f32_16x16x32_bf16 v[20:23], v[180:183], v[68:71], 0
    v_mfma_f32_16x16x32_bf16 v[24:27], v[184:187], v[68:71], 0
    buffer_load_dwordx4 v[116:119], v1, s[8:11], s50 offen sc1
    v_mfma_f32_16x16x32_bf16 v[28:31], v[188:191], v[68:71], 0
    v_mfma_f32_16x16x32_bf16 v[32:35], v[192:195], v[68:71], 0
    s_waitcnt vmcnt(29)
    v_mfma_f32_16x16x32_bf16 v[16:19], v[196:199], v[72:75], v[16:19]
    buffer_load_dwordx4 v[120:123], v1, s[8:11], s50 offen offset:1024 sc1
    v_mfma_f32_16x16x32_bf16 v[20:23], v[200:203], v[72:75], v[20:23]
    v_mfma_f32_16x16x32_bf16 v[24:27], v[204:207], v[72:75], v[24:27]
    v_mfma_f32_16x16x32_bf16 v[28:31], v[208:211], v[72:75], v[28:31]
    buffer_load_dwordx4 v[124:127], v1, s[8:11], s50 offen offset:2048 sc1
    v_mfma_f32_16x16x32_bf16 v[32:35], v[212:215], v[72:75], v[32:35]
    s_waitcnt vmcnt(30)
    v_mfma_f32_16x16x32_bf16 v[16:19], v[216:219], v[76:79], v[16:19]
    v_mfma_f32_16x16x32_bf16 v[20:23], v[220:223], v[76:79], v[20:23]
    buffer_load_dwordx4 v[128:131], v1, s[8:11], s50 offen offset:3072 sc1
    v_mfma_f32_16x16x32_bf16 v[24:27], v[224:227], v[76:79], v[24:27]
    v_mfma_f32_16x16x32_bf16 v[28:31], v[228:231], v[76:79], v[28:31]
    v_mfma_f32_16x16x32_bf16 v[32:35], v[232:235], v[76:79], v[32:35]
    s_add_u32 s50, s50, 4096
    buffer_load_dwordx4 v[132:135], v1, s[8:11], s50 offen sc1
    s_waitcnt vmcnt(31)
    v_mfma_f32_16x16x32_bf16 v[16:19], v[236:239], v[80:83], v[16:19]
    v_mfma_f32_16x16x32_bf16 v[20:23], v[240:243], v[80:83], v[20:23]
    v_mfma_f32_16x16x32_bf16 v[24:27], v[244:247], v[80:83], v[24:27]
    buffer_load_dwordx4 v[136:139], v1, s[8:11], s50 offen offset:1024 sc1
    v_mfma_f32_16x16x32_bf16 v[28:31], v[248:251], v[80:83], v[28:31]
    v_mfma_f32_16x16x32_bf16 v[32:35], v[252:255], v[80:83], v[32:35]
    s_waitcnt vmcnt(31)
    v_mfma_f32_16x16x32_bf16 v[16:19], a[80:83], v[84:87], v[16:19]
    buffer_load_dwordx4 v[140:143], v1, s[8:11], s50 offen offset:2048 sc1
    v_mfma_f32_16x16x32_bf16 v[20:23], a[84:87], v[84:87], v[20:23]
    v_mfma_f32_16x16x32_bf16 v[24:27], a[88:91], v[84:87], v[24:27]
    v_mfma_f32_16x16x32_bf16 v[28:31], a[92:95], v[84:87], v[28:31]
    buffer_load_dwordx4 v[144:147], v1, s[8:11], s50 offen offset:3072 sc1
    v_mfma_f32_16x16x32_bf16 v[32:35], a[96:99], v[84:87], v[32:35]
    s_waitcnt vmcnt(30)
    v_mfma_f32_16x16x32_bf16 v[16:19], a[100:103], v[88:91], v[16:19]
    v_mfma_f32_16x16x32_bf16 v[20:23], a[104:107], v[88:91], v[20:23]
    s_add_u32 s50, s50, 4096
    buffer_load_dwordx4 v[148:151], v1, s[8:11], s50 offen sc1
    v_mfma_f32_16x16x32_bf16 v[24:27], a[108:111], v[88:91], v[24:27]
    v_mfma_f32_16x16x32_bf16 v[28:31], a[112:115], v[88:91], v[28:31]
    v_mfma_f32_16x16x32_bf16 v[32:35], a[116:119], v[88:91], v[32:35]
    buffer_load_dwordx4 v[152:155], v1, s[8:11], s50 offen offset:1024 sc1
    s_waitcnt vmcnt(26)
    v_mfma_f32_16x16x32_bf16 v[16:19], a[120:123], v[92:95], v[16:19]
    v_mfma_f32_16x16x32_bf16 v[20:23], a[124:127], v[92:95], v[20:23]
    v_mfma_f32_16x16x32_bf16 v[24:27], a[128:131], v[92:95], v[24:27]
    buffer_load_dwordx4 v[156:159], v1, s[8:11], s50 offen offset:2048 sc1
    v_mfma_f32_16x16x32_bf16 v[28:31], a[132:135], v[92:95], v[28:31]
    v_mfma_f32_16x16x32_bf16 v[32:35], a[136:139], v[92:95], v[32:35]
    s_waitcnt vmcnt(21)
    v_mfma_f32_16x16x32_bf16 v[16:19], a[140:143], v[96:99], v[16:19]
    buffer_load_dwordx4 v[160:163], v1, s[8:11], s50 offen offset:3072 sc1
    v_mfma_f32_16x16x32_bf16 v[20:23], a[144:147], v[96:99], v[20:23]
    v_mfma_f32_16x16x32_bf16 v[24:27], a[148:151], v[96:99], v[24:27]
    v_mfma_f32_16x16x32_bf16 v[28:31], a[152:155], v[96:99], v[28:31]
    buffer_load_dwordx4 v[164:167], v1, s[8:11], s51 offen sc1
    v_mfma_f32_16x16x32_bf16 v[32:35], a[156:159], v[96:99], v[32:35]
    s_waitcnt vmcnt(22)
    v_mfma_f32_16x16x32_bf16 v[16:19], a[0:3], v[100:103], v[16:19]
    v_mfma_f32_16x16x32_bf16 v[20:23], a[4:7], v[100:103], v[20:23]
    buffer_load_dwordx4 v[168:171], v1, s[8:11], s51 offen offset:1024 sc1
    v_mfma_f32_16x16x32_bf16 v[24:27], a[8:11], v[100:103], v[24:27]
    v_mfma_f32_16x16x32_bf16 v[28:31], a[12:15], v[100:103], v[28:31]
    v_mfma_f32_16x16x32_bf16 v[32:35], a[16:19], v[100:103], v[32:35]
    buffer_load_dwordx4 v[172:175], v1, s[8:11], s51 offen offset:2048 sc1
    s_waitcnt vmcnt(23)
    v_mfma_f32_16x16x32_bf16 v[16:19], a[20:23], v[104:107], v[16:19]
    v_mfma_f32_16x16x32_bf16 v[20:23], a[24:27], v[104:107], v[20:23]
    v_mfma_f32_16x16x32_bf16 v[24:27], a[28:31], v[104:107], v[24:27]
    buffer_load_dwordx4 a[160:163], v1, s[8:11], s51 offen offset:3072 sc1
    v_mfma_f32_16x16x32_bf16 v[28:31], a[32:35], v[104:107], v[28:31]
    v_mfma_f32_16x16x32_bf16 v[32:35], a[36:39], v[104:107], v[32:35]
    s_waitcnt vmcnt(23)
    v_mfma_f32_16x16x32_bf16 v[16:19], a[40:43], v[108:111], v[16:19]
    s_add_u32 s51, s51, 4096
    buffer_load_dwordx4 a[164:167], v1, s[8:11], s51 offen sc1
    v_mfma_f32_16x16x32_bf16 v[20:23], a[44:47], v[108:111], v[20:23]
    v_mfma_f32_16x16x32_bf16 v[24:27], a[48:51], v[108:111], v[24:27]
    v_mfma_f32_16x16x32_bf16 v[28:31], a[52:55], v[108:111], v[28:31]
    buffer_load_dwordx4 a[168:171], v1, s[8:11], s51 offen offset:1024 sc1
    v_mfma_f32_16x16x32_bf16 v[32:35], a[56:59], v[108:111], v[32:35]
    s_waitcnt vmcnt(24)
    v_mfma_f32_16x16x32_bf16 v[16:19], a[60:63], v[112:115], v[16:19]
    v_mfma_f32_16x16x32_bf16 v[20:23], a[64:67], v[112:115], v[20:23]
    buffer_load_dwordx4 a[172:175], v1, s[8:11], s51 offen offset:2048 sc1
    v_mfma_f32_16x16x32_bf16 v[24:27], a[68:71], v[112:115], v[24:27]
    v_mfma_f32_16x16x32_bf16 v[28:31], a[72:75], v[112:115], v[28:31]
    v_mfma_f32_16x16x32_bf16 v[32:35], a[76:79], v[112:115], v[32:35]
    buffer_load_dwordx4 a[176:179], v1, s[8:11], s51 offen offset:3072 sc1
    s_barrier
    s_waitcnt vmcnt(19)
    v_mfma_f32_16x16x32_bf16 v[36:39], v[176:179], v[116:119], 0
    v_mfma_f32_16x16x32_bf16 v[40:43], v[180:183], v[116:119], 0
    v_mfma_f32_16x16x32_bf16 v[44:47], v[184:187], v[116:119], 0
    s_add_u32 s51, s51, 4096
    buffer_load_dwordx4 a[180:183], v1, s[8:11], s51 offen sc1
    v_mfma_f32_16x16x32_bf16 v[48:51], v[188:191], v[116:119], 0
    v_mfma_f32_16x16x32_bf16 v[52:55], v[192:195], v[116:119], 0
    s_waitcnt vmcnt(19)
    v_mfma_f32_16x16x32_bf16 v[36:39], v[196:199], v[120:123], v[36:39]
    buffer_load_dwordx4 a[184:187], v1, s[8:11], s51 offen offset:1024 sc1
    v_mfma_f32_16x16x32_bf16 v[40:43], v[200:203], v[120:123], v[40:43]
    v_mfma_f32_16x16x32_bf16 v[44:47], v[204:207], v[120:123], v[44:47]
    v_mfma_f32_16x16x32_bf16 v[48:51], v[208:211], v[120:123], v[48:51]
    ds_write_b128 v9, v[16:19] offset:0
    buffer_load_dwordx4 a[188:191], v1, s[8:11], s51 offen offset:2048 sc1
    v_mfma_f32_16x16x32_bf16 v[52:55], v[212:215], v[120:123], v[52:55]
    s_waitcnt vmcnt(20)
    v_mfma_f32_16x16x32_bf16 v[36:39], v[216:219], v[124:127], v[36:39]
    v_mfma_f32_16x16x32_bf16 v[40:43], v[220:223], v[124:127], v[40:43]
    buffer_load_dwordx4 a[192:195], v1, s[8:11], s51 offen offset:3072 sc1
    v_mfma_f32_16x16x32_bf16 v[44:47], v[224:227], v[124:127], v[44:47]
    v_mfma_f32_16x16x32_bf16 v[48:51], v[228:231], v[124:127], v[48:51]
    v_mfma_f32_16x16x32_bf16 v[52:55], v[232:235], v[124:127], v[52:55]
    buffer_load_dwordx4 a[196:199], v1, s[8:11], s52 offen sc1
    s_waitcnt vmcnt(21)
    v_mfma_f32_16x16x32_bf16 v[36:39], v[236:239], v[128:131], v[36:39]
    v_mfma_f32_16x16x32_bf16 v[40:43], v[240:243], v[128:131], v[40:43]
    v_mfma_f32_16x16x32_bf16 v[44:47], v[244:247], v[128:131], v[44:47]
    ds_write_b128 v9, v[20:23] offset:4096
    buffer_load_dwordx4 a[200:203], v1, s[8:11], s52 offen offset:1024 sc1
    v_mfma_f32_16x16x32_bf16 v[48:51], v[248:251], v[128:131], v[48:51]
    v_mfma_f32_16x16x32_bf16 v[52:55], v[252:255], v[128:131], v[52:55]
    s_waitcnt vmcnt(21)
    v_mfma_f32_16x16x32_bf16 v[36:39], a[80:83], v[132:135], v[36:39]
    buffer_load_dwordx4 a[204:207], v1, s[8:11], s52 offen offset:2048 sc1
    v_mfma_f32_16x16x32_bf16 v[40:43], a[84:87], v[132:135], v[40:43]
    v_mfma_f32_16x16x32_bf16 v[44:47], a[88:91], v[132:135], v[44:47]
    v_mfma_f32_16x16x32_bf16 v[48:51], a[92:95], v[132:135], v[48:51]
    buffer_load_dwordx4 a[208:211], v1, s[8:11], s52 offen offset:3072 sc1
    v_mfma_f32_16x16x32_bf16 v[52:55], a[96:99], v[132:135], v[52:55]
    s_waitcnt vmcnt(22)
    v_mfma_f32_16x16x32_bf16 v[36:39], a[100:103], v[136:139], v[36:39]
    v_mfma_f32_16x16x32_bf16 v[40:43], a[104:107], v[136:139], v[40:43]
    ds_write_b128 v9, v[24:27] offset:8192
    s_add_u32 s52, s52, 4096
    buffer_load_dwordx4 a[212:215], v1, s[8:11], s52 offen sc1
    v_mfma_f32_16x16x32_bf16 v[44:47], a[108:111], v[136:139], v[44:47]
    v_mfma_f32_16x16x32_bf16 v[48:51], a[112:115], v[136:139], v[48:51]
    v_mfma_f32_16x16x32_bf16 v[52:55], a[116:119], v[136:139], v[52:55]
    buffer_load_dwordx4 a[216:219], v1, s[8:11], s52 offen offset:1024 sc1
    s_waitcnt vmcnt(23)
    v_mfma_f32_16x16x32_bf16 v[36:39], a[120:123], v[140:143], v[36:39]
    v_mfma_f32_16x16x32_bf16 v[40:43], a[124:127], v[140:143], v[40:43]
    v_mfma_f32_16x16x32_bf16 v[44:47], a[128:131], v[140:143], v[44:47]
    buffer_load_dwordx4 a[220:223], v1, s[8:11], s52 offen offset:2048 sc1
    v_mfma_f32_16x16x32_bf16 v[48:51], a[132:135], v[140:143], v[48:51]
    v_mfma_f32_16x16x32_bf16 v[52:55], a[136:139], v[140:143], v[52:55]
    ds_write_b128 v9, v[28:31] offset:12288
    s_waitcnt vmcnt(23)
    v_mfma_f32_16x16x32_bf16 v[36:39], a[140:143], v[144:147], v[36:39]
    buffer_load_dwordx4 a[224:227], v1, s[8:11], s52 offen offset:3072 sc1
    v_mfma_f32_16x16x32_bf16 v[40:43], a[144:147], v[144:147], v[40:43]
    v_mfma_f32_16x16x32_bf16 v[44:47], a[148:151], v[144:147], v[44:47]
    v_mfma_f32_16x16x32_bf16 v[48:51], a[152:155], v[144:147], v[48:51]
    s_add_u32 s52, s52, 4096
    buffer_load_dwordx4 a[228:231], v1, s[8:11], s52 offen sc1
    v_mfma_f32_16x16x32_bf16 v[52:55], a[156:159], v[144:147], v[52:55]
    s_waitcnt vmcnt(24)
    v_mfma_f32_16x16x32_bf16 v[36:39], a[0:3], v[148:151], v[36:39]
    v_mfma_f32_16x16x32_bf16 v[40:43], a[4:7], v[148:151], v[40:43]
    buffer_load_dwordx4 a[232:235], v1, s[8:11], s52 offen offset:1024 sc1
    v_mfma_f32_16x16x32_bf16 v[44:47], a[8:11], v[148:151], v[44:47]
    ds_write_b128 v9, v[32:35] offset:16384
    v_mfma_f32_16x16x32_bf16 v[48:51], a[12:15], v[148:151], v[48:51]
    v_mfma_f32_16x16x32_bf16 v[52:55], a[16:19], v[148:151], v[52:55]
    buffer_load_dwordx4 a[236:239], v1, s[8:11], s52 offen offset:2048 sc1
    s_waitcnt vmcnt(25)
    v_mfma_f32_16x16x32_bf16 v[36:39], a[20:23], v[152:155], v[36:39]
    v_mfma_f32_16x16x32_bf16 v[40:43], a[24:27], v[152:155], v[40:43]
    v_mfma_f32_16x16x32_bf16 v[44:47], a[28:31], v[152:155], v[44:47]
    buffer_load_dwordx4 a[240:243], v1, s[8:11], s52 offen offset:3072 sc1
    v_mfma_f32_16x16x32_bf16 v[48:51], a[32:35], v[152:155], v[48:51]
    v_mfma_f32_16x16x32_bf16 v[52:55], a[36:39], v[152:155], v[52:55]
    s_waitcnt vmcnt(25)
    v_mfma_f32_16x16x32_bf16 v[36:39], a[40:43], v[156:159], v[36:39]
    v_mfma_f32_16x16x32_bf16 v[40:43], a[44:47], v[156:159], v[40:43]
    v_mfma_f32_16x16x32_bf16 v[44:47], a[48:51], v[156:159], v[44:47]
    v_mfma_f32_16x16x32_bf16 v[48:51], a[52:55], v[156:159], v[48:51]
    v_mfma_f32_16x16x32_bf16 v[52:55], a[56:59], v[156:159], v[52:55]
    s_waitcnt vmcnt(24)
    v_mfma_f32_16x16x32_bf16 v[36:39], a[60:63], v[160:163], v[36:39]
    v_mfma_f32_16x16x32_bf16 v[40:43], a[64:67], v[160:163], v[40:43]
    v_mfma_f32_16x16x32_bf16 v[44:47], a[68:71], v[160:163], v[44:47]
    v_mfma_f32_16x16x32_bf16 v[48:51], a[72:75], v[160:163], v[48:51]
    v_mfma_f32_16x16x32_bf16 v[52:55], a[76:79], v[160:163], v[52:55]
    s_waitcnt vmcnt(23)
    v_mfma_f32_16x16x32_bf16 v[16:19], v[176:179], v[164:167], 0
    v_mfma_f32_16x16x32_bf16 v[20:23], v[180:183], v[164:167], 0
    v_mfma_f32_16x16x32_bf16 v[24:27], v[184:187], v[164:167], 0
    ds_write_b128 v9, v[36:39] offset:20480
    v_mfma_f32_16x16x32_bf16 v[28:31], v[188:191], v[164:167], 0
    v_mfma_f32_16x16x32_bf16 v[32:35], v[192:195], v[164:167], 0
    s_waitcnt vmcnt(22)
    v_mfma_f32_16x16x32_bf16 v[16:19], v[196:199], v[168:171], v[16:19]
    ds_write_b128 v9, v[40:43] offset:24576
    v_mfma_f32_16x16x32_bf16 v[20:23], v[200:203], v[168:171], v[20:23]
    v_mfma_f32_16x16x32_bf16 v[24:27], v[204:207], v[168:171], v[24:27]
    v_mfma_f32_16x16x32_bf16 v[28:31], v[208:211], v[168:171], v[28:31]
    ds_write_b128 v9, v[44:47] offset:28672
    v_mfma_f32_16x16x32_bf16 v[32:35], v[212:215], v[168:171], v[32:35]
    s_waitcnt vmcnt(21)
    v_mfma_f32_16x16x32_bf16 v[16:19], v[216:219], v[172:175], v[16:19]
    v_mfma_f32_16x16x32_bf16 v[20:23], v[220:223], v[172:175], v[20:23]
    ds_write_b128 v9, v[48:51] offset:32768
    v_mfma_f32_16x16x32_bf16 v[24:27], v[224:227], v[172:175], v[24:27]
    v_mfma_f32_16x16x32_bf16 v[28:31], v[228:231], v[172:175], v[28:31]
    v_mfma_f32_16x16x32_bf16 v[32:35], v[232:235], v[172:175], v[32:35]
    ds_write_b128 v9, v[52:55] offset:36864
    s_waitcnt vmcnt(20)
    v_mfma_f32_16x16x32_bf16 v[16:19], v[236:239], a[160:163], v[16:19]
    v_mfma_f32_16x16x32_bf16 v[20:23], v[240:243], a[160:163], v[20:23]
    v_mfma_f32_16x16x32_bf16 v[24:27], v[244:247], a[160:163], v[24:27]
    v_mfma_f32_16x16x32_bf16 v[28:31], v[248:251], a[160:163], v[28:31]
    v_add_u32 v9, 40960, v9
    s_waitcnt lgkmcnt(0)
    s_barrier
    v_mfma_f32_16x16x32_bf16 v[32:35], v[252:255], a[160:163], v[32:35]
    ds_read_b128 v[68:71], v15 offset:0
    s_waitcnt vmcnt(19)
    v_mfma_f32_16x16x32_bf16 v[16:19], a[80:83], a[164:167], v[16:19]
    ds_read_b128 v[72:75], v15 offset:1024
    v_mfma_f32_16x16x32_bf16 v[20:23], a[84:87], a[164:167], v[20:23]
    ds_read_b128 v[76:79], v15 offset:2048
    v_mfma_f32_16x16x32_bf16 v[24:27], a[88:91], a[164:167], v[24:27]
    ds_read_b128 v[80:83], v15 offset:3072
    v_mfma_f32_16x16x32_bf16 v[28:31], a[92:95], a[164:167], v[28:31]
    ds_read_b128 v[84:87], v15 offset:4096
    v_mfma_f32_16x16x32_bf16 v[32:35], a[96:99], a[164:167], v[32:35]
    ds_read_b128 v[88:91], v15 offset:5120
    s_waitcnt vmcnt(18)
    v_mfma_f32_16x16x32_bf16 v[16:19], a[100:103], a[168:171], v[16:19]
    ds_read_b128 v[92:95], v15 offset:6144
    v_mfma_f32_16x16x32_bf16 v[20:23], a[104:107], a[168:171], v[20:23]
    ds_read_b128 v[96:99], v15 offset:7168
    v_mfma_f32_16x16x32_bf16 v[24:27], a[108:111], a[168:171], v[24:27]
    ds_read_b128 v[100:103], v10 offset:16384
    v_mfma_f32_16x16x32_bf16 v[28:31], a[112:115], a[168:171], v[28:31]
    ds_read_b128 v[104:107], v10 offset:17408
    v_mfma_f32_16x16x32_bf16 v[32:35], a[116:119], a[168:171], v[32:35]
    ds_read_b128 v[108:111], v10 offset:18432
    s_waitcnt vmcnt(17)
    v_mfma_f32_16x16x32_bf16 v[16:19], a[120:123], a[172:175], v[16:19]
    ds_read_b128 v[112:115], v10 offset:19456
    v_mfma_f32_16x16x32_bf16 v[20:23], a[124:127], a[172:175], v[20:23]
    v_lshlrev_b32_e64 v116, 16, v56
    v_and_b32 v117, 0xffff0000, v56
    v_mfma_f32_16x16x32_bf16 v[24:27], a[128:131], a[172:175], v[24:27]
    v_lshlrev_b32_e64 v118, 16, v57
    v_and_b32 v119, 0xffff0000, v57
    v_mfma_f32_16x16x32_bf16 v[28:31], a[132:135], a[172:175], v[28:31]
    v_lshlrev_b32_e64 v120, 16, v58
    v_and_b32 v121, 0xffff0000, v58
    v_mfma_f32_16x16x32_bf16 v[32:35], a[136:139], a[172:175], v[32:35]
    v_lshlrev_b32_e64 v122, 16, v59
    v_and_b32 v123, 0xffff0000, v59
    s_waitcnt vmcnt(16)
    v_mfma_f32_16x16x32_bf16 v[16:19], a[140:143], a[176:179], v[16:19]
    v_lshlrev_b32 v124, 16, v60
    v_and_b32 v125, 0xffff0000, v60
    v_mfma_f32_16x16x32_bf16 v[20:23], a[144:147], a[176:179], v[20:23]
    v_lshlrev_b32_e64 v126, 16, v61
    v_and_b32 v127, 0xffff0000, v61
    v_mfma_f32_16x16x32_bf16 v[24:27], a[148:151], a[176:179], v[24:27]
    s_waitcnt lgkmcnt(11)
    v_add_f32 v116, v116, v68
    v_add_f32_e64 v117, v117, v69
    v_mfma_f32_16x16x32_bf16 v[28:31], a[152:155], a[176:179], v[28:31]
    v_add_f32 v118, v118, v70
    v_add_f32 v119, v119, v71
    v_mfma_f32_16x16x32_bf16 v[32:35], a[156:159], a[176:179], v[32:35]
    s_waitcnt lgkmcnt(10)
    v_add_f32 v116, v116, v72
    v_add_f32 v117, v117, v73
    s_waitcnt vmcnt(15)
    v_mfma_f32_16x16x32_bf16 v[16:19], a[0:3], a[180:183], v[16:19]
    v_add_f32 v118, v118, v74
    v_add_f32 v119, v119, v75
    v_mfma_f32_16x16x32_bf16 v[20:23], a[4:7], a[180:183], v[20:23]
    s_waitcnt lgkmcnt(9)
    v_add_f32 v116, v116, v76
    v_add_f32_e64 v117, v117, v77
    v_mfma_f32_16x16x32_bf16 v[24:27], a[8:11], a[180:183], v[24:27]
    v_add_f32 v118, v118, v78
    v_add_f32 v119, v119, v79
    v_mfma_f32_16x16x32_bf16 v[28:31], a[12:15], a[180:183], v[28:31]
    s_waitcnt lgkmcnt(8)
    v_add_f32 v116, v116, v80
    v_add_f32_e64 v117, v117, v81
    v_mfma_f32_16x16x32_bf16 v[32:35], a[16:19], a[180:183], v[32:35]
    v_add_f32 v118, v118, v82
    v_add_f32_e64 v119, v119, v83
    s_waitcnt vmcnt(14)
    v_mfma_f32_16x16x32_bf16 v[16:19], a[20:23], a[184:187], v[16:19]
    s_waitcnt lgkmcnt(7)
    v_add_f32 v120, v120, v84
    v_add_f32_e64 v121, v121, v85
    v_mfma_f32_16x16x32_bf16 v[20:23], a[24:27], a[184:187], v[20:23]
    v_add_f32 v122, v122, v86
    v_add_f32 v123, v123, v87
    v_mfma_f32_16x16x32_bf16 v[24:27], a[28:31], a[184:187], v[24:27]
    s_waitcnt lgkmcnt(6)
    v_add_f32 v120, v120, v88
    v_add_f32_e64 v121, v121, v89
    v_mfma_f32_16x16x32_bf16 v[28:31], a[32:35], a[184:187], v[28:31]
    v_add_f32 v122, v122, v90
    v_add_f32 v123, v123, v91
    v_mfma_f32_16x16x32_bf16 v[32:35], a[36:39], a[184:187], v[32:35]
    s_waitcnt lgkmcnt(5)
    v_add_f32 v120, v120, v92
    v_add_f32 v121, v121, v93
    s_waitcnt vmcnt(13)
    v_mfma_f32_16x16x32_bf16 v[16:19], a[40:43], a[188:191], v[16:19]
    v_add_f32 v122, v122, v94
    v_add_f32 v123, v123, v95
    v_mfma_f32_16x16x32_bf16 v[20:23], a[44:47], a[188:191], v[20:23]
    s_waitcnt lgkmcnt(4)
    v_add_f32 v120, v120, v96
    v_add_f32_e64 v121, v121, v97
    v_mfma_f32_16x16x32_bf16 v[24:27], a[48:51], a[188:191], v[24:27]
    v_add_f32 v122, v122, v98
    v_add_f32 v123, v123, v99
    v_mfma_f32_16x16x32_bf16 v[28:31], a[52:55], a[188:191], v[28:31]
    s_waitcnt lgkmcnt(3)
    v_add_f32 v124, v124, v100
    v_add_f32_e64 v125, v125, v101
    v_mfma_f32_16x16x32_bf16 v[32:35], a[56:59], a[188:191], v[32:35]
    v_add_f32 v126, v126, v102
    v_add_f32_e64 v127, v127, v103
    s_waitcnt vmcnt(12)
    v_mfma_f32_16x16x32_bf16 v[16:19], a[60:63], a[192:195], v[16:19]
    s_waitcnt lgkmcnt(2)
    v_add_f32 v124, v124, v104
    v_add_f32_e64 v125, v125, v105
    v_mfma_f32_16x16x32_bf16 v[20:23], a[64:67], a[192:195], v[20:23]
    v_add_f32 v126, v126, v106
    v_add_f32 v127, v127, v107
    v_mfma_f32_16x16x32_bf16 v[24:27], a[68:71], a[192:195], v[24:27]
    s_waitcnt lgkmcnt(1)
    v_add_f32 v124, v124, v108
    v_add_f32_e64 v125, v125, v109
    v_mfma_f32_16x16x32_bf16 v[28:31], a[72:75], a[192:195], v[28:31]
    v_add_f32 v126, v126, v110
    v_add_f32 v127, v127, v111
    v_mfma_f32_16x16x32_bf16 v[32:35], a[76:79], a[192:195], v[32:35]
    s_waitcnt lgkmcnt(0)
    v_add_f32 v124, v124, v112
    v_add_f32 v125, v125, v113
    s_waitcnt vmcnt(11)
    v_mfma_f32_16x16x32_bf16 v[36:39], v[176:179], a[196:199], 0
    v_add_f32 v126, v126, v114
    v_add_f32 v127, v127, v115
    v_mfma_f32_16x16x32_bf16 v[40:43], v[180:183], a[196:199], 0
    v_cvt_pk_bf16_f32 v68, v116, v117
    v_cvt_pk_bf16_f32 v69, v118, v119
    v_mfma_f32_16x16x32_bf16 v[44:47], v[184:187], a[196:199], 0
    v_cvt_pk_bf16_f32 v70, v120, v121
    v_cvt_pk_bf16_f32 v71, v122, v123
    v_mfma_f32_16x16x32_bf16 v[48:51], v[188:191], a[196:199], 0
    v_cvt_pk_bf16_f32 v72, v124, v125
    v_cvt_pk_bf16_f32 v73, v126, v127
    v_mfma_f32_16x16x32_bf16 v[52:55], v[192:195], a[196:199], 0
    v_permlane16_swap_b32 v68, v70
    v_permlane16_swap_b32 v69, v71
    s_waitcnt vmcnt(10)
    v_mfma_f32_16x16x32_bf16 v[36:39], v[196:199], a[200:203], v[36:39]
    buffer_store_dwordx4 v[68:71], v7, s[12:15], s43 offen
    v_mfma_f32_16x16x32_bf16 v[40:43], v[200:203], a[200:203], v[40:43]
    buffer_store_dwordx2 v[72:73], v8, s[12:15], s43 offen offset:128
    v_mfma_f32_16x16x32_bf16 v[44:47], v[204:207], a[200:203], v[44:47]
    v_mfma_f32_16x16x32_bf16 v[48:51], v[208:211], a[200:203], v[48:51]
    v_mfma_f32_16x16x32_bf16 v[52:55], v[212:215], a[200:203], v[52:55]
    s_waitcnt vmcnt(11)
    v_mfma_f32_16x16x32_bf16 v[36:39], v[216:219], a[204:207], v[36:39]
    v_mfma_f32_16x16x32_bf16 v[40:43], v[220:223], a[204:207], v[40:43]
    v_mfma_f32_16x16x32_bf16 v[44:47], v[224:227], a[204:207], v[44:47]
    ds_write_b128 v9, v[16:19] offset:0
    v_mfma_f32_16x16x32_bf16 v[48:51], v[228:231], a[204:207], v[48:51]
    v_mfma_f32_16x16x32_bf16 v[52:55], v[232:235], a[204:207], v[52:55]
    s_waitcnt vmcnt(10)
    v_mfma_f32_16x16x32_bf16 v[36:39], v[236:239], a[208:211], v[36:39]
    v_mfma_f32_16x16x32_bf16 v[40:43], v[240:243], a[208:211], v[40:43]
    ds_write_b128 v9, v[20:23] offset:4096
    v_mfma_f32_16x16x32_bf16 v[44:47], v[244:247], a[208:211], v[44:47]
    v_mfma_f32_16x16x32_bf16 v[48:51], v[248:251], a[208:211], v[48:51]
    v_mfma_f32_16x16x32_bf16 v[52:55], v[252:255], a[208:211], v[52:55]
    s_waitcnt vmcnt(9)
    v_mfma_f32_16x16x32_bf16 v[36:39], a[80:83], a[212:215], v[36:39]
    ds_write_b128 v9, v[24:27] offset:8192
    v_mfma_f32_16x16x32_bf16 v[40:43], a[84:87], a[212:215], v[40:43]
    v_mfma_f32_16x16x32_bf16 v[44:47], a[88:91], a[212:215], v[44:47]
    v_mfma_f32_16x16x32_bf16 v[48:51], a[92:95], a[212:215], v[48:51]
    v_mfma_f32_16x16x32_bf16 v[52:55], a[96:99], a[212:215], v[52:55]
    ds_write_b128 v9, v[28:31] offset:12288
    s_waitcnt vmcnt(8)
    v_mfma_f32_16x16x32_bf16 v[36:39], a[100:103], a[216:219], v[36:39]
    v_mfma_f32_16x16x32_bf16 v[40:43], a[104:107], a[216:219], v[40:43]
    v_mfma_f32_16x16x32_bf16 v[44:47], a[108:111], a[216:219], v[44:47]
    v_mfma_f32_16x16x32_bf16 v[48:51], a[112:115], a[216:219], v[48:51]
    ds_write_b128 v9, v[32:35] offset:16384
    v_mfma_f32_16x16x32_bf16 v[52:55], a[116:119], a[216:219], v[52:55]
    s_waitcnt vmcnt(7)
    v_mfma_f32_16x16x32_bf16 v[36:39], a[120:123], a[220:223], v[36:39]
    v_mfma_f32_16x16x32_bf16 v[40:43], a[124:127], a[220:223], v[40:43]
    v_mfma_f32_16x16x32_bf16 v[44:47], a[128:131], a[220:223], v[44:47]
    v_mfma_f32_16x16x32_bf16 v[48:51], a[132:135], a[220:223], v[48:51]
    v_mfma_f32_16x16x32_bf16 v[52:55], a[136:139], a[220:223], v[52:55]
    s_waitcnt vmcnt(6)
    v_mfma_f32_16x16x32_bf16 v[36:39], a[140:143], a[224:227], v[36:39]
    v_mfma_f32_16x16x32_bf16 v[40:43], a[144:147], a[224:227], v[40:43]
    v_mfma_f32_16x16x32_bf16 v[44:47], a[148:151], a[224:227], v[44:47]
    v_mfma_f32_16x16x32_bf16 v[48:51], a[152:155], a[224:227], v[48:51]
    v_mfma_f32_16x16x32_bf16 v[52:55], a[156:159], a[224:227], v[52:55]
    s_waitcnt vmcnt(5)
    v_mfma_f32_16x16x32_bf16 v[36:39], a[0:3], a[228:231], v[36:39]
    s_waitcnt vmcnt(4)
    v_mfma_f32_16x16x32_bf16 v[36:39], a[20:23], a[232:235], v[36:39]
    s_waitcnt vmcnt(3)
    v_mfma_f32_16x16x32_bf16 v[36:39], a[40:43], a[236:239], v[36:39]
    s_waitcnt vmcnt(2)
    v_mfma_f32_16x16x32_bf16 v[36:39], a[60:63], a[240:243], v[36:39]
    v_mfma_f32_16x16x32_bf16 v[40:43], a[4:7], a[228:231], v[40:43]
    v_mfma_f32_16x16x32_bf16 v[40:43], a[24:27], a[232:235], v[40:43]
    v_mfma_f32_16x16x32_bf16 v[40:43], a[44:47], a[236:239], v[40:43]
    v_mfma_f32_16x16x32_bf16 v[40:43], a[64:67], a[240:243], v[40:43]
    v_mfma_f32_16x16x32_bf16 v[44:47], a[8:11], a[228:231], v[44:47]
    v_mfma_f32_16x16x32_bf16 v[44:47], a[28:31], a[232:235], v[44:47]
    v_mfma_f32_16x16x32_bf16 v[44:47], a[48:51], a[236:239], v[44:47]
    v_mfma_f32_16x16x32_bf16 v[44:47], a[68:71], a[240:243], v[44:47]
    ds_write_b128 v9, v[36:39] offset:20480
    v_mfma_f32_16x16x32_bf16 v[48:51], a[12:15], a[228:231], v[48:51]
    v_mfma_f32_16x16x32_bf16 v[48:51], a[32:35], a[232:235], v[48:51]
    v_mfma_f32_16x16x32_bf16 v[48:51], a[52:55], a[236:239], v[48:51]
    v_mfma_f32_16x16x32_bf16 v[48:51], a[72:75], a[240:243], v[48:51]
    ds_write_b128 v9, v[40:43] offset:24576
    v_mfma_f32_16x16x32_bf16 v[52:55], a[16:19], a[228:231], v[52:55]
    v_mfma_f32_16x16x32_bf16 v[52:55], a[36:39], a[232:235], v[52:55]
    v_mfma_f32_16x16x32_bf16 v[52:55], a[56:59], a[236:239], v[52:55]
    v_mfma_f32_16x16x32_bf16 v[52:55], a[76:79], a[240:243], v[52:55]
    ds_write_b128 v9, v[44:47] offset:28672
    s_nop 1
    ds_write_b128 v9, v[48:51] offset:32768
    s_nop 3
    ds_write_b128 v9, v[52:55] offset:36864
    s_waitcnt lgkmcnt(0)
    s_barrier
    s_nop 0
    v_add_u32 v15, 40960, v15
    v_add_u32 v10, 40960, v10
    ds_read_b128 v[68:71], v15 offset:0
    ds_read_b128 v[72:75], v15 offset:1024
    ds_read_b128 v[76:79], v15 offset:2048
    ds_read_b128 v[80:83], v15 offset:3072
    ds_read_b128 v[84:87], v15 offset:4096
    ds_read_b128 v[88:91], v15 offset:5120
    ds_read_b128 v[92:95], v15 offset:6144
    ds_read_b128 v[96:99], v15 offset:7168
    ds_read_b128 v[100:103], v10 offset:16384
    ds_read_b128 v[104:107], v10 offset:17408
    ds_read_b128 v[108:111], v10 offset:18432
    ds_read_b128 v[112:115], v10 offset:19456
    v_lshlrev_b32_e64 v116, 16, v62
    v_and_b32 v117, 0xffff0000, v62
    v_lshlrev_b32_e64 v118, 16, v63
    v_and_b32 v119, 0xffff0000, v63
    v_lshlrev_b32_e64 v120, 16, v64
    v_and_b32 v121, 0xffff0000, v64
    v_lshlrev_b32_e64 v122, 16, v65
    v_and_b32 v123, 0xffff0000, v65
    v_lshlrev_b32_e64 v124, 16, v66
    v_and_b32 v125, 0xffff0000, v66
    v_lshlrev_b32_e64 v126, 16, v67
    v_and_b32 v127, 0xffff0000, v67
    s_waitcnt lgkmcnt(11)
    v_pk_add_f32 v[116:117], v[116:117], v[68:69]
    v_pk_add_f32 v[118:119], v[118:119], v[70:71]
    s_waitcnt lgkmcnt(10)
    v_pk_add_f32 v[116:117], v[116:117], v[72:73]
    v_pk_add_f32 v[118:119], v[118:119], v[74:75]
    s_waitcnt lgkmcnt(9)
    v_pk_add_f32 v[116:117], v[116:117], v[76:77]
    v_pk_add_f32 v[118:119], v[118:119], v[78:79]
    s_waitcnt lgkmcnt(8)
    v_pk_add_f32 v[116:117], v[116:117], v[80:81]
    v_pk_add_f32 v[118:119], v[118:119], v[82:83]
    s_waitcnt lgkmcnt(7)
    v_pk_add_f32 v[120:121], v[120:121], v[84:85]
    v_pk_add_f32 v[122:123], v[122:123], v[86:87]
    s_waitcnt lgkmcnt(6)
    v_pk_add_f32 v[120:121], v[120:121], v[88:89]
    v_pk_add_f32 v[122:123], v[122:123], v[90:91]
    s_waitcnt lgkmcnt(5)
    v_pk_add_f32 v[120:121], v[120:121], v[92:93]
    v_pk_add_f32 v[122:123], v[122:123], v[94:95]
    s_waitcnt lgkmcnt(4)
    v_pk_add_f32 v[120:121], v[120:121], v[96:97]
    v_pk_add_f32 v[122:123], v[122:123], v[98:99]
    s_waitcnt lgkmcnt(3)
    v_pk_add_f32 v[124:125], v[124:125], v[100:101]
    v_pk_add_f32 v[126:127], v[126:127], v[102:103]
    s_waitcnt lgkmcnt(2)
    v_pk_add_f32 v[124:125], v[124:125], v[104:105]
    v_pk_add_f32 v[126:127], v[126:127], v[106:107]
    s_waitcnt lgkmcnt(1)
    v_pk_add_f32 v[124:125], v[124:125], v[108:109]
    v_pk_add_f32 v[126:127], v[126:127], v[110:111]
    s_waitcnt lgkmcnt(0)
    v_pk_add_f32 v[124:125], v[124:125], v[112:113]
    v_pk_add_f32 v[126:127], v[126:127], v[114:115]
    v_cvt_pk_bf16_f32 v68, v116, v117
    v_cvt_pk_bf16_f32 v69, v118, v119
    v_cvt_pk_bf16_f32 v70, v120, v121
    v_cvt_pk_bf16_f32 v71, v122, v123
    v_cvt_pk_bf16_f32 v72, v124, v125
    v_cvt_pk_bf16_f32 v73, v126, v127
    s_add_u32 s43, s43, 81920
    v_permlane16_swap_b32 v68, v70
    v_permlane16_swap_b32 v69, v71
    buffer_store_dwordx4 v[68:71], v7, s[12:15], s43 offen
    buffer_store_dwordx2 v[72:73], v8, s[12:15], s43 offen offset:128
L_end:
    s_endpgm
.section .rodata,"a"
.p2align 6
.amdhsa_kernel sequential_preLN__linear_kernel_hedgehog__glu_gated_geglu__prompt_kernel
  .amdhsa_next_free_vgpr 512
  .amdhsa_next_free_sgpr 102
  .amdhsa_accum_offset 256
  .amdhsa_group_segment_fixed_size 0
  .amdhsa_kernarg_size 88
  .amdhsa_user_sgpr_count 2
  .amdhsa_user_sgpr_kernarg_segment_ptr 1
  .amdhsa_system_sgpr_workgroup_id_x 1
  .amdhsa_float_denorm_mode_32 3
.end_amdhsa_kernel
```
